```python
import torch

def _softmax(x, axis=-1):
    return torch.softmax(x, dim=axis)
def _gelu(x):
    return torch.nn.functional.gelu(x, approximate="tanh")
def _silu(x):
    return torch.nn.functional.silu(x)
def _sigmoid(x):
    return torch.sigmoid(x)
def _layernorm(x, axis=-1, eps=1e-5):
    m = x.mean(dim=axis, keepdim=True)
    v = x.var(dim=axis, keepdim=True, unbiased=False)
    return (x - m) / torch.sqrt(v + eps)
def _scatter_add(tgt, idx, src, axis=0):
    return tgt.clone().index_add_(axis, idx, src)
def _segment_sum(src, seg, n):
    out = torch.zeros((n,) + src.shape[1:], dtype=src.dtype)
    return out.index_add_(0, seg, src)
def _pad(x, pw):
    flat = tuple(v for pair in reversed(pw) for v in pair)
    return torch.nn.functional.pad(x, flat)

kernel_name = 'recurrent_scan__linear_attn_block__dense_activation_gelu__prompt'

def setup_inputs():

    _w = (lambda a: (lambda t: t.to(torch.bfloat16) if t.is_floating_point() else t)(torch.as_tensor(a)))
    def _A_setup():
        B, S, D = 1, 2048, 512
        return {
            "x": _w((lambda *s: torch.randn(*s, dtype=torch.bfloat16) * 0.05)(B, S, D)),
            "wqkv": _w((lambda *s: torch.randn(*s, dtype=torch.bfloat16) * 0.2)(D, 3 * D)),
            "wo": _w((lambda *s: torch.randn(*s, dtype=torch.bfloat16) * 0.2)(D, D)),
        }
    _A_in = _A_setup()

    def _B_setup():
        B, S, D, F = 1, 2048, 512, 1792
        return {
            "x": _w((lambda *s: torch.randn(*s, dtype=torch.bfloat16) * 0.05)(B, S, D)),
            "w1": _w((lambda *s: torch.randn(*s, dtype=torch.bfloat16) * 0.4)(D, F) * (D ** -0.5)),
            "b1": _w((lambda *s: torch.randn(*s, dtype=torch.bfloat16) * 12.8)(F) * 0.01),
            "w2": _w((lambda *s: torch.randn(*s, dtype=torch.bfloat16) * 0.1)(F, D) * (F ** -0.5)),
            "b2": _w((lambda *s: torch.randn(*s, dtype=torch.bfloat16) * 1.6)(D) * 0.01),
        }
    _B_in = _B_setup()

    return {
        "A_x": _A_in["x"],
        "A_wqkv": _A_in["wqkv"],
        "A_wo": _A_in["wo"],
        "B_x": _B_in["x"],
        "B_w1": _B_in["w1"],
        "B_b1": _B_in["b1"],
        "B_w2": _B_in["w2"],
        "B_b2": _B_in["b2"],
    }

def reference(A_x, A_wqkv, A_wo, B_x, B_w1, B_b1, B_w2, B_b2):
    def _A_ref(x, wqkv, wo):
        B, S, D = x.shape
        H = 32; Dh = D // H
        qkv = (lambda x, *d: x.permute(*d))((x @ wqkv).reshape(B, S, 3, H, Dh), 2, 0, 3, 1, 4)
        q, k, v = qkv[0], qkv[1], qkv[2]
        phi = lambda t: torch.where(t > 0, t + 1, torch.exp(t)) + 1e-6
        pq, pk = phi(q), phi(k)
        kv = torch.einsum("bhsd,bhse->bhde", pk, v)
        z = torch.einsum("bhsd->bhd", pk)
        num = torch.einsum("bhqd,bhde->bhqe", pq, kv)
        den = torch.einsum("bhqd,bhd->bhq", pq, z)[..., None] + 1e-6
        o = num / den
        return (lambda x, *d: x.permute(*d))(o, 0, 2, 1, 3).reshape(B, S, D) @ wo

    def _B_ref(x, w1, b1, w2, b2):
        h = torch.einsum("bsd,df->bsf", x, w1) + b1
        h = _gelu(h)
        return torch.einsum("bsf,fd->bsd", h, w2) + b2

    x = A_x
    xn = _layernorm(x, axis=-1)
    s = _A_ref(xn, A_wqkv, A_wo)
    g = _silu(_B_ref(xn, B_w1, B_b1, B_w2, B_b2))
    return x + s * g
```

```asm
; @launch grid=(256,1,1) block=(512,1,1) lds=163840
.amdgcn_target "amdgcn-amd-amdhsa--gfx950"
.text
.globl recurrent_scan__linear_attn_block__dense_activation_gelu__prompt_kernel
.p2align 8
.type recurrent_scan__linear_attn_block__dense_activation_gelu__prompt_kernel,@function
recurrent_scan__linear_attn_block__dense_activation_gelu__prompt_kernel:
    s_cmp_ge_u32 s2, 256
    s_cbranch_scc1 L_end
    s_load_dwordx16 s[48:63], s[0:1], 0
    s_load_dwordx2 s[64:65], s[0:1], 64
    s_load_dwordx2 s[66:67], s[0:1], 80
    s_getpc_b64 s[68:69]
L_pc:
    s_lshr_b32 s70, s2, 3
    v_and_b32 v1, 15, v0
    v_lshl_or_b32 v1, s70, 4, v1
    v_lshlrev_b32_e64 v1, 7, v1
    v_min_u32 v1, L_end-L_pc, v1
    global_load_dword a127, v1, s[68:69]
    v_lshrrev_b32 v2, 6, v0
    v_and_b32 v0, 63, v0
    v_readfirstlane_b32 s42, v2
    s_bitcmp1_b32 s2, 6
    s_cbranch_scc1 L_typeQ
    s_cmp_lt_u32 s42, 4
    s_cbranch_scc1 L_AKV
    s_and_b32 s42, s42, 3
L_BKV:
    s_and_b32 s90, s2, 7
    s_lshr_b32 s91, s2, 3
    s_lshr_b32 s70, s90, 2
    s_and_b32 s71, s91, 7
    s_lshl_b32 s43, s70, 3
    s_add_u32 s43, s43, s71
    s_and_b32 s72, s2, 3
    s_lshl_b32 s72, s72, 1
    s_lshr_b32 s92, s2, 7
    s_add_u32 s3, s72, s92
    v_lshrrev_b32 v28, 5, v0
    v_and_b32 v29, 3, v0
    s_add_u32 s47, s71, s72
    s_lshl_b32 s93, s43, 2
    s_add_u32 s93, s93, s42
    s_lshl_b32 s92, s93, 15
    v_lshrrev_b32 v27, 3, v0
    v_lshlrev_b32 v27, 12, v27
    v_and_b32 v26, 7, v0
    v_lshlrev_b32 v8, 2, v28
    v_xor_b32 v26, v26, v8
    v_lshl_or_b32 v27, v26, 4, v27
    v_add_u32 v8, s92, v27
    v_xor_b32 v9, 16, v8
    v_xor_b32 v10, 32, v8
    v_xor_b32 v11, 48, v8
    s_lshr_b32 s73, s42, 1
    s_lshl_b32 s73, s73, 10
    s_lshl_b32 s92, s3, 7
    s_add_u32 s73, s73, s92
    s_add_u32 s73, s73, 1024
    s_and_b32 s92, s42, 1
    s_mul_i32 s92, s92, 98304
    s_add_u32 s74, s73, s92
    v_bfe_u32 v25, v0, 2, 3
    v_lshlrev_b32 v26, 6, v28
    v_lshl_or_b32 v26, v29, 4, v26
    v_mul_u32_u24 v27, 3072, v25
    v_add3_u32 v12, v26, v27, s74
    v_add_u32 v13, 23552, v12
    v_add_u32 v14, 47104, v12
    v_add_u32 v15, 70656, v12
    s_and_b32 s92, s47, 7
    s_mul_i32 s76, s92, 196608
    s_lshl_b32 s92, s92, 7
    s_lshl_b32 s100, s42, 12
    s_mov_b32 s6, 2097152
    s_mov_b32 s7, 0x20000
    s_mov_b32 s31, 0x20000
    s_mov_b32 s30, 1572864
    s_waitcnt lgkmcnt(0)
    s_mov_b32 s4, s48
    s_mov_b32 s5, s49
    s_mov_b32 s28, s50
    s_mov_b32 s29, s51
    s_mov_b32 m0, s100
    s_nop 0
    buffer_load_dwordx4 v8, s[4:7], s92 offen offset:0 lds
    s_load_dwordx2 s[40:41], s[66:67], 0
    s_mov_b32 s12, s56
    s_mov_b32 s13, s57
    s_mov_b32 s14, 1835008
    s_mov_b32 s15, 0x20000
    buffer_load_dwordx4 v9, s[4:7], s92 offen offset:1024 lds
    s_mov_b32 s20, s52
    s_mov_b32 s21, s53
    s_mov_b32 s22, 524288
    s_mov_b32 s23, 0x20000
    buffer_load_dwordx4 v10, s[4:7], s92 offen offset:2048 lds
    buffer_load_dwordx4 v11, s[4:7], s92 offen offset:3072 lds
    s_mov_b32 s32, s58
    s_mov_b32 s33, s59
    s_mov_b32 s34, 3584
    s_mov_b32 s35, 0x20000
    s_add_u32 m0, s100, 16384
    s_nop 0
    buffer_load_dwordx4 v12, s[28:31], s76 offen offset:0 lds
    s_mov_b32 s16, s60
    s_mov_b32 s17, s61
    s_mov_b32 s18, 1835008
    s_mov_b32 s19, 0x20000
    buffer_load_dwordx4 v13, s[28:31], s76 offen offset:1024 lds
    s_mov_b32 s36, s62
    s_mov_b32 s37, s63
    s_mov_b32 s38, 1024
    s_mov_b32 s39, 0x20000
    buffer_load_dwordx4 v14, s[28:31], s76 offen offset:2048 lds
    s_mov_b32 s24, s66
    s_mov_b32 s25, s67
    s_mov_b32 s26, 16777216
    s_mov_b32 s27, 0x20000
    buffer_load_dwordx4 v15, s[28:31], s76 offen offset:3072 lds
    s_mov_b32 s64, s70
    s_mov_b32 s65, s71
    s_mov_b32 s62, s100
    s_mov_b32 s63, s93
    s_add_u32 s92, s47, 1
    s_and_b32 s92, s92, 7
    s_lshl_b32 s69, s92, 7
    s_mul_i32 s77, s92, 196608
    s_add_u32 s92, s47, 2
    s_and_b32 s92, s92, 7
    s_lshl_b32 s70, s92, 7
    s_mul_i32 s78, s92, 196608
    s_add_u32 s92, s47, 3
    s_and_b32 s92, s92, 7
    s_lshl_b32 s71, s92, 7
    s_mul_i32 s79, s92, 196608
    s_add_u32 s92, s47, 4
    s_and_b32 s92, s92, 7
    s_lshl_b32 s72, s92, 7
    s_mul_i32 s80, s92, 196608
    s_add_u32 s92, s47, 5
    s_and_b32 s92, s92, 7
    s_lshl_b32 s73, s92, 7
    s_mul_i32 s81, s92, 196608
    s_add_u32 s92, s47, 6
    s_and_b32 s92, s92, 7
    s_lshl_b32 s74, s92, 7
    s_mul_i32 s82, s92, 196608
    s_add_u32 s92, s47, 7
    s_and_b32 s92, s92, 7
    s_lshl_b32 s75, s92, 7
    s_mul_i32 s83, s92, 196608
    s_lshl_b32 s44, s3, 1
    s_and_b32 s45, s2, 7
    s_lshl_b32 s45, s45, 2
    s_bfe_u32 s92, s2, 0x10003
    s_add_u32 s45, s45, s92
    s_bfe_u32 s46, s2, 0x20004
    s_lshr_b32 s92, s2, 7
    s_lshl_b32 s92, s92, 2
    s_add_u32 s46, s46, s92
    v_lshlrev_b32 v1, 4, v0
    s_add_u32 m0, s62, 32768
    s_nop 0
    buffer_load_dwordx4 v8, s[4:7], s69 offen offset:0 lds
    v_and_b32 v29, 3, v0
    v_bfe_u32 v30, v0, 2, 2
    v_lshlrev_b32_e64 v30, 6, v30
    v_bfe_u32 v31, v0, 4, 1
    v_lshl_or_b32 v30, v31, 5, v30
    v_lshl_or_b32 v30, v29, 3, v30
    v_lshl_or_b32 v2, v28, 10, v30
    v_lshl_or_b32 v20, v28, 8, v30
    v_mul_u32_u24 v4, 3584, v25
    v_add_u32_e64 v4, v4, v26
    v_add_u32 v5, 27648, v4
    buffer_load_dwordx4 v9, s[4:7], s69 offen offset:1024 lds
    v_add_u32 v6, 55296, v4
    v_add_u32 v7, 82944, v4
    buffer_load_dwordx4 v10, s[4:7], s69 offen offset:2048 lds
    v_lshrrev_b32 v30, 5, v0
    v_lshl_add_u32 v30, v30, 4, v25
    v_and_b32 v31, 3, v0
    v_lshlrev_b32_e64 v31, 4, v31
    v_mul_u32_u24 v30, 3584, v30
    v_add_u32_e64 v124, v30, v31
    v_add_u32 v125, 27648, v124
    v_add_u32 v126, 112640, v124
    buffer_load_dwordx4 v11, s[4:7], s69 offen offset:3072 lds
    v_add_u32 v127, 140288, v124
    s_cmp_lt_u32 s42, 2
    s_cselect_b64 vcc, -1, 0
    v_cndmask_b32 v116, v124, v4, vcc
    v_cndmask_b32 v117, v125, v5, vcc
    v_cndmask_b32 v118, v126, v6, vcc
    v_cndmask_b32 v119, v127, v7, vcc
    s_and_b32 s100, s42, 1
    s_mul_i32 s100, s100, 114688
    s_lshl_b32 s101, s3, 7
    s_add_u32 s100, s100, s101
    s_add_u32 s100, s100, 2048
    s_lshr_b32 s101, s101, 1
    s_add_u32 s101, s101, 3072
    s_cmp_lt_u32 s42, 2
    s_cselect_b32 s93, s100, s101
    s_add_u32 m0, s62, 49152
    s_nop 0
    buffer_load_dwordx4 v12, s[28:31], s77 offen offset:0 lds
    s_lshl_b32 s90, s42, 2
    s_lshr_b32 s92, 0x1000, s90
    s_add_u32 s92, s92, s47
    s_and_b32 s92, s92, 7
    s_mul_i32 s92, s92, 229376
    s_add_u32 s84, s92, s93
    s_lshr_b32 s92, 0x2211, s90
    s_add_u32 s92, s92, s47
    s_and_b32 s92, s92, 7
    s_mul_i32 s92, s92, 229376
    s_add_u32 s85, s92, s100
    s_lshr_b32 s92, 0x4433, s90
    s_add_u32 s92, s92, s47
    s_and_b32 s92, s92, 7
    s_mul_i32 s92, s92, 229376
    s_add_u32 s86, s92, s100
    buffer_load_dwordx4 v13, s[28:31], s77 offen offset:1024 lds
    s_lshr_b32 s92, 0x6655, s90
    s_add_u32 s92, s92, s47
    s_and_b32 s92, s92, 7
    s_mul_i32 s92, s92, 229376
    s_add_u32 s87, s92, s100
    s_lshr_b32 s92, 0x3277, s90
    s_add_u32 s92, s92, s47
    s_and_b32 s92, s92, 7
    s_mul_i32 s92, s92, 229376
    s_add_u32 s88, s92, s93
    buffer_load_dwordx4 v14, s[28:31], s77 offen offset:2048 lds
    s_lshr_b32 s92, 0x7654, s90
    s_add_u32 s92, s92, s47
    s_and_b32 s92, s92, 7
    s_mul_i32 s92, s92, 229376
    s_add_u32 s89, s92, s101
    v_bfe_u32 v49, v0, 4, 1
    v_bfe_u32 v50, v0, 2, 1
    v_cmp_eq_u32 vcc, v49, v50
    v_mov_b32 v49, 0x3f803f80
    s_nop 0
    v_cndmask_b32 v48, 0, v49, vcc
    v_mov_b32 v49, v48
    v_mov_b32 v50, v48
    v_mov_b32 v51, v48
    buffer_load_dwordx4 v15, s[28:31], s77 offen offset:3072 lds
    s_lshr_b32 s90, s42, 1
    s_lshl_b32 s90, s90, 13
    s_and_b32 s92, s42, 1
    s_lshl_b32 s92, s92, 9
    s_add_u32 s90, s90, s92
    v_add_u32 v52, s90, v2
    s_mov_b32 s90, 0x18000
    s_cmp_eq_u32 s42, 1
    s_cselect_b32 s90, 0x18200, s90
    s_cmp_eq_u32 s42, 2
    s_cselect_b32 s90, 0x1a000, s90
    v_add_u32 v53, s90, v2
    s_movk_i32 s90, 2048
    s_cmp_eq_u32 s42, 2
    s_cselect_b32 s90, 512, s90
    s_cselect_b32 s92, 0, 1
    s_lshl_b32 s92, 2048, s92
    v_add_u32 v54, s90, v53
    v_add_u32 v55, s92, v53
    v_add_u32 v56, s92, v54
    s_lshl_b32 s90, s64, 4
    s_add_u32 s90, s90, s44
    s_lshl_b32 s90, s90, 14
    s_lshl_b32 s92, s42, 9
    s_add_u32 s90, s90, s92
    s_add_u32 s100, s90, 65536
    s_lshl_b32 s90, s65, 11
    s_add_u32 s101, s100, s90
    v_and_b32 v123, 31, v0
    v_lshlrev_b32 v120, 4, v123
    v_lshrrev_b32_e64 v121, 5, v0
    v_lshl_or_b32 v121, v121, 12, v120
    v_add_u32 v122, 8192, v121
    v_lshlrev_b32 v123, 1, v123
    s_lshl_b32 s90, s42, 9
    s_add_u32 s90, s90, 147456
    v_add_u32_e64 v120, s90, v120
    v_lshrrev_b32_e64 v59, 5, v0
    v_lshl_add_u32 v59, v59, 11, v120
    s_mov_b32 s96, 0
    s_mov_b32 s97, -1
    s_lshl_b32 s90, s3, 7
    s_lshl_b32 s92, s42, 6
    s_add_u32 s92, s90, s92
    s_add_u32 s92, s92, 2048
    s_lshr_b32 s90, s90, 1
    s_add_u32 s90, s90, 3072
    s_cmp_lt_u32 s42, 2
    s_cselect_b32 s90, s92, s90
    buffer_load_ushort v60, v123, s[32:35], s90 offen
    s_waitcnt lgkmcnt(0)
    s_mul_i32 s40, s40, 1664525
    s_add_u32 s40, s40, 1013904223
    s_mul_i32 s41, s41, 22695477
    s_add_u32 s41, s41, 1
    v_lshlrev_b32 v31, 10, v25
    v_add_u32 v31, v31, v26
    s_lshl_b32 s90, s46, 7
    v_add_u32 v16, s90, v31
    v_add_u32 v17, 7168, v16
    v_add_u32 v18, 14336, v16
    v_add_u32 v19, 21504, v16
    s_lshr_b32 s64, s46, 0
    s_mul_i32 s64, s64, 1
    s_lshr_b32 s92, s45, 2
    s_mul_i32 s92, s92, 2
    s_add_u32 s64, s64, s92
    s_lshl_b32 s65, s42, 3
    s_add_u32 s92, s64, 0
    s_and_b32 s92, s92, 7
    s_add_u32 s92, s92, s65
    s_lshl_b32 s48, s92, 11
    s_add_u32 s92, s64, 1
    s_and_b32 s92, s92, 7
    s_add_u32 s92, s92, s65
    s_lshl_b32 s49, s92, 11
    s_add_u32 s92, s64, 2
    s_and_b32 s92, s92, 7
    s_add_u32 s92, s92, s65
    s_lshl_b32 s50, s92, 11
    v_and_b32 v26, 3, v0
    v_lshlrev_b32 v26, 2, v26
    v_add_u32 v26, 152576, v26
    s_lshl_b32 s92, s42, 2
    s_add_u32 s92, s92, 152576
    v_mov_b32 v27, s92
    v_mov_b32_e64 v28, 0
    ds_write_b32 v27, v28
    s_waitcnt vmcnt(9) lgkmcnt(0)
    s_barrier
    ds_read_b64_tr_b16 v[32:33], v52 offset:16384
    ds_read_b64_tr_b16 v[34:35], v52 offset:16640
    ds_read_b64_tr_b16 v[36:37], v52 offset:18432
    ds_read_b64_tr_b16 v[38:39], v52 offset:18688
    ds_read_b64_tr_b16 v[40:41], v52 offset:20480
    ds_read_b64_tr_b16 v[42:43], v52 offset:20736
    ds_read_b64_tr_b16 v[44:45], v52 offset:22528
    ds_read_b64_tr_b16 v[46:47], v52 offset:22784
    s_add_u32 m0, s62, 98304
    s_nop 0
    buffer_load_dwordx4 v116, s[12:15], s84 offen offset:0 lds
    buffer_load_dwordx4 v117, s[12:15], s84 offen offset:1024 lds
    buffer_load_dwordx4 v118, s[12:15], s84 offen offset:2048 lds
    buffer_load_dwordx4 v119, s[12:15], s84 offen offset:3072 lds
    s_add_u32 m0, s62, 65536
    s_nop 0
    buffer_load_dwordx4 v8, s[4:7], s70 offen offset:0 lds
    s_waitcnt lgkmcnt(0)
    s_setprio 2
    v_mfma_f32_16x16x32_bf16 v[64:67], v[48:51], v[32:35], 0
    v_mfma_f32_16x16x32_bf16 v[64:67], v[48:51], v[36:39], v[64:67]
    v_mfma_f32_16x16x32_bf16 v[64:67], v[48:51], v[40:43], v[64:67]
    v_mfma_f32_16x16x32_bf16 v[64:67], v[48:51], v[44:47], v[64:67]
    s_setprio 0
    buffer_load_dwordx4 v9, s[4:7], s70 offen offset:1024 lds
    buffer_load_dwordx4 v10, s[4:7], s70 offen offset:2048 lds
    buffer_load_dwordx4 v11, s[4:7], s70 offen offset:3072 lds
    s_add_u32 m0, s62, 81920
    s_nop 0
    buffer_load_dwordx4 v12, s[28:31], s78 offen offset:0 lds
    buffer_load_dwordx4 v13, s[28:31], s78 offen offset:1024 lds
    buffer_load_dwordx4 v14, s[28:31], s78 offen offset:2048 lds
    buffer_load_dwordx4 v15, s[28:31], s78 offen offset:3072 lds
    s_waitcnt vmcnt(8)
    s_barrier
    ds_read_b64_tr_b16 v[32:33], v53 offset:0
    ds_read_b64_tr_b16 v[34:35], v53 offset:256
    ds_read_b64_tr_b16 v[36:37], v54 offset:0
    ds_read_b64_tr_b16 v[38:39], v54 offset:256
    ds_read_b64_tr_b16 v[40:41], v55 offset:0
    ds_read_b64_tr_b16 v[42:43], v55 offset:256
    ds_read_b64_tr_b16 v[44:45], v56 offset:0
    ds_read_b64_tr_b16 v[46:47], v56 offset:256
    s_add_u32 m0, s62, 0
    s_nop 0
    buffer_load_dwordx4 v8, s[4:7], s71 offen offset:0 lds
    buffer_load_dwordx4 v9, s[4:7], s71 offen offset:1024 lds
    buffer_load_dwordx4 v10, s[4:7], s71 offen offset:2048 lds
    s_waitcnt lgkmcnt(0)
    s_setprio 2
    v_mfma_f32_16x16x32_bf16 v[80:83], v[48:51], v[32:35], 0
    v_mfma_f32_16x16x32_bf16 v[80:83], v[48:51], v[36:39], v[80:83]
    v_mfma_f32_16x16x32_bf16 v[80:83], v[48:51], v[40:43], v[80:83]
    v_mfma_f32_16x16x32_bf16 v[80:83], v[48:51], v[44:47], v[80:83]
    s_setprio 0
    buffer_load_dwordx4 v11, s[4:7], s71 offen offset:3072 lds
    s_add_u32 m0, s62, 16384
    s_nop 0
    buffer_load_dwordx4 v12, s[28:31], s79 offen offset:0 lds
    buffer_load_dwordx4 v13, s[28:31], s79 offen offset:1024 lds
    buffer_load_dwordx4 v14, s[28:31], s79 offen offset:2048 lds
    buffer_load_dwordx4 v15, s[28:31], s79 offen offset:3072 lds
    s_waitcnt vmcnt(8)
    s_barrier
    s_add_u32 m0, s62, 32768
    s_nop 0
    buffer_load_dwordx4 v8, s[4:7], s72 offen offset:0 lds
    v_mov_b32 v66, s40
    v_mov_b32_e64 v67, s41
    v_mov_b32_e64 v65, v80
    buffer_load_dwordx4 v9, s[4:7], s72 offen offset:1024 lds
    s_mov_b32 exec_hi, 0
    buffer_store_dwordx4 v[64:67], v1, s[24:27], s101 offen sc1
    s_mov_b32 exec_hi, -1
    buffer_load_dwordx4 v10, s[4:7], s72 offen offset:2048 lds
    buffer_load_dwordx4 v11, s[4:7], s72 offen offset:3072 lds
    s_add_u32 m0, s62, 49152
    s_nop 0
    buffer_load_dwordx4 v12, s[28:31], s80 offen offset:0 lds
    buffer_load_dwordx4 v13, s[28:31], s80 offen offset:1024 lds
    buffer_load_dwordx4 v14, s[28:31], s80 offen offset:2048 lds
    buffer_load_dwordx4 v15, s[28:31], s80 offen offset:3072 lds
    s_waitcnt vmcnt(9)
    s_barrier
    s_add_u32 m0, s62, 65536
    s_nop 0
    buffer_load_dwordx4 v8, s[4:7], s73 offen offset:0 lds
    buffer_load_dwordx4 v9, s[4:7], s73 offen offset:1024 lds
    buffer_load_dwordx4 v10, s[4:7], s73 offen offset:2048 lds
    buffer_load_dwordx4 v11, s[4:7], s73 offen offset:3072 lds
    s_add_u32 m0, s62, 81920
    s_nop 0
    buffer_load_dwordx4 v12, s[28:31], s81 offen offset:0 lds
    buffer_load_dwordx4 v13, s[28:31], s81 offen offset:1024 lds
    buffer_load_dwordx4 v14, s[28:31], s81 offen offset:2048 lds
    buffer_load_dwordx4 v15, s[28:31], s81 offen offset:3072 lds
    s_waitcnt vmcnt(8)
    s_barrier
    s_add_u32 m0, s62, 0
    s_nop 0
    buffer_load_dwordx4 v8, s[4:7], s74 offen offset:0 lds
    buffer_load_dwordx4 v9, s[4:7], s74 offen offset:1024 lds
    buffer_load_dwordx4 v10, s[4:7], s74 offen offset:2048 lds
    buffer_load_dwordx4 v11, s[4:7], s74 offen offset:3072 lds
    s_add_u32 m0, s62, 16384
    s_nop 0
    buffer_load_dwordx4 v12, s[28:31], s82 offen offset:0 lds
    buffer_load_dwordx4 v[96:99], v121, s[24:27], s100 offen offset:0 sc1
    buffer_load_dwordx4 v13, s[28:31], s82 offen offset:1024 lds
    buffer_load_dwordx4 v[100:103], v121, s[24:27], s100 offen offset:2048 sc1
    buffer_load_dwordx4 v14, s[28:31], s82 offen offset:2048 lds
    buffer_load_dwordx4 v[104:107], v122, s[24:27], s100 offen offset:0 sc1
    buffer_load_dwordx4 v15, s[28:31], s82 offen offset:3072 lds
    buffer_load_dwordx4 v[108:111], v122, s[24:27], s100 offen offset:2048 sc1
    s_waitcnt vmcnt(12)
    s_barrier
    s_add_u32 m0, s62, 32768
    s_nop 0
    buffer_load_dwordx4 v8, s[4:7], s75 offen offset:0 lds
    buffer_load_dwordx4 v9, s[4:7], s75 offen offset:1024 lds
    buffer_load_dwordx4 v10, s[4:7], s75 offen offset:2048 lds
    buffer_load_dwordx4 v11, s[4:7], s75 offen offset:3072 lds
    s_add_u32 m0, s62, 49152
    s_nop 0
    buffer_load_dwordx4 v12, s[28:31], s83 offen offset:0 lds
    buffer_load_dwordx4 v13, s[28:31], s83 offen offset:1024 lds
    buffer_load_dwordx4 v14, s[28:31], s83 offen offset:2048 lds
    buffer_load_dwordx4 v15, s[28:31], s83 offen offset:3072 lds
    s_waitcnt vmcnt(9)
    s_barrier
    s_add_u32 m0, s62, 114688
    s_nop 0
    buffer_load_dwordx4 v4, s[12:15], s85 offen offset:0 lds
    buffer_load_dwordx4 v5, s[12:15], s85 offen offset:1024 lds
    buffer_load_dwordx4 v6, s[12:15], s85 offen offset:2048 lds
    buffer_load_dwordx4 v7, s[12:15], s85 offen offset:3072 lds
    v_xor_b32 v98, s40, v98
    v_xor_b32 v99, s41, v99
    v_xor_b32 v102, s40, v102
    v_xor_b32 v103, s41, v103
    v_xor_b32 v106, s40, v106
    v_xor_b32 v107, s41, v107
    s_waitcnt vmcnt(12)
    v_xor_b32 v110, s40, v110
    v_xor_b32 v111, s41, v111
    v_or_b32 v98, v98, v99
    v_or3_b32 v98, v98, v102, v103
    v_or3_b32 v98, v98, v106, v107
    v_or3_b32 v98, v98, v110, v111
    v_cmp_ne_u32 vcc, 0, v98
    s_nop 1
    s_cbranch_vccnz L_slow_eg1
L_ret_eg2:
    s_add_u32 m0, s62, 131072
    s_nop 0
    buffer_load_dwordx4 v4, s[12:15], s86 offen offset:0 lds
    v_add_f32 v36, v96, v100
    v_add_f32 v37, v104, v108
    v_add_f32 v44, v97, v101
    v_add_f32 v45, v105, v109
    v_add_f32 v36, v36, v37
    buffer_load_dwordx4 v5, s[12:15], s86 offen offset:1024 lds
    v_mov_b32 v35, 0
    v_add_f32 v44, v44, v45
    v_mov_b32 v43, 0
    v_mov_b32 v37, v36
    v_mov_b32 v32, 0
    v_mov_b32_e64 v45, v44
    v_lshl_or_b32 v40, v60, 16, v60
    v_permlane32_swap_b32 v36, v37
    buffer_load_dwordx4 v6, s[12:15], s86 offen offset:2048 lds
    v_permlane32_swap_b32 v44, v45
    v_add_f32 v36, v36, v37
    v_add_f32_e64 v44, v44, v45
    v_cvt_pk_bf16_f32 v34, v36, v35
    v_cvt_pk_bf16_f32 v42, v44, v43
    v_lshlrev_b32 v37, 16, v34
    v_lshlrev_b32 v45, 16, v42
    buffer_load_dwordx4 v7, s[12:15], s86 offen offset:3072 lds
    v_sub_f32 v37, v36, v37
    v_sub_f32 v45, v44, v45
    v_cvt_pk_bf16_f32 v33, v36, v37
    v_cvt_pk_bf16_f32 v41, v44, v45
    v_cndmask_b32 v32, v32, v40, s[96:97]
    v_cndmask_b32 v33, v33, v41, s[96:97]
    v_cndmask_b32 v34, v34, v42, s[96:97]
    ds_write_b128 v59, v[32:35]
    s_waitcnt vmcnt(8)
    s_barrier
    s_add_u32 m0, s62, 65536
    s_nop 0
    buffer_load_dwordx4 v4, s[12:15], s87 offen offset:0 lds
    buffer_load_dwordx4 v5, s[12:15], s87 offen offset:1024 lds
    buffer_load_dwordx4 v6, s[12:15], s87 offen offset:2048 lds
    buffer_load_dwordx4 v7, s[12:15], s87 offen offset:3072 lds
    s_add_u32 m0, s62, 81920
    s_nop 0
    buffer_load_dwordx4 v116, s[12:15], s88 offen offset:0 lds
    buffer_load_dwordx4 v117, s[12:15], s88 offen offset:1024 lds
    buffer_load_dwordx4 v118, s[12:15], s88 offen offset:2048 lds
    buffer_load_dwordx4 v119, s[12:15], s88 offen offset:3072 lds
    s_waitcnt lgkmcnt(0)
    s_barrier
    s_add_u32 m0, s62, 49152
    s_nop 0
    buffer_load_dwordx4 v124, s[12:15], s89 offen offset:0 lds
    s_and_b32 s90, s42, 1
    s_lshl_b32 s90, s90, 9
    s_add_u32 s90, s90, s62
    v_add_u32_e64 v20, s90, v20
    v_xor_b32 v21, 512, v20
    buffer_load_dwordx4 v125, s[12:15], s89 offen offset:1024 lds
    s_mul_i32 s92, s45, 229376
    s_add_u32 s92, s92, 4194304
    v_add_u32 v23, s92, v1
    s_lshr_b32 s90, s42, 1
    s_mul_i32 s90, s90, 114688
    v_add_u32 v22, s90, v23
    s_sub_u32 s90, 114688, s90
    v_add_u32 v23, s90, v23
    buffer_load_dwordx4 v126, s[12:15], s89 offen offset:2048 lds
    v_and_b32 v30, 1, v0
    v_lshlrev_b32 v30, 8, v30
    v_bfe_u32 v31, v0, 1, 1
    v_lshl_or_b32 v30, v31, 11, v30
    s_lshl_b32 s90, s42, 9
    s_lshl_b32 s92, s45, 12
    s_add_u32 s90, s90, s92
    s_add_u32 s90, s90, 589824
    v_add_u32 v24, s90, v30
    s_mov_b32 s94, 0xffff0000
    s_mov_b32 s95, 0xffff0000
    s_mov_b32 s96, 0
    s_mov_b32 s97, -1
    buffer_load_dwordx4 v127, s[12:15], s89 offen offset:3072 lds
    s_add_u32 s92, s64, 3
    s_and_b32 s92, s92, 7
    s_add_u32 s92, s92, s65
    s_lshl_b32 s51, s92, 11
    s_add_u32 s92, s64, 4
    s_and_b32 s92, s92, 7
    s_add_u32 s92, s92, s65
    s_lshl_b32 s52, s92, 11
    s_lshl_b32 s91, s48, 4
    s_add_u32 m0, s62, 0
    s_nop 0
    buffer_load_dwordx4 v16, s[16:19], s91 offen offset:0 lds
    s_add_u32 s92, s64, 5
    s_and_b32 s92, s92, 7
    s_add_u32 s92, s92, s65
    s_lshl_b32 s53, s92, 11
    s_add_u32 s92, s64, 6
    s_and_b32 s92, s92, 7
    s_add_u32 s92, s92, s65
    s_lshl_b32 s54, s92, 11
    buffer_load_dwordx4 v17, s[16:19], s91 offen offset:1024 lds
    s_add_u32 s92, s64, 7
    s_and_b32 s92, s92, 7
    s_add_u32 s92, s92, s65
    s_lshl_b32 s55, s92, 11
    s_mul_i32 s92, s64, 43
    s_lshr_b32 s92, s92, 8
    s_mul_i32 s92, s92, 6
    s_sub_u32 s64, s64, s92
    s_lshl_b32 s100, s42, 2
    s_add_u32 s100, s100, 32
    s_lshl_b32 s101, s42, 1
    s_add_u32 s101, s101, 44
    buffer_load_dwordx4 v18, s[16:19], s91 offen offset:2048 lds
    s_add_u32 s92, s64, 0
    s_cmp_ge_u32 s92, 6
    s_cselect_b32 s56, 6, 0
    s_sub_u32 s92, s92, s56
    s_cmp_lt_u32 s92, 4
    s_cselect_b32 s56, s100, s101
    s_add_u32 s92, s92, s56
    s_lshl_b32 s56, s92, 11
    buffer_load_dwordx4 v19, s[16:19], s91 offen offset:3072 lds
    s_add_u32 s92, s64, 1
    s_cmp_ge_u32 s92, 6
    s_cselect_b32 s57, 6, 0
    s_sub_u32 s92, s92, s57
    s_cmp_lt_u32 s92, 4
    s_cselect_b32 s57, s100, s101
    s_add_u32 s92, s92, s57
    s_lshl_b32 s57, s92, 11
    s_lshl_b32 s91, s49, 4
    s_add_u32 m0, s62, 16384
    s_nop 0
    buffer_load_dwordx4 v16, s[16:19], s91 offen offset:0 lds
    s_add_u32 s92, s64, 2
    s_cmp_ge_u32 s92, 6
    s_cselect_b32 s58, 6, 0
    s_sub_u32 s92, s92, s58
    s_cmp_lt_u32 s92, 4
    s_cselect_b32 s58, s100, s101
    s_add_u32 s92, s92, s58
    s_lshl_b32 s58, s92, 11
    buffer_load_dwordx4 v17, s[16:19], s91 offen offset:1024 lds
    s_add_u32 s92, s64, 3
    s_cmp_ge_u32 s92, 6
    s_cselect_b32 s59, 6, 0
    s_sub_u32 s92, s92, s59
    s_cmp_lt_u32 s92, 4
    s_cselect_b32 s59, s100, s101
    s_add_u32 s92, s92, s59
    s_lshl_b32 s59, s92, 11
    buffer_load_dwordx4 v18, s[16:19], s91 offen offset:2048 lds
    s_add_u32 s92, s64, 4
    s_cmp_ge_u32 s92, 6
    s_cselect_b32 s60, 6, 0
    s_sub_u32 s92, s92, s60
    s_cmp_lt_u32 s92, 4
    s_cselect_b32 s60, s100, s101
    s_add_u32 s92, s92, s60
    s_lshl_b32 s60, s92, 11
    buffer_load_dwordx4 v19, s[16:19], s91 offen offset:3072 lds
    s_add_u32 s92, s64, 5
    s_cmp_ge_u32 s92, 6
    s_cselect_b32 s61, 6, 0
    s_sub_u32 s92, s92, s61
    s_cmp_lt_u32 s92, 4
    s_cselect_b32 s61, s100, s101
    s_add_u32 s92, s92, s61
    s_lshl_b32 s61, s92, 11
    s_waitcnt vmcnt(4)
    ds_read_b64_tr_b16 a[0:1], v20 offset:0
    ds_read_b64_tr_b16 a[2:3], v20 offset:1024
    ds_read_b64_tr_b16 a[4:5], v21 offset:0
    ds_read_b64_tr_b16 a[6:7], v21 offset:1024
    ds_read_b64_tr_b16 a[8:9], v20 offset:2048
    ds_read_b64_tr_b16 a[10:11], v20 offset:3072
    ds_read_b64_tr_b16 a[12:13], v21 offset:2048
    ds_read_b64_tr_b16 a[14:15], v21 offset:3072
    v_mov_b32_e64 v28, 2
    ds_write_b32 v27, v28
    s_waitcnt lgkmcnt(1)
    s_lshl_b32 s91, s50, 4
    s_add_u32 m0, s62, 0
    s_nop 0
    buffer_load_dwordx4 v16, s[16:19], s91 offen offset:0 lds
    buffer_load_dwordx4 v17, s[16:19], s91 offen offset:1024 lds
    buffer_load_dwordx4 v18, s[16:19], s91 offen offset:2048 lds
    buffer_load_dwordx4 v19, s[16:19], s91 offen offset:3072 lds
    s_waitcnt vmcnt(4)
    ds_read_b64_tr_b16 a[16:17], v20 offset:16384
    ds_read_b64_tr_b16 a[18:19], v20 offset:17408
    ds_read_b64_tr_b16 a[20:21], v21 offset:16384
    ds_read_b64_tr_b16 a[22:23], v21 offset:17408
    ds_read_b64_tr_b16 a[24:25], v20 offset:18432
    ds_read_b64_tr_b16 a[26:27], v20 offset:19456
    ds_read_b64_tr_b16 a[28:29], v21 offset:18432
    ds_read_b64_tr_b16 a[30:31], v21 offset:19456
    s_waitcnt lgkmcnt(0)
    s_lshl_b32 s91, s51, 4
    s_add_u32 m0, s62, 16384
    s_nop 0
    buffer_load_dwordx4 v16, s[16:19], s91 offen offset:0 lds
    buffer_load_dwordx4 v17, s[16:19], s91 offen offset:1024 lds
    buffer_load_dwordx4 v18, s[16:19], s91 offen offset:2048 lds
    buffer_load_dwordx4 v19, s[16:19], s91 offen offset:3072 lds
    ds_read_b32 v30, v26 offset:16
    s_waitcnt lgkmcnt(0)
    v_cmp_gt_u32 vcc, 2, v30
    s_nop 1
    s_cbranch_vccnz L_lslow3
L_lret4:
    s_lshl_b32 s91, s52, 4
    s_add_u32 m0, s62, 32768
    s_nop 0
    buffer_load_dwordx4 v16, s[16:19], s91 offen offset:0 lds
    buffer_load_dwordx4 v17, s[16:19], s91 offen offset:1024 lds
    buffer_load_dwordx4 v18, s[16:19], s91 offen offset:2048 lds
    buffer_load_dwordx4 v19, s[16:19], s91 offen offset:3072 lds
    s_waitcnt vmcnt(8)
    ds_read_b64_tr_b16 a[32:33], v20 offset:0
    ds_read_b64_tr_b16 a[34:35], v20 offset:1024
    ds_read_b64_tr_b16 a[36:37], v21 offset:0
    ds_read_b64_tr_b16 a[38:39], v21 offset:1024
    ds_read_b64_tr_b16 a[40:41], v20 offset:2048
    ds_read_b64_tr_b16 a[42:43], v20 offset:3072
    ds_read_b64_tr_b16 a[44:45], v21 offset:2048
    ds_read_b64_tr_b16 a[46:47], v21 offset:3072
    s_waitcnt lgkmcnt(0)
    s_lshl_b32 s91, s53, 4
    s_add_u32 m0, s62, 0
    s_nop 0
    buffer_load_dwordx4 v16, s[16:19], s91 offen offset:0 lds
    buffer_load_dwordx4 v17, s[16:19], s91 offen offset:1024 lds
    buffer_load_dwordx4 v18, s[16:19], s91 offen offset:2048 lds
    buffer_load_dwordx4 v19, s[16:19], s91 offen offset:3072 lds
    s_waitcnt vmcnt(8)
    ds_read_b64_tr_b16 a[48:49], v20 offset:16384
    ds_read_b64_tr_b16 a[50:51], v20 offset:17408
    ds_read_b64_tr_b16 a[52:53], v21 offset:16384
    ds_read_b64_tr_b16 a[54:55], v21 offset:17408
    ds_read_b64_tr_b16 a[56:57], v20 offset:18432
    ds_read_b64_tr_b16 a[58:59], v20 offset:19456
    ds_read_b64_tr_b16 a[60:61], v21 offset:18432
    ds_read_b64_tr_b16 a[62:63], v21 offset:19456
    s_waitcnt lgkmcnt(0)
    s_lshl_b32 s91, s54, 4
    s_add_u32 m0, s62, 16384
    s_nop 0
    buffer_load_dwordx4 v16, s[16:19], s91 offen offset:0 lds
    buffer_load_dwordx4 v17, s[16:19], s91 offen offset:1024 lds
    buffer_load_dwordx4 v18, s[16:19], s91 offen offset:2048 lds
    buffer_load_dwordx4 v19, s[16:19], s91 offen offset:3072 lds
    s_waitcnt vmcnt(8)
    ds_read_b64_tr_b16 a[64:65], v20 offset:32768
    ds_read_b64_tr_b16 a[66:67], v20 offset:33792
    ds_read_b64_tr_b16 a[68:69], v21 offset:32768
    ds_read_b64_tr_b16 a[70:71], v21 offset:33792
    ds_read_b64_tr_b16 a[72:73], v20 offset:34816
    ds_read_b64_tr_b16 a[74:75], v20 offset:35840
    ds_read_b64_tr_b16 a[76:77], v21 offset:34816
    ds_read_b64_tr_b16 a[78:79], v21 offset:35840
    s_waitcnt lgkmcnt(0)
    s_lshl_b32 s91, s55, 4
    s_add_u32 m0, s62, 32768
    s_nop 0
    buffer_load_dwordx4 v16, s[16:19], s91 offen offset:0 lds
    buffer_load_dwordx4 v17, s[16:19], s91 offen offset:1024 lds
    buffer_load_dwordx4 v18, s[16:19], s91 offen offset:2048 lds
    buffer_load_dwordx4 v19, s[16:19], s91 offen offset:3072 lds
    s_waitcnt vmcnt(8)
    ds_read_b64_tr_b16 a[80:81], v20 offset:0
    ds_read_b64_tr_b16 a[82:83], v20 offset:1024
    ds_read_b64_tr_b16 a[84:85], v21 offset:0
    ds_read_b64_tr_b16 a[86:87], v21 offset:1024
    ds_read_b64_tr_b16 a[88:89], v20 offset:2048
    ds_read_b64_tr_b16 a[90:91], v20 offset:3072
    ds_read_b64_tr_b16 a[92:93], v21 offset:2048
    ds_read_b64_tr_b16 a[94:95], v21 offset:3072
    s_waitcnt lgkmcnt(0)
    s_lshl_b32 s91, s56, 4
    s_add_u32 m0, s62, 0
    s_nop 0
    buffer_load_dwordx4 v16, s[16:19], s91 offen offset:0 lds
    buffer_load_dwordx4 v17, s[16:19], s91 offen offset:1024 lds
    buffer_load_dwordx4 v18, s[16:19], s91 offen offset:2048 lds
    buffer_load_dwordx4 v19, s[16:19], s91 offen offset:3072 lds
    s_waitcnt vmcnt(8)
    ds_read_b64_tr_b16 a[96:97], v20 offset:16384
    ds_read_b64_tr_b16 a[98:99], v20 offset:17408
    ds_read_b64_tr_b16 a[100:101], v21 offset:16384
    ds_read_b64_tr_b16 a[102:103], v21 offset:17408
    ds_read_b64_tr_b16 a[104:105], v20 offset:18432
    ds_read_b64_tr_b16 a[106:107], v20 offset:19456
    ds_read_b64_tr_b16 a[108:109], v21 offset:18432
    ds_read_b64_tr_b16 a[110:111], v21 offset:19456
    s_waitcnt lgkmcnt(0)
    s_lshl_b32 s91, s57, 4
    s_add_u32 m0, s62, 16384
    s_nop 0
    buffer_load_dwordx4 v16, s[16:19], s91 offen offset:0 lds
    buffer_load_dwordx4 v17, s[16:19], s91 offen offset:1024 lds
    buffer_load_dwordx4 v18, s[16:19], s91 offen offset:2048 lds
    buffer_load_dwordx4 v19, s[16:19], s91 offen offset:3072 lds
    s_waitcnt vmcnt(8)
    ds_read_b64_tr_b16 a[112:113], v20 offset:32768
    ds_read_b64_tr_b16 a[114:115], v20 offset:33792
    ds_read_b64_tr_b16 a[116:117], v21 offset:32768
    ds_read_b64_tr_b16 a[118:119], v21 offset:33792
    ds_read_b64_tr_b16 a[120:121], v20 offset:34816
    ds_read_b64_tr_b16 a[122:123], v20 offset:35840
    ds_read_b64_tr_b16 a[124:125], v21 offset:34816
    ds_read_b64_tr_b16 a[126:127], v21 offset:35840
    s_waitcnt lgkmcnt(0)
    s_lshl_b32 s91, s58, 4
    s_add_u32 m0, s62, 32768
    s_nop 0
    buffer_load_dwordx4 v16, s[16:19], s91 offen offset:0 lds
    buffer_load_dwordx4 v17, s[16:19], s91 offen offset:1024 lds
    buffer_load_dwordx4 v18, s[16:19], s91 offen offset:2048 lds
    buffer_load_dwordx4 v19, s[16:19], s91 offen offset:3072 lds
    s_lshl_b32 s76, s42, 9
    s_lshl_b32 s92, s45, 12
    s_add_u32 s76, s76, s92
    s_add_u32 s76, s76, 589824
    ds_read_b32 v30, v26 offset:16
    s_waitcnt lgkmcnt(0)
    v_cmp_gt_u32 vcc, 3, v30
    s_nop 1
    s_cbranch_vccnz L_lslow9
L_lret10:
    s_lshl_b32 s92, s42, 3
    s_lshr_b32 s92, 0x1d1c1918, s92
    s_and_b32 s92, s92, 0xff
    s_mul_i32 s90, s46, 1
    s_add_u32 s90, s90, s42
    s_add_u32 s90, s90, 0
    s_and_b32 s90, s90, 7
    s_add_u32 s90, s90, 0
    s_lshl_b32 s90, s90, 15
    s_lshl_b32 m0, s92, 12
    s_nop 0
    buffer_load_dwordx4 v16, s[20:23], s90 offen offset:0 lds
    buffer_load_dwordx4 v17, s[20:23], s90 offen offset:1024 lds
    buffer_load_dwordx4 v18, s[20:23], s90 offen offset:2048 lds
    buffer_load_dwordx4 v19, s[20:23], s90 offen offset:3072 lds
    s_lshl_b32 s92, s42, 3
    s_lshr_b32 s92, 0x21201f1e, s92
    s_and_b32 s92, s92, 0xff
    s_mul_i32 s90, s46, 1
    s_add_u32 s90, s90, s42
    s_add_u32 s90, s90, 4
    s_and_b32 s90, s90, 7
    s_add_u32 s90, s90, 0
    s_lshl_b32 s90, s90, 15
    s_lshl_b32 m0, s92, 12
    s_nop 0
    buffer_load_dwordx4 v16, s[20:23], s90 offen offset:0 lds
    buffer_load_dwordx4 v17, s[20:23], s90 offen offset:1024 lds
    buffer_load_dwordx4 v18, s[20:23], s90 offen offset:2048 lds
    buffer_load_dwordx4 v19, s[20:23], s90 offen offset:3072 lds
    ds_read_b32 v30, v26 offset:16
    s_waitcnt lgkmcnt(0)
    v_cmp_gt_u32 vcc, 4, v30
    s_nop 1
    s_cbranch_vccnz L_lslow11
L_lret12:
    s_lshl_b32 s92, s42, 3
    s_lshr_b32 s92, 0x11102322, s92
    s_and_b32 s92, s92, 0xff
    s_mul_i32 s90, s46, 1
    s_add_u32 s90, s90, s42
    s_add_u32 s90, s90, 0
    s_and_b32 s90, s90, 7
    s_add_u32 s90, s90, 8
    s_lshl_b32 s90, s90, 15
    s_lshl_b32 m0, s92, 12
    s_nop 0
    buffer_load_dwordx4 v16, s[20:23], s90 offen offset:0 lds
    buffer_load_dwordx4 v17, s[20:23], s90 offen offset:1024 lds
    buffer_load_dwordx4 v18, s[20:23], s90 offen offset:2048 lds
    buffer_load_dwordx4 v19, s[20:23], s90 offen offset:3072 lds
    s_lshl_b32 s92, s42, 3
    s_lshr_b32 s92, 0x15141312, s92
    s_and_b32 s92, s92, 0xff
    s_mul_i32 s90, s46, 1
    s_add_u32 s90, s90, s42
    s_add_u32 s90, s90, 4
    s_and_b32 s90, s90, 7
    s_add_u32 s90, s90, 8
    s_lshl_b32 s90, s90, 15
    s_lshl_b32 m0, s92, 12
    s_nop 0
    buffer_load_dwordx4 v16, s[20:23], s90 offen offset:0 lds
    buffer_load_dwordx4 v17, s[20:23], s90 offen offset:1024 lds
    buffer_load_dwordx4 v18, s[20:23], s90 offen offset:2048 lds
    buffer_load_dwordx4 v19, s[20:23], s90 offen offset:3072 lds
    s_buffer_load_dwordx2 s[68:69], s[24:27], s76 offset:128 glc
    s_buffer_load_dwordx2 s[70:71], s[24:27], s76 offset:384 glc
    s_buffer_load_dwordx2 s[72:73], s[24:27], s76 offset:2176 glc
    s_buffer_load_dwordx2 s[74:75], s[24:27], s76 offset:2432 glc
    s_waitcnt lgkmcnt(0)
    s_xor_b64 s[68:69], s[68:69], s[40:41]
    s_xor_b64 s[70:71], s[70:71], s[40:41]
    s_xor_b64 s[72:73], s[72:73], s[40:41]
    s_xor_b64 s[74:75], s[74:75], s[40:41]
    s_or_b64 s[68:69], s[68:69], s[70:71]
    s_or_b64 s[68:69], s[68:69], s[72:73]
    s_or_b64 s[68:69], s[68:69], s[74:75]
    s_cbranch_scc1 L_slow_h5
L_ret_h6:
    buffer_load_dwordx4 v[32:35], v22, s[24:27], s48 offen offset:0 sc1
    buffer_load_dwordx4 v[36:39], v23, s[24:27], s48 offen offset:0 sc1
    buffer_load_dwordx4 v[40:43], v22, s[24:27], s48 offen offset:1024 sc1
    buffer_load_dwordx4 v[44:47], v23, s[24:27], s48 offen offset:1024 sc1
    buffer_load_dwordx4 v[48:51], v22, s[24:27], s49 offen offset:0 sc1
    buffer_load_dwordx4 v[52:55], v23, s[24:27], s49 offen offset:0 sc1
    buffer_load_dwordx4 v[56:59], v22, s[24:27], s49 offen offset:1024 sc1
    buffer_load_dwordx4 v[60:63], v23, s[24:27], s49 offen offset:1024 sc1
    s_lshl_b32 s92, s46, 1
    s_and_b32 s93, s42, 1
    s_add_u32 s92, s92, s93
    s_lshl_b32 s92, s92, 6
    v_and_b32 v5, 31, v0
    v_lshlrev_b32 v5, 1, v5
    buffer_load_ushort v4, v5, s[36:39], s92 offen
    s_waitcnt vmcnt(9)
    v_mov_b32 v28, 3
    ds_write_b32 v27, v28
    buffer_load_dwordx4 v[8:11], v22, s[24:27], s50 offen offset:0 sc1
    s_waitcnt vmcnt(9)
    v_mfma_f32_32x32x16_bf16 v[64:79], a[0:3], v[32:35], 0
    v_mfma_f32_32x32x16_bf16 v[80:95], a[4:7], v[32:35], 0
    buffer_load_dwordx4 v[12:15], v23, s[24:27], s50 offen offset:0 sc1
    s_waitcnt vmcnt(9)
    v_mfma_f32_32x32x16_bf16 v[96:111], a[0:3], v[36:39], 0
    v_mfma_f32_32x32x16_bf16 v[112:127], a[4:7], v[36:39], 0
    buffer_load_dwordx4 v[32:35], v22, s[24:27], s50 offen offset:1024 sc1
    s_waitcnt vmcnt(9)
    v_mfma_f32_32x32x16_bf16 v[64:79], a[8:11], v[40:43], v[64:79]
    v_mfma_f32_32x32x16_bf16 v[80:95], a[12:15], v[40:43], v[80:95]
    buffer_load_dwordx4 v[36:39], v23, s[24:27], s50 offen offset:1024 sc1
    s_waitcnt vmcnt(9)
    v_mfma_f32_32x32x16_bf16 v[96:111], a[8:11], v[44:47], v[96:111]
    v_mfma_f32_32x32x16_bf16 v[112:127], a[12:15], v[44:47], v[112:127]
    buffer_load_dwordx4 v[40:43], v22, s[24:27], s51 offen offset:0 sc1
    s_waitcnt vmcnt(9)
    v_mfma_f32_32x32x16_bf16 v[64:79], a[16:19], v[48:51], v[64:79]
    ds_read_b64_tr_b16 a[0:1], v20 offset:0
    ds_read_b64_tr_b16 a[2:3], v20 offset:1024
    v_mfma_f32_32x32x16_bf16 v[80:95], a[20:23], v[48:51], v[80:95]
    ds_read_b64_tr_b16 a[4:5], v21 offset:0
    ds_read_b64_tr_b16 a[6:7], v21 offset:1024
    buffer_load_dwordx4 v[44:47], v23, s[24:27], s51 offen offset:0 sc1
    s_waitcnt vmcnt(9)
    v_mfma_f32_32x32x16_bf16 v[96:111], a[16:19], v[52:55], v[96:111]
    ds_read_b64_tr_b16 a[8:9], v20 offset:2048
    ds_read_b64_tr_b16 a[10:11], v20 offset:3072
    v_mfma_f32_32x32x16_bf16 v[112:127], a[20:23], v[52:55], v[112:127]
    ds_read_b64_tr_b16 a[12:13], v21 offset:2048
    ds_read_b64_tr_b16 a[14:15], v21 offset:3072
    buffer_load_dwordx4 v[48:51], v22, s[24:27], s51 offen offset:1024 sc1
    s_waitcnt vmcnt(9)
    v_mfma_f32_32x32x16_bf16 v[64:79], a[24:27], v[56:59], v[64:79]
    v_mfma_f32_32x32x16_bf16 v[80:95], a[28:31], v[56:59], v[80:95]
    s_waitcnt lgkmcnt(0)
    s_lshl_b32 s91, s59, 4
    s_add_u32 m0, s62, 0
    s_nop 0
    buffer_load_dwordx4 v16, s[16:19], s91 offen offset:0 lds
    buffer_load_dwordx4 v[52:55], v23, s[24:27], s51 offen offset:1024 sc1
    s_waitcnt vmcnt(10)
    v_mfma_f32_32x32x16_bf16 v[96:111], a[24:27], v[60:63], v[96:111]
    buffer_load_dwordx4 v17, s[16:19], s91 offen offset:1024 lds
    v_mfma_f32_32x32x16_bf16 v[112:127], a[28:31], v[60:63], v[112:127]
    buffer_load_dwordx4 v18, s[16:19], s91 offen offset:2048 lds
    buffer_load_dwordx4 v19, s[16:19], s91 offen offset:3072 lds
    buffer_load_dwordx4 v[56:59], v22, s[24:27], s52 offen offset:0 sc1
    s_waitcnt vmcnt(12)
    v_mfma_f32_32x32x16_bf16 v[64:79], a[32:35], v[8:11], v[64:79]
    ds_read_b64_tr_b16 a[16:17], v20 offset:16384
    ds_read_b64_tr_b16 a[18:19], v20 offset:17408
    v_mfma_f32_32x32x16_bf16 v[80:95], a[36:39], v[8:11], v[80:95]
    ds_read_b64_tr_b16 a[20:21], v21 offset:16384
    ds_read_b64_tr_b16 a[22:23], v21 offset:17408
    buffer_load_dwordx4 v[60:63], v23, s[24:27], s52 offen offset:0 sc1
    s_waitcnt vmcnt(12)
    v_mfma_f32_32x32x16_bf16 v[96:111], a[32:35], v[12:15], v[96:111]
    ds_read_b64_tr_b16 a[24:25], v20 offset:18432
    ds_read_b64_tr_b16 a[26:27], v20 offset:19456
    v_mfma_f32_32x32x16_bf16 v[112:127], a[36:39], v[12:15], v[112:127]
    ds_read_b64_tr_b16 a[28:29], v21 offset:18432
    ds_read_b64_tr_b16 a[30:31], v21 offset:19456
    buffer_load_dwordx4 v[8:11], v22, s[24:27], s52 offen offset:1024 sc1
    s_waitcnt vmcnt(12)
    v_mfma_f32_32x32x16_bf16 v[64:79], a[40:43], v[32:35], v[64:79]
    v_mfma_f32_32x32x16_bf16 v[80:95], a[44:47], v[32:35], v[80:95]
    s_waitcnt lgkmcnt(0)
    s_lshl_b32 s91, s60, 4
    s_add_u32 m0, s62, 16384
    s_nop 0
    buffer_load_dwordx4 v16, s[16:19], s91 offen offset:0 lds
    buffer_load_dwordx4 v[12:15], v23, s[24:27], s52 offen offset:1024 sc1
    s_waitcnt vmcnt(13)
    v_mfma_f32_32x32x16_bf16 v[96:111], a[40:43], v[36:39], v[96:111]
    buffer_load_dwordx4 v17, s[16:19], s91 offen offset:1024 lds
    v_mfma_f32_32x32x16_bf16 v[112:127], a[44:47], v[36:39], v[112:127]
    buffer_load_dwordx4 v18, s[16:19], s91 offen offset:2048 lds
    buffer_load_dwordx4 v19, s[16:19], s91 offen offset:3072 lds
    buffer_load_dwordx4 v[32:35], v22, s[24:27], s53 offen offset:0 sc1
    s_waitcnt vmcnt(16)
    v_mfma_f32_32x32x16_bf16 v[64:79], a[48:51], v[40:43], v[64:79]
    ds_read_b64_tr_b16 a[32:33], v20 offset:32768
    ds_read_b64_tr_b16 a[34:35], v20 offset:33792
    v_mfma_f32_32x32x16_bf16 v[80:95], a[52:55], v[40:43], v[80:95]
    ds_read_b64_tr_b16 a[36:37], v21 offset:32768
    ds_read_b64_tr_b16 a[38:39], v21 offset:33792
    buffer_load_dwordx4 v[36:39], v23, s[24:27], s53 offen offset:0 sc1
    s_waitcnt vmcnt(16)
    v_mfma_f32_32x32x16_bf16 v[96:111], a[48:51], v[44:47], v[96:111]
    ds_read_b64_tr_b16 a[40:41], v20 offset:34816
    ds_read_b64_tr_b16 a[42:43], v20 offset:35840
    v_mfma_f32_32x32x16_bf16 v[112:127], a[52:55], v[44:47], v[112:127]
    ds_read_b64_tr_b16 a[44:45], v21 offset:34816
    ds_read_b64_tr_b16 a[46:47], v21 offset:35840
    buffer_load_dwordx4 v[40:43], v22, s[24:27], s53 offen offset:1024 sc1
    s_waitcnt vmcnt(16)
    v_mfma_f32_32x32x16_bf16 v[64:79], a[56:59], v[48:51], v[64:79]
    v_mfma_f32_32x32x16_bf16 v[80:95], a[60:63], v[48:51], v[80:95]
    s_waitcnt lgkmcnt(0)
    s_lshl_b32 s91, s61, 4
    s_add_u32 m0, s62, 32768
    s_nop 0
    buffer_load_dwordx4 v16, s[16:19], s91 offen offset:0 lds
    buffer_load_dwordx4 v[44:47], v23, s[24:27], s53 offen offset:1024 sc1
    s_waitcnt vmcnt(16)
    v_mfma_f32_32x32x16_bf16 v[96:111], a[56:59], v[52:55], v[96:111]
    buffer_load_dwordx4 v17, s[16:19], s91 offen offset:1024 lds
    v_mfma_f32_32x32x16_bf16 v[112:127], a[60:63], v[52:55], v[112:127]
    buffer_load_dwordx4 v18, s[16:19], s91 offen offset:2048 lds
    buffer_load_dwordx4 v19, s[16:19], s91 offen offset:3072 lds
    buffer_load_dwordx4 v[48:51], v22, s[24:27], s54 offen offset:0 sc1
    s_waitcnt vmcnt(16)
    v_mfma_f32_32x32x16_bf16 v[64:79], a[64:67], v[56:59], v[64:79]
    ds_read_b64_tr_b16 a[48:49], v20 offset:0
    ds_read_b64_tr_b16 a[50:51], v20 offset:1024
    v_mfma_f32_32x32x16_bf16 v[80:95], a[68:71], v[56:59], v[80:95]
    ds_read_b64_tr_b16 a[52:53], v21 offset:0
    ds_read_b64_tr_b16 a[54:55], v21 offset:1024
    buffer_load_dwordx4 v[52:55], v23, s[24:27], s54 offen offset:0 sc1
    s_waitcnt vmcnt(16)
    v_mfma_f32_32x32x16_bf16 v[96:111], a[64:67], v[60:63], v[96:111]
    ds_read_b64_tr_b16 a[56:57], v20 offset:2048
    ds_read_b64_tr_b16 a[58:59], v20 offset:3072
    v_mfma_f32_32x32x16_bf16 v[112:127], a[68:71], v[60:63], v[112:127]
    ds_read_b64_tr_b16 a[60:61], v21 offset:2048
    ds_read_b64_tr_b16 a[62:63], v21 offset:3072
    buffer_load_dwordx4 v[56:59], v22, s[24:27], s54 offen offset:1024 sc1
    s_waitcnt vmcnt(16)
    v_mfma_f32_32x32x16_bf16 v[64:79], a[72:75], v[8:11], v[64:79]
    s_buffer_load_dwordx2 s[68:69], s[24:27], s76 offset:0 glc
    v_mfma_f32_32x32x16_bf16 v[80:95], a[76:79], v[8:11], v[80:95]
    s_buffer_load_dwordx2 s[70:71], s[24:27], s76 offset:256 glc
    buffer_load_dwordx4 v[60:63], v23, s[24:27], s54 offen offset:1024 sc1
    s_waitcnt vmcnt(15)
    v_mfma_f32_32x32x16_bf16 v[96:111], a[72:75], v[12:15], v[96:111]
    s_buffer_load_dwordx2 s[72:73], s[24:27], s76 offset:2048 glc
    v_mfma_f32_32x32x16_bf16 v[112:127], a[76:79], v[12:15], v[112:127]
    s_buffer_load_dwordx2 s[74:75], s[24:27], s76 offset:2304 glc
    buffer_load_dwordx4 v[8:11], v22, s[24:27], s55 offen offset:0 sc1
    s_waitcnt vmcnt(12)
    v_mfma_f32_32x32x16_bf16 v[64:79], a[80:83], v[32:35], v[64:79]
    ds_read_b64_tr_b16 a[64:65], v20 offset:16384
    ds_read_b64_tr_b16 a[66:67], v20 offset:17408
    v_mfma_f32_32x32x16_bf16 v[80:95], a[84:87], v[32:35], v[80:95]
    ds_read_b64_tr_b16 a[68:69], v21 offset:16384
    ds_read_b64_tr_b16 a[70:71], v21 offset:17408
    buffer_load_dwordx4 v[12:15], v23, s[24:27], s55 offen offset:0 sc1
    s_waitcnt vmcnt(12)
    v_mfma_f32_32x32x16_bf16 v[96:111], a[80:83], v[36:39], v[96:111]
    ds_read_b64_tr_b16 a[72:73], v20 offset:18432
    ds_read_b64_tr_b16 a[74:75], v20 offset:19456
    v_mfma_f32_32x32x16_bf16 v[112:127], a[84:87], v[36:39], v[112:127]
    ds_read_b64_tr_b16 a[76:77], v21 offset:18432
    ds_read_b64_tr_b16 a[78:79], v21 offset:19456
    buffer_load_dwordx4 v[32:35], v22, s[24:27], s55 offen offset:1024 sc1
    s_waitcnt vmcnt(12)
    v_mfma_f32_32x32x16_bf16 v[64:79], a[88:91], v[40:43], v[64:79]
    v_mfma_f32_32x32x16_bf16 v[80:95], a[92:95], v[40:43], v[80:95]
    buffer_load_dwordx4 v[36:39], v23, s[24:27], s55 offen offset:1024 sc1
    s_waitcnt vmcnt(11)
    v_mfma_f32_32x32x16_bf16 v[96:111], a[88:91], v[44:47], v[96:111]
    v_mfma_f32_32x32x16_bf16 v[112:127], a[92:95], v[44:47], v[112:127]
    s_waitcnt lgkmcnt(0)
    s_xor_b64 s[68:69], s[68:69], s[40:41]
    s_xor_b64 s[70:71], s[70:71], s[40:41]
    s_xor_b64 s[72:73], s[72:73], s[40:41]
    s_xor_b64 s[74:75], s[74:75], s[40:41]
    s_or_b64 s[68:69], s[68:69], s[70:71]
    s_or_b64 s[68:69], s[68:69], s[72:73]
    s_or_b64 s[68:69], s[68:69], s[74:75]
    s_cbranch_scc1 L_slow_h27
L_ret_h28:
    buffer_load_dwordx4 v[40:43], v22, s[24:27], s56 offen offset:0 sc1
    s_waitcnt vmcnt(8)
    v_mfma_f32_32x32x16_bf16 v[64:79], a[96:99], v[48:51], v[64:79]
    ds_read_b64_tr_b16 a[80:81], v20 offset:32768
    ds_read_b64_tr_b16 a[82:83], v20 offset:33792
    v_mfma_f32_32x32x16_bf16 v[80:95], a[100:103], v[48:51], v[80:95]
    ds_read_b64_tr_b16 a[84:85], v21 offset:32768
    ds_read_b64_tr_b16 a[86:87], v21 offset:33792
    buffer_load_dwordx4 v[44:47], v23, s[24:27], s56 offen offset:0 sc1
    s_waitcnt vmcnt(8)
    v_mfma_f32_32x32x16_bf16 v[96:111], a[96:99], v[52:55], v[96:111]
    ds_read_b64_tr_b16 a[88:89], v20 offset:34816
    ds_read_b64_tr_b16 a[90:91], v20 offset:35840
    v_mfma_f32_32x32x16_bf16 v[112:127], a[100:103], v[52:55], v[112:127]
    ds_read_b64_tr_b16 a[92:93], v21 offset:34816
    ds_read_b64_tr_b16 a[94:95], v21 offset:35840
    buffer_load_dwordx4 v[48:51], v22, s[24:27], s56 offen offset:1024 sc1
    s_waitcnt vmcnt(8)
    v_mfma_f32_32x32x16_bf16 v[64:79], a[104:107], v[56:59], v[64:79]
    v_mfma_f32_32x32x16_bf16 v[80:95], a[108:111], v[56:59], v[80:95]
    buffer_load_dwordx4 v[52:55], v23, s[24:27], s56 offen offset:1024 sc1
    s_waitcnt vmcnt(8)
    v_mfma_f32_32x32x16_bf16 v[96:111], a[104:107], v[60:63], v[96:111]
    v_mov_b32_e64 v28, 4
    ds_write_b32 v27, v28
    v_mfma_f32_32x32x16_bf16 v[112:127], a[108:111], v[60:63], v[112:127]
    s_setprio 2
    buffer_load_dwordx4 v[56:59], v22, s[24:27], s57 offen offset:0 sc1
    s_waitcnt vmcnt(8)
    v_mfma_f32_32x32x16_bf16 v[64:79], a[112:115], v[8:11], v[64:79]
    v_mfma_f32_32x32x16_bf16 v[80:95], a[116:119], v[8:11], v[80:95]
    buffer_load_dwordx4 v[60:63], v23, s[24:27], s57 offen offset:0 sc1
    s_waitcnt vmcnt(8)
    v_mfma_f32_32x32x16_bf16 v[96:111], a[112:115], v[12:15], v[96:111]
    s_waitcnt lgkmcnt(1)
    v_mov_b32 v28, 5
    ds_write_b32 v27, v28
    v_mfma_f32_32x32x16_bf16 v[112:127], a[116:119], v[12:15], v[112:127]
    buffer_load_dwordx4 v[8:11], v22, s[24:27], s57 offen offset:1024 sc1
    s_waitcnt vmcnt(8)
    v_mfma_f32_32x32x16_bf16 v[64:79], a[120:123], v[32:35], v[64:79]
    v_mfma_f32_32x32x16_bf16 v[80:95], a[124:127], v[32:35], v[80:95]
    buffer_load_dwordx4 v[12:15], v23, s[24:27], s57 offen offset:1024 sc1
    s_waitcnt vmcnt(8)
    v_mfma_f32_32x32x16_bf16 v[96:111], a[120:123], v[36:39], v[96:111]
    v_mfma_f32_32x32x16_bf16 v[112:127], a[124:127], v[36:39], v[112:127]
    buffer_load_dwordx4 v[32:35], v22, s[24:27], s58 offen offset:0 sc1
    s_waitcnt vmcnt(8)
    v_mfma_f32_32x32x16_bf16 v[64:79], a[0:3], v[40:43], v[64:79]
    v_mfma_f32_32x32x16_bf16 v[80:95], a[4:7], v[40:43], v[80:95]
    buffer_load_dwordx4 v[36:39], v23, s[24:27], s58 offen offset:0 sc1
    s_waitcnt vmcnt(8)
    v_mfma_f32_32x32x16_bf16 v[96:111], a[0:3], v[44:47], v[96:111]
    v_mov_b32 v5, 0
    v_mov_b32 v6, 0
    v_mov_b32 v7, 0
    v_mov_b32 v17, 0
    v_mov_b32 v18, 0
    v_mov_b32 v19, 0
    v_mov_b32 v16, 0x3f80
    v_cndmask_b32 v16, v16, v5, s[96:97]
    v_mfma_f32_32x32x16_bf16 v[112:127], a[4:7], v[44:47], v[112:127]
    buffer_load_dwordx4 v[40:43], v22, s[24:27], s58 offen offset:1024 sc1
    s_waitcnt vmcnt(8)
    v_mfma_f32_32x32x16_bf16 v[64:79], a[8:11], v[48:51], v[64:79]
    v_mfma_f32_32x32x16_bf16 v[80:95], a[12:15], v[48:51], v[80:95]
    buffer_load_dwordx4 v[44:47], v23, s[24:27], s58 offen offset:1024 sc1
    s_waitcnt vmcnt(8)
    v_mfma_f32_32x32x16_bf16 v[96:111], a[8:11], v[52:55], v[96:111]
    v_mfma_f32_32x32x16_bf16 v[112:127], a[12:15], v[52:55], v[112:127]
    buffer_load_dwordx4 v[48:51], v22, s[24:27], s59 offen offset:0 sc1
    s_waitcnt vmcnt(8)
    v_mfma_f32_32x32x16_bf16 v[64:79], a[16:19], v[56:59], v[64:79]
    v_mfma_f32_32x32x16_bf16 v[80:95], a[20:23], v[56:59], v[80:95]
    buffer_load_dwordx4 v[52:55], v23, s[24:27], s59 offen offset:0 sc1
    s_waitcnt vmcnt(8)
    v_mfma_f32_32x32x16_bf16 v[96:111], a[16:19], v[60:63], v[96:111]
    v_mfma_f32_32x32x16_bf16 v[64:79], v[4:7], v[16:19], v[64:79]
    v_mfma_f32_32x32x16_bf16 v[112:127], a[20:23], v[60:63], v[112:127]
    buffer_load_dwordx4 v[56:59], v22, s[24:27], s59 offen offset:1024 sc1
    s_waitcnt vmcnt(8)
    v_mfma_f32_32x32x16_bf16 v[64:79], a[24:27], v[8:11], v[64:79]
    v_mfma_f32_32x32x16_bf16 v[80:95], a[28:31], v[8:11], v[80:95]
    buffer_load_dwordx4 v[60:63], v23, s[24:27], s59 offen offset:1024 sc1
    s_waitcnt vmcnt(8)
    v_mfma_f32_32x32x16_bf16 v[96:111], a[24:27], v[12:15], v[96:111]
    v_mfma_f32_32x32x16_bf16 v[112:127], a[28:31], v[12:15], v[112:127]
    buffer_load_dwordx4 v[8:11], v23, s[24:27], s60 offen offset:0 sc1
    s_waitcnt vmcnt(8)
    v_mfma_f32_32x32x16_bf16 v[64:79], a[32:35], v[32:35], v[64:79]
    v_mfma_f32_32x32x16_bf16 v[80:95], a[36:39], v[32:35], v[80:95]
    ds_read_b32 v30, v26 offset:0
    buffer_load_dwordx4 v[12:15], v23, s[24:27], s60 offen offset:1024 sc1
    s_waitcnt vmcnt(8)
    v_mfma_f32_32x32x16_bf16 v[96:111], a[32:35], v[36:39], v[96:111]
    v_mfma_f32_32x32x16_bf16 v[112:127], a[36:39], v[36:39], v[112:127]
    ds_read_b32 v31, v26 offset:16
    buffer_load_dwordx4 v[32:35], v23, s[24:27], s61 offen offset:0 sc1
    s_waitcnt vmcnt(8)
    v_mfma_f32_32x32x16_bf16 v[64:79], a[40:43], v[40:43], v[64:79]
    v_mfma_f32_32x32x16_bf16 v[80:95], a[44:47], v[40:43], v[80:95]
    buffer_load_dwordx4 v[36:39], v23, s[24:27], s61 offen offset:1024 sc1
    s_waitcnt vmcnt(8)
    v_mfma_f32_32x32x16_bf16 v[96:111], a[40:43], v[44:47], v[96:111]
    s_xor_b32 s90, s42, 0
    s_lshl_b32 s90, s90, 14
    s_add_u32 s90, s90, 0
    v_add_u32 v2, s90, v1
    s_xor_b32 s90, s42, 1
    s_lshl_b32 s90, s90, 14
    s_add_u32 s90, s90, 4096
    v_add_u32 v3, s90, v1
    s_xor_b32 s90, s42, 2
    s_lshl_b32 s90, s90, 14
    s_add_u32 s90, s90, 8192
    v_add_u32 v24, s90, v1
    s_xor_b32 s90, s42, 3
    s_lshl_b32 s90, s90, 14
    s_add_u32 s90, s90, 12288
    v_add_u32_e64 v25, s90, v1
    v_mfma_f32_32x32x16_bf16 v[112:127], a[44:47], v[44:47], v[112:127]
    buffer_load_dwordx4 v[40:43], v22, s[24:27], s60 offen offset:0 sc1
    s_waitcnt vmcnt(8)
    v_mfma_f32_32x32x16_bf16 v[64:79], a[48:51], v[48:51], v[64:79]
    v_mfma_f32_32x32x16_bf16 v[80:95], a[52:55], v[48:51], v[80:95]
    buffer_load_dwordx4 v[44:47], v22, s[24:27], s60 offen offset:1024 sc1
    s_waitcnt vmcnt(8)
    v_mfma_f32_32x32x16_bf16 v[96:111], a[48:51], v[52:55], v[96:111]
    v_mfma_f32_32x32x16_bf16 v[112:127], a[52:55], v[52:55], v[112:127]
    buffer_load_dwordx4 v[48:51], v22, s[24:27], s61 offen offset:0 sc1
    s_waitcnt vmcnt(8)
    v_mfma_f32_32x32x16_bf16 v[64:79], a[56:59], v[56:59], v[64:79]
    v_mfma_f32_32x32x16_bf16 v[80:95], a[60:63], v[56:59], v[80:95]
    buffer_load_dwordx4 v[52:55], v22, s[24:27], s61 offen offset:1024 sc1
    s_waitcnt vmcnt(8)
    v_mfma_f32_32x32x16_bf16 v[96:111], a[56:59], v[60:63], v[96:111]
    v_mfma_f32_32x32x16_bf16 v[112:127], a[60:63], v[60:63], v[112:127]
    s_waitcnt lgkmcnt(1)
    v_cmp_gt_u32 vcc, 5, v30
    s_nop 1
    s_cbranch_vccnz L_lslow13
L_lret14:
    s_waitcnt lgkmcnt(0)
    v_cmp_gt_u32 vcc, 5, v31
    s_nop 1
    s_cbranch_vccnz L_lslow15
L_lret16:
    s_waitcnt vmcnt(7)
    v_mfma_f32_32x32x16_bf16 v[96:111], a[64:67], v[8:11], v[96:111]
    v_mfma_f32_32x32x16_bf16 v[112:127], a[68:71], v[8:11], v[112:127]
    s_waitcnt vmcnt(6)
    v_mfma_f32_32x32x16_bf16 v[96:111], a[72:75], v[12:15], v[96:111]
    v_mfma_f32_32x32x16_bf16 v[112:127], a[76:79], v[12:15], v[112:127]
    s_waitcnt vmcnt(5)
    v_mfma_f32_32x32x16_bf16 v[96:111], a[80:83], v[32:35], v[96:111]
    v_mfma_f32_32x32x16_bf16 v[112:127], a[84:87], v[32:35], v[112:127]
    s_waitcnt vmcnt(4)
    v_mfma_f32_32x32x16_bf16 v[96:111], a[88:91], v[36:39], v[96:111]
    v_mfma_f32_32x32x16_bf16 v[112:127], a[92:95], v[36:39], v[112:127]
    s_waitcnt vmcnt(3)
    v_mfma_f32_32x32x16_bf16 v[80:95], a[68:71], v[40:43], v[80:95]
    s_waitcnt vmcnt(2)
    v_mfma_f32_32x32x16_bf16 v[80:95], a[76:79], v[44:47], v[80:95]
    s_waitcnt vmcnt(1)
    v_mfma_f32_32x32x16_bf16 v[80:95], a[84:87], v[48:51], v[80:95]
    s_nop 4
    ds_write_b128 v24, v[96:99] offset:0
    ds_write_b128 v24, v[100:103] offset:1024
    s_waitcnt vmcnt(0)
    v_mfma_f32_32x32x16_bf16 v[80:95], a[92:95], v[52:55], v[80:95]
    ds_write_b128 v24, v[104:107] offset:2048
    v_mfma_f32_32x32x16_bf16 v[64:79], a[64:67], v[40:43], v[64:79]
    ds_write_b128 v24, v[108:111] offset:3072
    v_mfma_f32_32x32x16_bf16 v[64:79], a[72:75], v[44:47], v[64:79]
    ds_write_b128 v25, v[112:115] offset:0
    v_mfma_f32_32x32x16_bf16 v[64:79], a[80:83], v[48:51], v[64:79]
    ds_write_b128 v25, v[116:119] offset:1024
    ds_write_b128 v25, v[120:123] offset:2048
    v_mfma_f32_32x32x16_bf16 v[64:79], a[88:91], v[52:55], v[64:79]
    ds_write_b128 v25, v[124:127] offset:3072
    s_nop 1
    ds_write_b128 v3, v[80:83] offset:0
    ds_write_b128 v3, v[84:87] offset:1024
    ds_write_b128 v3, v[88:91] offset:2048
    ds_write_b128 v3, v[92:95] offset:3072
    s_nop 4
    ds_write_b128 v2, v[64:67] offset:0
    ds_write_b128 v2, v[68:71] offset:1024
    ds_write_b128 v2, v[72:75] offset:2048
    ds_write_b128 v2, v[76:79] offset:3072
    v_mov_b32 v28, 6
    ds_write_b32 v27, v28
    s_endpgm
L_slow_eg1:
s_mov_b32 s67, 0
L_slow_eg1_loop:
s_sleep 4
buffer_load_dwordx4 v[96:99], v121, s[24:27], s100 offen offset:0 sc1
buffer_load_dwordx4 v[100:103], v121, s[24:27], s100 offen offset:2048 sc1
buffer_load_dwordx4 v[104:107], v122, s[24:27], s100 offen offset:0 sc1
buffer_load_dwordx4 v[108:111], v122, s[24:27], s100 offen offset:2048 sc1
s_waitcnt vmcnt(0)
s_add_u32 s67, s67, 1
s_cmp_ge_u32 s67, 0x8000
s_cbranch_scc1 L_ret_eg2
v_cmp_ne_u64 vcc, s[40:41], v[98:99]
s_nop 1
s_cbranch_vccnz L_slow_eg1_loop
v_cmp_ne_u64 vcc, s[40:41], v[102:103]
s_nop 1
s_cbranch_vccnz L_slow_eg1_loop
v_cmp_ne_u64 vcc, s[40:41], v[106:107]
s_nop 1
s_cbranch_vccnz L_slow_eg1_loop
v_cmp_ne_u64 vcc, s[40:41], v[110:111]
s_nop 1
s_cbranch_vccnz L_slow_eg1_loop
s_branch L_ret_eg2
L_lslow3:
s_mov_b32 s67, 0
L_lslow3_loop:
ds_read_b32 v30, v26 offset:16
s_add_u32 s67, s67, 1
s_cmp_ge_u32 s67, 0x100000
s_cbranch_scc1 L_lret4
s_waitcnt lgkmcnt(0)
v_cmp_gt_u32 vcc, 2, v30
s_nop 1
s_cbranch_vccnz L_lslow3_loop
s_branch L_lret4
L_slow_h5:
s_mov_b32 s67, 0
L_slow_h5_loop:
s_sleep 2
s_buffer_load_dwordx2 s[68:69], s[24:27], s76 offset:128 glc
s_buffer_load_dwordx2 s[70:71], s[24:27], s76 offset:384 glc
s_buffer_load_dwordx2 s[72:73], s[24:27], s76 offset:2176 glc
s_buffer_load_dwordx2 s[74:75], s[24:27], s76 offset:2432 glc
s_waitcnt lgkmcnt(0)
s_add_u32 s67, s67, 1
s_cmp_ge_u32 s67, 0x8000
s_cbranch_scc1 L_ret_h6
s_xor_b64 s[68:69], s[68:69], s[40:41]
s_xor_b64 s[70:71], s[70:71], s[40:41]
s_xor_b64 s[72:73], s[72:73], s[40:41]
s_xor_b64 s[74:75], s[74:75], s[40:41]
s_or_b64 s[68:69], s[68:69], s[70:71]
s_or_b64 s[68:69], s[68:69], s[72:73]
s_or_b64 s[68:69], s[68:69], s[74:75]
s_cbranch_scc1 L_slow_h5_loop
s_branch L_ret_h6
L_slow_h27:
s_mov_b32 s67, 0
L_slow_h27_loop:
s_sleep 2
s_buffer_load_dwordx2 s[68:69], s[24:27], s76 offset:0 glc
s_buffer_load_dwordx2 s[70:71], s[24:27], s76 offset:256 glc
s_buffer_load_dwordx2 s[72:73], s[24:27], s76 offset:2048 glc
s_buffer_load_dwordx2 s[74:75], s[24:27], s76 offset:2304 glc
s_waitcnt lgkmcnt(0)
s_add_u32 s67, s67, 1
s_cmp_ge_u32 s67, 0x8000
s_cbranch_scc1 L_ret_h28
s_xor_b64 s[68:69], s[68:69], s[40:41]
s_xor_b64 s[70:71], s[70:71], s[40:41]
s_xor_b64 s[72:73], s[72:73], s[40:41]
s_xor_b64 s[74:75], s[74:75], s[40:41]
s_or_b64 s[68:69], s[68:69], s[70:71]
s_or_b64 s[68:69], s[68:69], s[72:73]
s_or_b64 s[68:69], s[68:69], s[74:75]
s_cbranch_scc1 L_slow_h27_loop
s_branch L_ret_h28
L_lslow9:
s_mov_b32 s67, 0
L_lslow9_loop:
ds_read_b32 v30, v26 offset:16
s_add_u32 s67, s67, 1
s_cmp_ge_u32 s67, 0x100000
s_cbranch_scc1 L_lret10
s_waitcnt lgkmcnt(0)
v_cmp_gt_u32 vcc, 3, v30
s_nop 1
s_cbranch_vccnz L_lslow9_loop
s_branch L_lret10
L_lslow11:
s_mov_b32 s67, 0
L_lslow11_loop:
ds_read_b32 v30, v26 offset:16
s_add_u32 s67, s67, 1
s_cmp_ge_u32 s67, 0x100000
s_cbranch_scc1 L_lret12
s_waitcnt lgkmcnt(0)
v_cmp_gt_u32 vcc, 4, v30
s_nop 1
s_cbranch_vccnz L_lslow11_loop
s_branch L_lret12
L_lslow13:
s_mov_b32 s67, 0
L_lslow13_loop:
ds_read_b32 v30, v26 offset:0
s_add_u32 s67, s67, 1
s_cmp_ge_u32 s67, 0x100000
s_cbranch_scc1 L_lret14
s_waitcnt lgkmcnt(0)
v_cmp_gt_u32 vcc, 5, v30
s_nop 1
s_cbranch_vccnz L_lslow13_loop
s_branch L_lret14
L_lslow15:
s_mov_b32 s67, 0
L_lslow15_loop:
ds_read_b32 v31, v26 offset:16
s_add_u32 s67, s67, 1
s_cmp_ge_u32 s67, 0x100000
s_cbranch_scc1 L_lret16
s_waitcnt lgkmcnt(0)
v_cmp_gt_u32 vcc, 5, v31
s_nop 1
s_cbranch_vccnz L_lslow15_loop
s_branch L_lret16
.p2align 6
L_AKV:
    s_and_b32 s90, s2, 7
    s_lshr_b32 s91, s2, 3
    s_lshr_b32 s70, s90, 2
    s_and_b32 s71, s91, 7
    s_lshl_b32 s43, s70, 3
    s_add_u32 s43, s43, s71
    s_and_b32 s72, s2, 3
    s_lshl_b32 s72, s72, 1
    s_lshr_b32 s92, s2, 7
    s_add_u32 s3, s72, s92
    v_lshrrev_b32 v28, 5, v0
    v_and_b32_e64 v29, 3, v0
    s_lshl_b32 s44, s3, 1
    s_and_b32 s45, s2, 7
    s_lshl_b32 s45, s45, 2
    s_bfe_u32 s92, s2, 0x10003
    s_add_u32 s45, s45, s92
    s_bfe_u32 s46, s2, 0x20004
    s_lshr_b32 s92, s2, 7
    s_lshl_b32 s92, s92, 2
    s_add_u32 s46, s46, s92
    v_lshlrev_b32 v1, 4, v0
    v_and_b32 v29, 3, v0
    v_bfe_u32 v30, v0, 2, 2
    v_lshlrev_b32_e64 v30, 6, v30
    v_bfe_u32 v31, v0, 4, 1
    v_lshl_or_b32 v30, v31, 5, v30
    v_lshl_or_b32 v30, v29, 3, v30
    s_lshl_b32 s92, s43, 7
    s_lshl_b32 s74, s44, 3
    s_add_u32 s92, s92, s74
    s_lshl_b32 s74, s42, 1
    s_add_u32 s74, s92, s74
    v_add_u32 v70, s74, v28
    v_and_b32 v71, 31, v0
    v_lshlrev_b32 v71, 4, v71
    v_lshl_or_b32 v72, v70, 10, v71
    s_mov_b32 s6, 2097152
    s_mov_b32 s7, 0x20000
    s_waitcnt lgkmcnt(0)
    s_mov_b32 s4, s48
    s_mov_b32 s5, s49
    buffer_load_dwordx4 v[64:67], v72, s[4:7], 0 offen
    s_load_dwordx2 s[40:41], s[66:67], 0
    buffer_load_dwordx4 v[76:79], v72, s[4:7], 0 offen offset:512
    s_lshr_b32 s90, s2, 3
    s_lshl_b32 s90, s90, 2
    s_add_u32 s90, s90, s42
    s_mul_i32 s90, s90, 18
    v_min_u32 v12, 17, v0
    v_add_u32 v12, s90, v12
    v_lshlrev_b32 v12, 10, v12
    v_subrev_u32 v13, 1835008, v12
    s_mov_b32 s16, s60
    s_mov_b32 s17, s61
    s_mov_b32 s18, 1835008
    s_mov_b32 s19, 0x20000
    s_mov_b32 s20, s52
    s_mov_b32 s21, s53
    s_mov_b32 s22, 524288
    s_mov_b32 s23, 0x20000
    s_sub_u32 s74, 0x180, s60
    s_and_b32 s74, s74, 0x380
    s_sub_u32 s75, 0x180, s52
    s_and_b32 s75, s75, 0x380
    s_mov_b32 s28, s64
    s_mov_b32 s29, s65
    s_mov_b32 s30, 2097152
    s_mov_b32 s31, 0x20000
    s_mov_b32 s24, s66
    s_mov_b32 s25, s67
    s_mov_b32 s26, 16777216
    s_mov_b32 s27, 0x20000
    v_lshl_or_b32 v2, v28, 10, v30
    v_add_u32 v3, 0x10000, v2
    v_add_u32 v4, 0x20000, v2
    s_lshl_b32 s63, s43, 2
    s_add_u32 s63, s63, s42
    s_lshl_b32 s62, s42, 12
    v_xor_b32 v31, v28, v29
    v_bfe_u32 v30, v0, 4, 1
    v_lshlrev_b32 v30, 2, v30
    v_xor_b32 v31, v31, v30
    v_lshlrev_b32_e64 v31, 4, v31
    v_lshl_or_b32 v31, v29, 10, v31
    v_bfe_u32 v30, v0, 2, 3
    v_lshl_or_b32 v31, v30, 7, v31
    v_add_u32 v5, s62, v31
    v_xor_b32 v6, 32, v5
    v_xor_b32_e64 v7, 64, v5
    v_xor_b32 v8, 96, v5
    v_add_u32 v9, 147456, v71
    v_mov_b32 v31, v71
    s_lshl_b32 s101, s63, 9
    s_add_u32 s101, s101, 4096
    v_and_b32 v26, 3, v0
    v_lshlrev_b32 v26, 2, v26
    v_add_u32 v26, 152576, v26
    s_lshl_b32 s92, s42, 2
    s_add_u32 s92, s92, 152592
    v_mov_b32 v27, s92
    v_mov_b32_e64 v28, 0
    ds_write_b32 v27, v28
    s_mov_b32 s94, 0xffff0000
    s_mov_b32 s95, 0xffff0000
    s_mov_b32 s96, 0
    s_mov_b32 s97, -1
    s_waitcnt lgkmcnt(0)
    s_mul_i32 s40, s40, 1664525
    s_add_u32 s40, s40, 1013904223
    s_mul_i32 s41, s41, 22695477
    s_add_u32 s41, s41, 1
    s_waitcnt vmcnt(1)
    v_lshlrev_b32 v80, 16, v64
    v_and_b32 v81, 0xffff0000, v64
    v_lshlrev_b32 v82, 16, v65
    v_and_b32 v83, 0xffff0000, v65
    v_lshlrev_b32 v84, 16, v66
    v_and_b32 v85, 0xffff0000, v66
    v_lshlrev_b32 v86, 16, v67
    v_and_b32 v87, 0xffff0000, v67
    s_waitcnt vmcnt(0)
    v_lshlrev_b32_e64 v88, 16, v76
    v_and_b32 v89, 0xffff0000, v76
    v_lshlrev_b32 v90, 16, v77
    v_and_b32 v91, 0xffff0000, v77
    v_lshlrev_b32 v92, 16, v78
    v_and_b32 v93, 0xffff0000, v78
    v_lshlrev_b32 v94, 16, v79
    v_and_b32 v95, 0xffff0000, v79
    v_add_f32 v96, v80, v81
    v_add_f32 v97, v82, v83
    v_add_f32 v96, v96, v84
    v_add_f32 v96, v96, v85
    v_add_f32 v97, v97, v86
    v_add_f32 v97, v97, v87
    v_add_f32 v96, v96, v88
    v_add_f32 v96, v96, v89
    v_add_f32 v97, v97, v90
    v_add_f32 v97, v97, v91
    v_add_f32 v96, v96, v92
    v_add_f32 v96, v96, v93
    v_add_f32 v97, v97, v94
    v_add_f32 v97, v97, v95
    v_add_f32 v96, v96, v97
    s_nop 1
    v_add_f32_dpp v96, v96, v96 quad_perm:[1,0,3,2] row_mask:0xf bank_mask:0xf
    s_nop 1
    v_add_f32_dpp v96, v96, v96 quad_perm:[2,3,0,1] row_mask:0xf bank_mask:0xf
    s_nop 1
    v_add_f32_dpp v96, v96, v96 row_half_mirror row_mask:0xf bank_mask:0xf
    s_nop 1
    v_add_f32_dpp v96, v96, v96 row_mirror row_mask:0xf bank_mask:0xf
    v_mov_b32 v97, v96
    s_nop 1
    v_permlane16_swap_b32 v96, v97
    v_add_f32 v96, v96, v97
    v_mul_f32 v100, 0x3b000000, v96
    v_sub_f32 v80, v80, v100
    v_sub_f32 v81, v81, v100
    v_sub_f32 v82, v82, v100
    v_sub_f32 v83, v83, v100
    v_sub_f32 v84, v84, v100
    v_sub_f32 v85, v85, v100
    v_sub_f32 v86, v86, v100
    v_sub_f32 v87, v87, v100
    v_sub_f32 v88, v88, v100
    v_sub_f32 v89, v89, v100
    v_sub_f32 v90, v90, v100
    v_sub_f32 v91, v91, v100
    v_sub_f32 v92, v92, v100
    v_sub_f32 v93, v93, v100
    v_sub_f32 v94, v94, v100
    v_sub_f32 v95, v95, v100
    v_mul_f32 v96, v80, v80
    v_mul_f32 v97, v81, v81
    v_fmac_f32 v96, v82, v82
    v_fmac_f32 v97, v83, v83
    v_fmac_f32 v96, v84, v84
    v_fmac_f32 v97, v85, v85
    v_fmac_f32 v96, v86, v86
    v_fmac_f32 v97, v87, v87
    v_fmac_f32 v96, v88, v88
    v_fmac_f32 v97, v89, v89
    v_fmac_f32 v96, v90, v90
    v_fmac_f32 v97, v91, v91
    v_fmac_f32 v96, v92, v92
    v_fmac_f32 v97, v93, v93
    v_fmac_f32 v96, v94, v94
    v_fmac_f32 v97, v95, v95
    v_add_f32 v96, v96, v97
    s_nop 1
    v_add_f32_dpp v96, v96, v96 quad_perm:[1,0,3,2] row_mask:0xf bank_mask:0xf
    s_nop 1
    v_add_f32_dpp v96, v96, v96 quad_perm:[2,3,0,1] row_mask:0xf bank_mask:0xf
    s_nop 1
    v_add_f32_dpp v96, v96, v96 row_half_mirror row_mask:0xf bank_mask:0xf
    s_nop 1
    v_add_f32_dpp v96, v96, v96 row_mirror row_mask:0xf bank_mask:0xf
    v_mov_b32 v97, v96
    s_nop 1
    v_permlane16_swap_b32 v96, v97
    v_add_f32_e64 v96, v96, v97
    v_mov_b32 v97, 0x3727c5ac
    v_fmac_f32 v97, 0x3b000000, v96
    v_sqrt_f32 v101, v97
    v_mov_b32 v102, s40
    v_mov_b32 v103, s41
    v_lshlrev_b32 v70, 4, v70
    v_add_u32 v70, 4096, v70
    v_mov_b32 v14, v100
    v_mov_b32 v15, v101
    v_mov_b32 v16, v102
    v_mov_b32 v17, v103
    v_mov_b32 v18, v70
    s_lshl_b32 s80, s3, 13
    s_add_u32 s80, s80, 1048576
    s_lshl_b32 s90, s42, 10
    s_add_u32 s81, s80, s90
    s_add_u32 s80, s80, 4096
    s_lshl_b32 s82, s3, 2
    s_add_u32 s82, s82, s42
    s_lshl_b32 s82, s82, 7
    s_add_u32 s82, s82, 720896
    s_cmp_eq_u32 s42, 0
    s_cselect_b32 s80, s80, 0x8000000
    s_cmp_eq_u32 s43, 0
    s_cselect_b32 s90, s81, 0x8000000
    s_cselect_b32 s92, s80, 0x8000000
    s_cselect_b32 s83, s82, 0x8000000
    v_mov_b32 v64, 0
    v_mov_b32 v65, 0
    v_mov_b32 v66, 0
    v_mov_b32 v67, 0
    v_lshlrev_b32 v68, 2, v0
    buffer_store_dwordx4 v[64:67], v1, s[24:27], s90 offen sc1
    buffer_store_dword v64, v68, s[24:27], s92 offen sc1
    s_setprio 1
    s_barrier
    ds_read_b128 a[0:3], v5 offset:0
    ds_read_b64_tr_b16 v[32:33], v2 offset:16384
    ds_read_b64_tr_b16 v[34:35], v2 offset:16640
    ds_read_b64_tr_b16 v[36:37], v2 offset:16896
    ds_read_b64_tr_b16 v[38:39], v2 offset:17152
    ds_read_b64_tr_b16 v[40:41], v2 offset:24576
    ds_read_b64_tr_b16 v[42:43], v2 offset:24832
    ds_read_b64_tr_b16 v[44:45], v2 offset:25088
    ds_read_b64_tr_b16 v[46:47], v2 offset:25344
    ds_read_b128 a[4:7], v6 offset:0
    ds_read_b128 a[8:11], v7 offset:0
    ds_read_b128 a[12:15], v8 offset:0
    s_mov_b32 exec_lo, 1
    s_mov_b32 exec_hi, 1
    buffer_store_dwordx4 v[14:17], v18, s[24:27], 0 offen sc1
    s_mov_b64 exec, -1
    s_waitcnt lgkmcnt(7)
    v_mfma_f32_32x32x16_bf16 v[64:79], a[0:3], v[32:35], 0
    ds_read_b64_tr_b16 v[48:49], v2 offset:18432
    ds_read_b64_tr_b16 v[50:51], v2 offset:18688
    v_mfma_f32_32x32x16_bf16 v[80:95], a[0:3], v[36:39], 0
    ds_read_b64_tr_b16 v[52:53], v2 offset:18944
    ds_read_b64_tr_b16 v[54:55], v2 offset:19200
    s_waitcnt lgkmcnt(7)
    v_mfma_f32_32x32x16_bf16 v[96:111], a[0:3], v[40:43], 0
    ds_read_b64_tr_b16 v[56:57], v2 offset:26624
    ds_read_b64_tr_b16 v[58:59], v2 offset:26880
    v_mfma_f32_32x32x16_bf16 v[112:127], a[0:3], v[44:47], 0
    ds_read_b64_tr_b16 v[60:61], v2 offset:27136
    ds_read_b64_tr_b16 v[62:63], v2 offset:27392
    s_waitcnt lgkmcnt(4)
    v_mfma_f32_32x32x16_bf16 v[64:79], a[4:7], v[48:51], v[64:79]
    ds_read_b64_tr_b16 v[32:33], v2 offset:20480
    ds_read_b64_tr_b16 v[34:35], v2 offset:20736
    v_mfma_f32_32x32x16_bf16 v[80:95], a[4:7], v[52:55], v[80:95]
    ds_read_b64_tr_b16 v[36:37], v2 offset:20992
    ds_read_b64_tr_b16 v[38:39], v2 offset:21248
    s_waitcnt lgkmcnt(4)
    v_mfma_f32_32x32x16_bf16 v[96:111], a[4:7], v[56:59], v[96:111]
    ds_read_b64_tr_b16 v[40:41], v2 offset:28672
    ds_read_b64_tr_b16 v[42:43], v2 offset:28928
    v_mfma_f32_32x32x16_bf16 v[112:127], a[4:7], v[60:63], v[112:127]
    ds_read_b64_tr_b16 v[44:45], v2 offset:29184
    ds_read_b64_tr_b16 v[46:47], v2 offset:29440
    s_waitcnt lgkmcnt(4)
    v_mfma_f32_32x32x16_bf16 v[64:79], a[8:11], v[32:35], v[64:79]
    ds_read_b64_tr_b16 v[48:49], v2 offset:22528
    ds_read_b64_tr_b16 v[50:51], v2 offset:22784
    v_mfma_f32_32x32x16_bf16 v[80:95], a[8:11], v[36:39], v[80:95]
    ds_read_b64_tr_b16 v[52:53], v2 offset:23040
    ds_read_b64_tr_b16 v[54:55], v2 offset:23296
    s_waitcnt lgkmcnt(4)
    v_mfma_f32_32x32x16_bf16 v[96:111], a[8:11], v[40:43], v[96:111]
    ds_read_b64_tr_b16 v[56:57], v2 offset:30720
    ds_read_b64_tr_b16 v[58:59], v2 offset:30976
    v_mfma_f32_32x32x16_bf16 v[112:127], a[8:11], v[44:47], v[112:127]
    ds_read_b64_tr_b16 v[60:61], v2 offset:31232
    ds_read_b64_tr_b16 v[62:63], v2 offset:31488
    s_waitcnt lgkmcnt(4)
    v_mfma_f32_32x32x16_bf16 v[64:79], a[12:15], v[48:51], v[64:79]
    v_mfma_f32_32x32x16_bf16 v[80:95], a[12:15], v[52:55], v[80:95]
    s_waitcnt lgkmcnt(0)
    s_barrier
    ds_read_b128 a[16:19], v5 offset:32768
    ds_read_b64_tr_b16 v[32:33], v2 offset:49152
    ds_read_b64_tr_b16 v[34:35], v2 offset:49408
    ds_read_b64_tr_b16 v[36:37], v2 offset:49664
    ds_read_b64_tr_b16 v[38:39], v2 offset:49920
    v_mfma_f32_32x32x16_bf16 v[96:111], a[12:15], v[56:59], v[96:111]
    ds_read_b64_tr_b16 v[40:41], v2 offset:57344
    ds_read_b64_tr_b16 v[42:43], v2 offset:57600
    ds_read_b64_tr_b16 v[44:45], v2 offset:57856
    ds_read_b64_tr_b16 v[46:47], v2 offset:58112
    v_mfma_f32_32x32x16_bf16 v[112:127], a[12:15], v[60:63], v[112:127]
    ds_read_b128 a[20:23], v6 offset:32768
    ds_read_b128 a[24:27], v7 offset:32768
    ds_read_b128 a[28:31], v8 offset:32768
    buffer_load_dword v24, v12, s[16:19], s74 offen
    buffer_load_dword v25, v13, s[20:23], s75 offen
    s_waitcnt lgkmcnt(7)
    v_mfma_f32_32x32x16_bf16 v[64:79], a[16:19], v[32:35], v[64:79]
    ds_read_b64_tr_b16 v[48:49], v2 offset:51200
    ds_read_b64_tr_b16 v[50:51], v2 offset:51456
    v_mfma_f32_32x32x16_bf16 v[80:95], a[16:19], v[36:39], v[80:95]
    ds_read_b64_tr_b16 v[52:53], v2 offset:51712
    ds_read_b64_tr_b16 v[54:55], v2 offset:51968
    s_waitcnt lgkmcnt(7)
    v_mfma_f32_32x32x16_bf16 v[96:111], a[16:19], v[40:43], v[96:111]
    ds_read_b64_tr_b16 v[56:57], v2 offset:59392
    ds_read_b64_tr_b16 v[58:59], v2 offset:59648
    v_mfma_f32_32x32x16_bf16 v[112:127], a[16:19], v[44:47], v[112:127]
    ds_read_b64_tr_b16 v[60:61], v2 offset:59904
    ds_read_b64_tr_b16 v[62:63], v2 offset:60160
    s_waitcnt lgkmcnt(4)
    v_mfma_f32_32x32x16_bf16 v[64:79], a[20:23], v[48:51], v[64:79]
    ds_read_b64_tr_b16 v[32:33], v2 offset:53248
    ds_read_b64_tr_b16 v[34:35], v2 offset:53504
    v_mfma_f32_32x32x16_bf16 v[80:95], a[20:23], v[52:55], v[80:95]
    ds_read_b64_tr_b16 v[36:37], v2 offset:53760
    ds_read_b64_tr_b16 v[38:39], v2 offset:54016
    s_waitcnt lgkmcnt(4)
    v_mfma_f32_32x32x16_bf16 v[96:111], a[20:23], v[56:59], v[96:111]
    ds_read_b64_tr_b16 v[40:41], v2 offset:61440
    ds_read_b64_tr_b16 v[42:43], v2 offset:61696
    v_mfma_f32_32x32x16_bf16 v[112:127], a[20:23], v[60:63], v[112:127]
    ds_read_b64_tr_b16 v[44:45], v2 offset:61952
    ds_read_b64_tr_b16 v[46:47], v2 offset:62208
    s_waitcnt lgkmcnt(4)
    v_mfma_f32_32x32x16_bf16 v[64:79], a[24:27], v[32:35], v[64:79]
    ds_read_b64_tr_b16 v[48:49], v2 offset:55296
    ds_read_b64_tr_b16 v[50:51], v2 offset:55552
    v_mfma_f32_32x32x16_bf16 v[80:95], a[24:27], v[36:39], v[80:95]
    ds_read_b64_tr_b16 v[52:53], v2 offset:55808
    ds_read_b64_tr_b16 v[54:55], v2 offset:56064
    s_waitcnt lgkmcnt(4)
    v_mfma_f32_32x32x16_bf16 v[96:111], a[24:27], v[40:43], v[96:111]
    ds_read_b64_tr_b16 v[56:57], v2 offset:63488
    ds_read_b64_tr_b16 v[58:59], v2 offset:63744
    v_mfma_f32_32x32x16_bf16 v[112:127], a[24:27], v[44:47], v[112:127]
    ds_read_b64_tr_b16 v[60:61], v2 offset:64000
    ds_read_b64_tr_b16 v[62:63], v2 offset:64256
    s_waitcnt lgkmcnt(4)
    v_mfma_f32_32x32x16_bf16 v[64:79], a[28:31], v[48:51], v[64:79]
    v_mfma_f32_32x32x16_bf16 v[80:95], a[28:31], v[52:55], v[80:95]
    s_waitcnt lgkmcnt(0)
    s_barrier
    v_add_u32 v30, 0x10000, v5
    ds_read_b128 a[32:35], v30
    ds_read_b64_tr_b16 v[32:33], v3 offset:16384
    ds_read_b64_tr_b16 v[34:35], v3 offset:16640
    ds_read_b64_tr_b16 v[36:37], v3 offset:16896
    ds_read_b64_tr_b16 v[38:39], v3 offset:17152
    v_mfma_f32_32x32x16_bf16 v[96:111], a[28:31], v[56:59], v[96:111]
    ds_read_b64_tr_b16 v[40:41], v3 offset:24576
    ds_read_b64_tr_b16 v[42:43], v3 offset:24832
    ds_read_b64_tr_b16 v[44:45], v3 offset:25088
    ds_read_b64_tr_b16 v[46:47], v3 offset:25344
    v_mfma_f32_32x32x16_bf16 v[112:127], a[28:31], v[60:63], v[112:127]
    v_add_u32 v30, 0x10000, v6
    ds_read_b128 a[36:39], v30
    v_add_u32 v30, 0x10000, v7
    ds_read_b128 a[40:43], v30
    v_add_u32 v30, 0x10000, v8
    ds_read_b128 a[44:47], v30
    s_waitcnt vmcnt(3)
    v_mov_b32 v22, s40
    s_mov_b64 exec, 1
    buffer_store_dword v22, off, s[24:27], s83 sc1
    s_mov_b64 exec, -1
    s_waitcnt lgkmcnt(7)
    v_mfma_f32_32x32x16_bf16 v[64:79], a[32:35], v[32:35], v[64:79]
    ds_read_b64_tr_b16 v[48:49], v3 offset:18432
    ds_read_b64_tr_b16 v[50:51], v3 offset:18688
    v_mfma_f32_32x32x16_bf16 v[80:95], a[32:35], v[36:39], v[80:95]
    ds_read_b64_tr_b16 v[52:53], v3 offset:18944
    ds_read_b64_tr_b16 v[54:55], v3 offset:19200
    s_waitcnt lgkmcnt(7)
    v_mfma_f32_32x32x16_bf16 v[96:111], a[32:35], v[40:43], v[96:111]
    ds_read_b64_tr_b16 v[56:57], v3 offset:26624
    ds_read_b64_tr_b16 v[58:59], v3 offset:26880
    v_mfma_f32_32x32x16_bf16 v[112:127], a[32:35], v[44:47], v[112:127]
    ds_read_b64_tr_b16 v[60:61], v3 offset:27136
    ds_read_b64_tr_b16 v[62:63], v3 offset:27392
    s_waitcnt lgkmcnt(4)
    v_mfma_f32_32x32x16_bf16 v[64:79], a[36:39], v[48:51], v[64:79]
    ds_read_b64_tr_b16 v[32:33], v3 offset:20480
    ds_read_b64_tr_b16 v[34:35], v3 offset:20736
    v_mfma_f32_32x32x16_bf16 v[80:95], a[36:39], v[52:55], v[80:95]
    ds_read_b64_tr_b16 v[36:37], v3 offset:20992
    ds_read_b64_tr_b16 v[38:39], v3 offset:21248
    s_waitcnt lgkmcnt(4)
    v_mfma_f32_32x32x16_bf16 v[96:111], a[36:39], v[56:59], v[96:111]
    ds_read_b64_tr_b16 v[40:41], v3 offset:28672
    ds_read_b64_tr_b16 v[42:43], v3 offset:28928
    v_mfma_f32_32x32x16_bf16 v[112:127], a[36:39], v[60:63], v[112:127]
    ds_read_b64_tr_b16 v[44:45], v3 offset:29184
    ds_read_b64_tr_b16 v[46:47], v3 offset:29440
    s_waitcnt lgkmcnt(4)
    v_mfma_f32_32x32x16_bf16 v[64:79], a[40:43], v[32:35], v[64:79]
    ds_read_b64_tr_b16 v[48:49], v3 offset:22528
    ds_read_b64_tr_b16 v[50:51], v3 offset:22784
    v_mfma_f32_32x32x16_bf16 v[80:95], a[40:43], v[36:39], v[80:95]
    ds_read_b64_tr_b16 v[52:53], v3 offset:23040
    ds_read_b64_tr_b16 v[54:55], v3 offset:23296
    s_waitcnt lgkmcnt(4)
    v_mfma_f32_32x32x16_bf16 v[96:111], a[40:43], v[40:43], v[96:111]
    ds_read_b64_tr_b16 v[56:57], v3 offset:30720
    ds_read_b64_tr_b16 v[58:59], v3 offset:30976
    v_mfma_f32_32x32x16_bf16 v[112:127], a[40:43], v[44:47], v[112:127]
    ds_read_b64_tr_b16 v[60:61], v3 offset:31232
    ds_read_b64_tr_b16 v[62:63], v3 offset:31488
    s_waitcnt lgkmcnt(4)
    v_mfma_f32_32x32x16_bf16 v[64:79], a[44:47], v[48:51], v[64:79]
    v_mfma_f32_32x32x16_bf16 v[80:95], a[44:47], v[52:55], v[80:95]
    s_waitcnt lgkmcnt(0)
    s_barrier
    ds_read_b128 a[48:51], v5 offset:0
    ds_read_b64_tr_b16 v[32:33], v2 offset:16384
    ds_read_b64_tr_b16 v[34:35], v2 offset:16640
    ds_read_b64_tr_b16 v[36:37], v2 offset:16896
    ds_read_b64_tr_b16 v[38:39], v2 offset:17152
    v_mfma_f32_32x32x16_bf16 v[96:111], a[44:47], v[56:59], v[96:111]
    ds_read_b64_tr_b16 v[40:41], v2 offset:24576
    ds_read_b64_tr_b16 v[42:43], v2 offset:24832
    ds_read_b64_tr_b16 v[44:45], v2 offset:25088
    ds_read_b64_tr_b16 v[46:47], v2 offset:25344
    v_mfma_f32_32x32x16_bf16 v[112:127], a[44:47], v[60:63], v[112:127]
    ds_read_b128 a[52:55], v6 offset:0
    ds_read_b128 a[56:59], v7 offset:0
    ds_read_b128 a[60:63], v8 offset:0
    s_waitcnt lgkmcnt(7)
    v_mfma_f32_32x32x16_bf16 v[64:79], a[48:51], v[32:35], v[64:79]
    ds_read_b64_tr_b16 v[48:49], v2 offset:18432
    ds_read_b64_tr_b16 v[50:51], v2 offset:18688
    buffer_load_dwordx4 v[18:21], v31, s[24:27], s101 offen sc1
    v_mfma_f32_32x32x16_bf16 v[80:95], a[48:51], v[36:39], v[80:95]
    ds_read_b64_tr_b16 v[52:53], v2 offset:18944
    ds_read_b64_tr_b16 v[54:55], v2 offset:19200
    s_waitcnt lgkmcnt(7)
    v_mfma_f32_32x32x16_bf16 v[96:111], a[48:51], v[40:43], v[96:111]
    ds_read_b64_tr_b16 v[56:57], v2 offset:26624
    ds_read_b64_tr_b16 v[58:59], v2 offset:26880
    v_mfma_f32_32x32x16_bf16 v[112:127], a[48:51], v[44:47], v[112:127]
    ds_read_b64_tr_b16 v[60:61], v2 offset:27136
    ds_read_b64_tr_b16 v[62:63], v2 offset:27392
    s_waitcnt lgkmcnt(4)
    v_mfma_f32_32x32x16_bf16 v[64:79], a[52:55], v[48:51], v[64:79]
    ds_read_b64_tr_b16 v[32:33], v2 offset:20480
    ds_read_b64_tr_b16 v[34:35], v2 offset:20736
    v_mfma_f32_32x32x16_bf16 v[80:95], a[52:55], v[52:55], v[80:95]
    ds_read_b64_tr_b16 v[36:37], v2 offset:20992
    ds_read_b64_tr_b16 v[38:39], v2 offset:21248
    s_waitcnt lgkmcnt(4)
    v_mfma_f32_32x32x16_bf16 v[96:111], a[52:55], v[56:59], v[96:111]
    ds_read_b64_tr_b16 v[40:41], v2 offset:28672
    ds_read_b64_tr_b16 v[42:43], v2 offset:28928
    v_mfma_f32_32x32x16_bf16 v[112:127], a[52:55], v[60:63], v[112:127]
    ds_read_b64_tr_b16 v[44:45], v2 offset:29184
    ds_read_b64_tr_b16 v[46:47], v2 offset:29440
    s_waitcnt lgkmcnt(4)
    v_mfma_f32_32x32x16_bf16 v[64:79], a[56:59], v[32:35], v[64:79]
    ds_read_b64_tr_b16 v[48:49], v2 offset:22528
    ds_read_b64_tr_b16 v[50:51], v2 offset:22784
    v_mfma_f32_32x32x16_bf16 v[80:95], a[56:59], v[36:39], v[80:95]
    ds_read_b64_tr_b16 v[52:53], v2 offset:23040
    ds_read_b64_tr_b16 v[54:55], v2 offset:23296
    s_waitcnt lgkmcnt(4)
    v_mfma_f32_32x32x16_bf16 v[96:111], a[56:59], v[40:43], v[96:111]
    ds_read_b64_tr_b16 v[56:57], v2 offset:30720
    ds_read_b64_tr_b16 v[58:59], v2 offset:30976
    v_mfma_f32_32x32x16_bf16 v[112:127], a[56:59], v[44:47], v[112:127]
    ds_read_b64_tr_b16 v[60:61], v2 offset:31232
    ds_read_b64_tr_b16 v[62:63], v2 offset:31488
    s_waitcnt lgkmcnt(4)
    v_mfma_f32_32x32x16_bf16 v[64:79], a[60:63], v[48:51], v[64:79]
    v_mfma_f32_32x32x16_bf16 v[80:95], a[60:63], v[52:55], v[80:95]
    s_waitcnt lgkmcnt(0)
    s_barrier
    ds_read_b128 a[64:67], v5 offset:32768
    ds_read_b64_tr_b16 v[32:33], v2 offset:49152
    ds_read_b64_tr_b16 v[34:35], v2 offset:49408
    ds_read_b64_tr_b16 v[36:37], v2 offset:49664
    ds_read_b64_tr_b16 v[38:39], v2 offset:49920
    v_mfma_f32_32x32x16_bf16 v[96:111], a[60:63], v[56:59], v[96:111]
    ds_read_b64_tr_b16 v[40:41], v2 offset:57344
    ds_read_b64_tr_b16 v[42:43], v2 offset:57600
    ds_read_b64_tr_b16 v[44:45], v2 offset:57856
    ds_read_b64_tr_b16 v[46:47], v2 offset:58112
    v_mfma_f32_32x32x16_bf16 v[112:127], a[60:63], v[60:63], v[112:127]
    ds_read_b128 a[68:71], v6 offset:32768
    ds_read_b128 a[72:75], v7 offset:32768
    ds_read_b128 a[76:79], v8 offset:32768
    s_waitcnt lgkmcnt(7)
    v_mfma_f32_32x32x16_bf16 v[64:79], a[64:67], v[32:35], v[64:79]
    ds_read_b64_tr_b16 v[48:49], v2 offset:51200
    ds_read_b64_tr_b16 v[50:51], v2 offset:51456
    v_mfma_f32_32x32x16_bf16 v[80:95], a[64:67], v[36:39], v[80:95]
    ds_read_b64_tr_b16 v[52:53], v2 offset:51712
    ds_read_b64_tr_b16 v[54:55], v2 offset:51968
    s_waitcnt lgkmcnt(7)
    v_mfma_f32_32x32x16_bf16 v[96:111], a[64:67], v[40:43], v[96:111]
    ds_read_b64_tr_b16 v[56:57], v2 offset:59392
    ds_read_b64_tr_b16 v[58:59], v2 offset:59648
    v_mfma_f32_32x32x16_bf16 v[112:127], a[64:67], v[44:47], v[112:127]
    ds_read_b64_tr_b16 v[60:61], v2 offset:59904
    ds_read_b64_tr_b16 v[62:63], v2 offset:60160
    s_waitcnt lgkmcnt(4)
    v_mfma_f32_32x32x16_bf16 v[64:79], a[68:71], v[48:51], v[64:79]
    ds_read_b64_tr_b16 v[32:33], v2 offset:53248
    ds_read_b64_tr_b16 v[34:35], v2 offset:53504
    v_mfma_f32_32x32x16_bf16 v[80:95], a[68:71], v[52:55], v[80:95]
    ds_read_b64_tr_b16 v[36:37], v2 offset:53760
    ds_read_b64_tr_b16 v[38:39], v2 offset:54016
    s_waitcnt lgkmcnt(4)
    v_mfma_f32_32x32x16_bf16 v[96:111], a[68:71], v[56:59], v[96:111]
    ds_read_b64_tr_b16 v[40:41], v2 offset:61440
    ds_read_b64_tr_b16 v[42:43], v2 offset:61696
    v_mfma_f32_32x32x16_bf16 v[112:127], a[68:71], v[60:63], v[112:127]
    ds_read_b64_tr_b16 v[44:45], v2 offset:61952
    ds_read_b64_tr_b16 v[46:47], v2 offset:62208
    s_waitcnt lgkmcnt(4)
    v_mfma_f32_32x32x16_bf16 v[64:79], a[72:75], v[32:35], v[64:79]
    ds_read_b64_tr_b16 v[48:49], v2 offset:55296
    ds_read_b64_tr_b16 v[50:51], v2 offset:55552
    v_mfma_f32_32x32x16_bf16 v[80:95], a[72:75], v[36:39], v[80:95]
    ds_read_b64_tr_b16 v[52:53], v2 offset:55808
    ds_read_b64_tr_b16 v[54:55], v2 offset:56064
    s_waitcnt lgkmcnt(4)
    v_mfma_f32_32x32x16_bf16 v[96:111], a[72:75], v[40:43], v[96:111]
    ds_read_b64_tr_b16 v[56:57], v2 offset:63488
    ds_read_b64_tr_b16 v[58:59], v2 offset:63744
    v_mfma_f32_32x32x16_bf16 v[112:127], a[72:75], v[44:47], v[112:127]
    ds_read_b64_tr_b16 v[60:61], v2 offset:64000
    ds_read_b64_tr_b16 v[62:63], v2 offset:64256
    s_waitcnt lgkmcnt(4)
    v_mfma_f32_32x32x16_bf16 v[64:79], a[76:79], v[48:51], v[64:79]
    v_mfma_f32_32x32x16_bf16 v[80:95], a[76:79], v[52:55], v[80:95]
    s_waitcnt lgkmcnt(0)
    s_barrier
    v_add_u32 v30, 0x10000, v5
    ds_read_b128 a[80:83], v30
    ds_read_b64_tr_b16 v[32:33], v3 offset:16384
    ds_read_b64_tr_b16 v[34:35], v3 offset:16640
    ds_read_b64_tr_b16 v[36:37], v3 offset:16896
    ds_read_b64_tr_b16 v[38:39], v3 offset:17152
    v_mfma_f32_32x32x16_bf16 v[96:111], a[76:79], v[56:59], v[96:111]
    ds_read_b64_tr_b16 v[40:41], v3 offset:24576
    ds_read_b64_tr_b16 v[42:43], v3 offset:24832
    ds_read_b64_tr_b16 v[44:45], v3 offset:25088
    ds_read_b64_tr_b16 v[46:47], v3 offset:25344
    v_mfma_f32_32x32x16_bf16 v[112:127], a[76:79], v[60:63], v[112:127]
    v_add_u32 v30, 0x10000, v6
    ds_read_b128 a[84:87], v30
    v_add_u32 v30, 0x10000, v7
    ds_read_b128 a[88:91], v30
    v_add_u32 v30, 0x10000, v8
    ds_read_b128 a[92:95], v30
    s_waitcnt lgkmcnt(7)
    v_mfma_f32_32x32x16_bf16 v[64:79], a[80:83], v[32:35], v[64:79]
    ds_read_b64_tr_b16 v[48:49], v3 offset:18432
    ds_read_b64_tr_b16 v[50:51], v3 offset:18688
    v_mfma_f32_32x32x16_bf16 v[80:95], a[80:83], v[36:39], v[80:95]
    ds_read_b64_tr_b16 v[52:53], v3 offset:18944
    ds_read_b64_tr_b16 v[54:55], v3 offset:19200
    s_waitcnt vmcnt(0)
    v_xor_b32 v20, s40, v20
    v_xor_b32 v21, s41, v21
    v_or_b32 v20, v20, v21
    v_cmp_ne_u32 vcc, 0, v20
    s_nop 1
    s_cbranch_vccnz L_slow_st17
L_ret_st18:
    s_waitcnt lgkmcnt(7)
    v_mfma_f32_32x32x16_bf16 v[96:111], a[80:83], v[40:43], v[96:111]
    ds_read_b64_tr_b16 v[56:57], v3 offset:26624
    ds_read_b64_tr_b16 v[58:59], v3 offset:26880
    v_rcp_f32 v22, v19
    v_mfma_f32_32x32x16_bf16 v[112:127], a[80:83], v[44:47], v[112:127]
    ds_read_b64_tr_b16 v[60:61], v3 offset:27136
    ds_read_b64_tr_b16 v[62:63], v3 offset:27392
    v_mov_b32 v15, v19
    v_mov_b32 v13, 0
    v_sub_f32 v18, 0, v18
    s_waitcnt lgkmcnt(4)
    v_mfma_f32_32x32x16_bf16 v[64:79], a[84:87], v[48:51], v[64:79]
    ds_read_b64_tr_b16 v[32:33], v3 offset:20480
    ds_read_b64_tr_b16 v[34:35], v3 offset:20736
    v_mul_f32 v14, 0xc0135761, v22
    v_mul_f32_e64 v23, v22, v22
    v_mfma_f32_32x32x16_bf16 v[80:95], a[84:87], v[52:55], v[80:95]
    ds_read_b64_tr_b16 v[36:37], v3 offset:20992
    ds_read_b64_tr_b16 v[38:39], v3 offset:21248
    v_mul_f32 v17, 0x3fb8aa3b, v22
    v_mul_f32 v23, v23, v22
    v_mul_f32 v16, 0xbdd2d3e8, v23
    s_waitcnt lgkmcnt(4)
    v_mfma_f32_32x32x16_bf16 v[96:111], a[84:87], v[56:59], v[96:111]
    ds_read_b64_tr_b16 v[40:41], v3 offset:28672
    ds_read_b64_tr_b16 v[42:43], v3 offset:28928
    v_cndmask_b32 v23, v17, v22, s[96:97]
    v_mfma_f32_32x32x16_bf16 v[112:127], a[84:87], v[60:63], v[112:127]
    ds_read_b64_tr_b16 v[44:45], v3 offset:29184
    ds_read_b64_tr_b16 v[46:47], v3 offset:29440
    s_lshl_b32 s90, s42, 8
    s_add_u32 s90, s90, 151552
    v_lshlrev_b32 v24, 2, v0
    v_add_u32 v24, s90, v24
    s_waitcnt lgkmcnt(4)
    v_mfma_f32_32x32x16_bf16 v[64:79], a[88:91], v[32:35], v[64:79]
    ds_read_b64_tr_b16 v[48:49], v3 offset:22528
    ds_read_b64_tr_b16 v[50:51], v3 offset:22784
    ds_write_b32 v24, v23
    v_cvt_pk_bf16_f32 v20, v19, v13
    v_mfma_f32_32x32x16_bf16 v[80:95], a[88:91], v[36:39], v[80:95]
    ds_read_b64_tr_b16 v[52:53], v3 offset:23040
    ds_read_b64_tr_b16 v[54:55], v3 offset:23296
    v_cvt_pk_bf16_f32 v11, v18, v18
    v_lshlrev_b32 v20, 16, v20
    v_lshlrev_b32 v21, 16, v11
    s_waitcnt lgkmcnt(5)
    v_mfma_f32_32x32x16_bf16 v[96:111], a[88:91], v[40:43], v[96:111]
    ds_read_b64_tr_b16 v[56:57], v3 offset:30720
    ds_read_b64_tr_b16 v[58:59], v3 offset:30976
    v_sub_f32 v20, v19, v20
    v_sub_f32_e64 v21, v18, v21
    v_mfma_f32_32x32x16_bf16 v[112:127], a[88:91], v[44:47], v[112:127]
    ds_read_b64_tr_b16 v[60:61], v3 offset:31232
    ds_read_b64_tr_b16 v[62:63], v3 offset:31488
    v_cvt_pk_bf16_f32 v10, v19, v20
    v_cvt_pk_bf16_f32 v12, v21, v13
    v_cndmask_b32 v10, v10, v13, s[96:97]
    s_waitcnt lgkmcnt(4)
    v_mfma_f32_32x32x16_bf16 v[64:79], a[92:95], v[48:51], v[64:79]
    v_cndmask_b32 v11, v11, v13, s[96:97]
    v_cndmask_b32 v12, v12, v13, s[96:97]
    v_mfma_f32_32x32x16_bf16 v[80:95], a[92:95], v[52:55], v[80:95]
    s_waitcnt lgkmcnt(0)
    s_barrier
    ds_read_b128 a[96:99], v5 offset:0
    ds_read_b64_tr_b16 v[32:33], v2 offset:16384
    ds_read_b64_tr_b16 v[34:35], v2 offset:16640
    ds_read_b64_tr_b16 v[36:37], v2 offset:16896
    ds_read_b64_tr_b16 v[38:39], v2 offset:17152
    v_mfma_f32_32x32x16_bf16 v[96:111], a[92:95], v[56:59], v[96:111]
    ds_read_b64_tr_b16 v[40:41], v2 offset:24576
    ds_read_b64_tr_b16 v[42:43], v2 offset:24832
    ds_read_b64_tr_b16 v[44:45], v2 offset:25088
    ds_read_b64_tr_b16 v[46:47], v2 offset:25344
    v_mfma_f32_32x32x16_bf16 v[112:127], a[92:95], v[60:63], v[112:127]
    ds_read_b128 a[100:103], v6 offset:0
    ds_read_b128 a[104:107], v7 offset:0
    ds_read_b128 a[108:111], v8 offset:0
    buffer_load_dword v29, off, s[24:27], s82 sc1
    s_waitcnt lgkmcnt(7)
    v_mfma_f32_32x32x16_bf16 v[64:79], a[96:99], v[32:35], v[64:79]
    ds_read_b64_tr_b16 v[48:49], v2 offset:18432
    ds_read_b64_tr_b16 v[50:51], v2 offset:18688
    v_mfma_f32_32x32x16_bf16 v[80:95], a[96:99], v[36:39], v[80:95]
    ds_read_b64_tr_b16 v[52:53], v2 offset:18944
    ds_read_b64_tr_b16 v[54:55], v2 offset:19200
    s_waitcnt lgkmcnt(7)
    v_mfma_f32_32x32x16_bf16 v[96:111], a[96:99], v[40:43], v[96:111]
    ds_read_b64_tr_b16 v[56:57], v2 offset:26624
    ds_read_b64_tr_b16 v[58:59], v2 offset:26880
    v_mfma_f32_32x32x16_bf16 v[112:127], a[96:99], v[44:47], v[112:127]
    ds_read_b64_tr_b16 v[60:61], v2 offset:27136
    ds_read_b64_tr_b16 v[62:63], v2 offset:27392
    s_waitcnt lgkmcnt(4)
    v_mfma_f32_32x32x16_bf16 v[64:79], a[100:103], v[48:51], v[64:79]
    ds_read_b64_tr_b16 v[32:33], v2 offset:20480
    ds_read_b64_tr_b16 v[34:35], v2 offset:20736
    v_mfma_f32_32x32x16_bf16 v[80:95], a[100:103], v[52:55], v[80:95]
    ds_read_b64_tr_b16 v[36:37], v2 offset:20992
    ds_read_b64_tr_b16 v[38:39], v2 offset:21248
    s_waitcnt lgkmcnt(4)
    v_mfma_f32_32x32x16_bf16 v[96:111], a[100:103], v[56:59], v[96:111]
    ds_read_b64_tr_b16 v[40:41], v2 offset:28672
    ds_read_b64_tr_b16 v[42:43], v2 offset:28928
    v_mfma_f32_32x32x16_bf16 v[112:127], a[100:103], v[60:63], v[112:127]
    ds_read_b64_tr_b16 v[44:45], v2 offset:29184
    ds_read_b64_tr_b16 v[46:47], v2 offset:29440
    s_waitcnt lgkmcnt(4)
    v_mfma_f32_32x32x16_bf16 v[64:79], a[104:107], v[32:35], v[64:79]
    ds_read_b64_tr_b16 v[48:49], v2 offset:22528
    ds_read_b64_tr_b16 v[50:51], v2 offset:22784
    v_mfma_f32_32x32x16_bf16 v[80:95], a[104:107], v[36:39], v[80:95]
    ds_read_b64_tr_b16 v[52:53], v2 offset:23040
    ds_read_b64_tr_b16 v[54:55], v2 offset:23296
    s_waitcnt lgkmcnt(4)
    v_mfma_f32_32x32x16_bf16 v[96:111], a[104:107], v[40:43], v[96:111]
    ds_read_b64_tr_b16 v[56:57], v2 offset:30720
    ds_read_b64_tr_b16 v[58:59], v2 offset:30976
    v_mfma_f32_32x32x16_bf16 v[112:127], a[104:107], v[44:47], v[112:127]
    ds_read_b64_tr_b16 v[60:61], v2 offset:31232
    ds_read_b64_tr_b16 v[62:63], v2 offset:31488
    s_waitcnt lgkmcnt(4)
    v_mfma_f32_32x32x16_bf16 v[64:79], a[108:111], v[48:51], v[64:79]
    v_mfma_f32_32x32x16_bf16 v[80:95], a[108:111], v[52:55], v[80:95]
    s_waitcnt lgkmcnt(0)
    s_barrier
    ds_read_b128 a[112:115], v5 offset:32768
    ds_read_b64_tr_b16 v[32:33], v2 offset:49152
    ds_read_b64_tr_b16 v[34:35], v2 offset:49408
    ds_read_b64_tr_b16 v[36:37], v2 offset:49664
    ds_read_b64_tr_b16 v[38:39], v2 offset:49920
    v_mfma_f32_32x32x16_bf16 v[96:111], a[108:111], v[56:59], v[96:111]
    ds_read_b64_tr_b16 v[40:41], v2 offset:57344
    ds_read_b64_tr_b16 v[42:43], v2 offset:57600
    ds_read_b64_tr_b16 v[44:45], v2 offset:57856
    ds_read_b64_tr_b16 v[46:47], v2 offset:58112
    v_mfma_f32_32x32x16_bf16 v[112:127], a[108:111], v[60:63], v[112:127]
    ds_read_b128 a[116:119], v6 offset:32768
    ds_read_b128 a[120:123], v7 offset:32768
    ds_read_b128 a[124:127], v8 offset:32768
    s_waitcnt lgkmcnt(7)
    v_mfma_f32_32x32x16_bf16 v[64:79], a[112:115], v[32:35], v[64:79]
    ds_read_b64_tr_b16 v[48:49], v2 offset:51200
    ds_read_b64_tr_b16 v[50:51], v2 offset:51456
    v_mfma_f32_32x32x16_bf16 v[80:95], a[112:115], v[36:39], v[80:95]
    ds_read_b64_tr_b16 v[52:53], v2 offset:51712
    ds_read_b64_tr_b16 v[54:55], v2 offset:51968
    s_waitcnt lgkmcnt(7)
    v_mfma_f32_32x32x16_bf16 v[96:111], a[112:115], v[40:43], v[96:111]
    ds_read_b64_tr_b16 v[56:57], v2 offset:59392
    ds_read_b64_tr_b16 v[58:59], v2 offset:59648
    v_mfma_f32_32x32x16_bf16 v[112:127], a[112:115], v[44:47], v[112:127]
    ds_read_b64_tr_b16 v[60:61], v2 offset:59904
    ds_read_b64_tr_b16 v[62:63], v2 offset:60160
    s_waitcnt lgkmcnt(4)
    v_mfma_f32_32x32x16_bf16 v[64:79], a[116:119], v[48:51], v[64:79]
    ds_read_b64_tr_b16 v[32:33], v2 offset:53248
    ds_read_b64_tr_b16 v[34:35], v2 offset:53504
    v_mfma_f32_32x32x16_bf16 v[80:95], a[116:119], v[52:55], v[80:95]
    ds_read_b64_tr_b16 v[36:37], v2 offset:53760
    ds_read_b64_tr_b16 v[38:39], v2 offset:54016
    v_mov_b32 v6, v15
    v_mov_b32 v7, v15
    v_mov_b32 v8, v17
    v_mov_b32 v15, v14
    v_mov_b32 v17, v16
    s_mov_b32 s70, 0x3f317218
    s_mov_b32 s71, 0x3f317218
    s_mov_b32 s72, 0x358637bd
    s_mov_b32 s73, 0x358637bd
    s_mov_b32 s76, 0xbfb8aa3b
    s_mov_b32 s77, 0xbfb8aa3b
    s_mov_b32 s78, 1.0
    s_mov_b32 s79, 1.0
    s_waitcnt lgkmcnt(4)
    v_mfma_f32_32x32x16_bf16 v[96:111], a[116:119], v[56:59], v[96:111]
    ds_read_b64_tr_b16 v[40:41], v2 offset:61440
    ds_read_b64_tr_b16 v[42:43], v2 offset:61696
    v_mfma_f32_32x32x16_bf16 v[112:127], a[116:119], v[60:63], v[112:127]
    ds_read_b64_tr_b16 v[44:45], v2 offset:61952
    ds_read_b64_tr_b16 v[46:47], v2 offset:62208
    s_waitcnt lgkmcnt(4)
    v_mfma_f32_32x32x16_bf16 v[64:79], a[120:123], v[32:35], v[64:79]
    ds_read_b64_tr_b16 v[48:49], v2 offset:55296
    ds_read_b64_tr_b16 v[50:51], v2 offset:55552
    v_mfma_f32_32x32x16_bf16 v[80:95], a[120:123], v[36:39], v[80:95]
    ds_read_b64_tr_b16 v[52:53], v2 offset:55808
    ds_read_b64_tr_b16 v[54:55], v2 offset:56064
    s_waitcnt lgkmcnt(4)
    v_mfma_f32_32x32x16_bf16 v[96:111], a[120:123], v[40:43], v[96:111]
    ds_read_b64_tr_b16 v[56:57], v2 offset:63488
    ds_read_b64_tr_b16 v[58:59], v2 offset:63744
    v_mfma_f32_32x32x16_bf16 v[112:127], a[120:123], v[44:47], v[112:127]
    ds_read_b64_tr_b16 v[60:61], v2 offset:64000
    ds_read_b64_tr_b16 v[62:63], v2 offset:64256
    s_waitcnt lgkmcnt(4)
    v_mfma_f32_32x32x16_bf16 v[64:79], a[124:127], v[48:51], v[64:79]
    v_mfma_f32_32x32x16_bf16 v[80:95], a[124:127], v[52:55], v[80:95]
    s_waitcnt lgkmcnt(0)
    s_barrier
    ds_read_b128 v[32:35], v9 offset:0
    ds_read_b128 v[36:39], v9 offset:512
    ds_read_b128 v[40:43], v9 offset:1024
    ds_read_b128 v[44:47], v9 offset:1536
    v_mfma_f32_32x32x16_bf16 v[96:111], a[124:127], v[56:59], v[96:111]
    v_mfma_f32_32x32x16_bf16 v[112:127], a[124:127], v[60:63], v[112:127]
    s_lshl_b32 s92, s42, 8
    s_add_u32 s92, s92, 151552
    v_lshrrev_b32 v31, 5, v0
    v_lshlrev_b32 v31, 4, v31
    v_add_u32 v31, s92, v31
    s_waitcnt lgkmcnt(3)
    v_mfma_f32_32x32x16_bf16 v[64:79], v[10:13], v[32:35], v[64:79]
    s_waitcnt lgkmcnt(2)
    v_mfma_f32_32x32x16_bf16 v[80:95], v[10:13], v[36:39], v[80:95]
    ds_read_b128 v[48:51], v31 offset:0
    ds_read_b128 v[52:55], v31 offset:32
    ds_read_b128 v[56:59], v31 offset:64
    ds_read_b128 v[60:63], v31 offset:96
    s_waitcnt lgkmcnt(5)
    v_mfma_f32_32x32x16_bf16 v[96:111], v[10:13], v[40:43], v[96:111]
    s_waitcnt lgkmcnt(4)
    v_mfma_f32_32x32x16_bf16 v[112:127], v[10:13], v[44:47], v[112:127]
    ds_read_b128 v[32:35], v31 offset:128
    ds_read_b128 v[36:39], v31 offset:160
    ds_read_b128 v[40:43], v31 offset:192
    ds_read_b128 v[44:47], v31 offset:224
    s_add_u32 s92, s62, 32768
    v_add_u32 v31, s92, v1
    s_mul_i32 s92, s42, 2304
    s_add_u32 s92, s92, 153600
    v_lshlrev_b32 v5, 2, v0
    v_add_u32 v8, s92, v5
    s_waitcnt vmcnt(0)
    v_subrev_u32_e64 v29, s40, v29
    v_cmp_lt_u32 vcc, 15, v29
    s_nop 1
    s_cbranch_vccnz L_slow_init19
L_ret_init20:
    s_waitcnt lgkmcnt(7)
    v_pk_mul_f32 v[64:65], v[64:65], v[48:49]
    v_pk_mul_f32 v[66:67], v[66:67], v[50:51]
    s_waitcnt lgkmcnt(6)
    v_pk_mul_f32 v[68:69], v[68:69], v[52:53]
    v_pk_mul_f32 v[70:71], v[70:71], v[54:55]
    v_exp_f32_e64 v18, v64 clamp
    v_exp_f32_e64 v19, v65 clamp
    v_exp_f32_e64 v20, v66 clamp
    v_exp_f32_e64 v21, v67 clamp
    v_exp_f32_e64 v22, v68 clamp
    v_exp_f32_e64 v23, v69 clamp
    v_exp_f32_e64 v24, v70 clamp
    v_exp_f32_e64 v25, v71 clamp
    v_max_f32 v64, 0, v64
    v_max_f32 v65, 0, v65
    v_max_f32 v66, 0, v66
    v_max_f32 v67, 0, v67
    v_max_f32 v68, 0, v68
    v_max_f32 v69, 0, v69
    v_max_f32 v70, 0, v70
    v_max_f32_e64 v71, 0, v71
    v_pk_add_f32 v[18:19], v[18:19], s[72:73]
    v_pk_add_f32 v[20:21], v[20:21], s[72:73]
    v_pk_add_f32 v[22:23], v[22:23], s[72:73]
    v_pk_add_f32 v[24:25], v[24:25], s[72:73]
    v_pk_fma_f32 v[18:19], v[64:65], s[70:71], v[18:19]
    v_pk_fma_f32 v[20:21], v[66:67], s[70:71], v[20:21]
    v_pk_fma_f32 v[22:23], v[68:69], s[70:71], v[22:23]
    v_pk_fma_f32 v[24:25], v[70:71], s[70:71], v[24:25]
    v_cvt_pk_bf16_f32 v64, v18, v19
    v_cvt_pk_bf16_f32 v65, v20, v21
    v_cvt_pk_bf16_f32 v66, v22, v23
    v_cvt_pk_bf16_f32 v67, v24, v25
    s_waitcnt lgkmcnt(5)
    v_pk_mul_f32 v[72:73], v[72:73], v[56:57]
    v_pk_mul_f32 v[74:75], v[74:75], v[58:59]
    s_waitcnt lgkmcnt(4)
    v_pk_mul_f32 v[76:77], v[76:77], v[60:61]
    v_pk_mul_f32 v[78:79], v[78:79], v[62:63]
    v_exp_f32_e64 v18, v72 clamp
    v_exp_f32_e64 v19, v73 clamp
    v_exp_f32_e64 v20, v74 clamp
    v_exp_f32_e64 v21, v75 clamp
    v_exp_f32_e64 v22, v76 clamp
    v_exp_f32_e64 v23, v77 clamp
    v_exp_f32_e64 v24, v78 clamp
    v_exp_f32_e64 v25, v79 clamp
    v_max_f32 v72, 0, v72
    v_max_f32 v73, 0, v73
    v_max_f32 v74, 0, v74
    v_max_f32 v75, 0, v75
    v_max_f32 v76, 0, v76
    v_max_f32 v77, 0, v77
    v_max_f32 v78, 0, v78
    v_max_f32 v79, 0, v79
    v_pk_add_f32 v[18:19], v[18:19], s[72:73]
    v_pk_add_f32 v[20:21], v[20:21], s[72:73]
    v_pk_add_f32 v[22:23], v[22:23], s[72:73]
    v_pk_add_f32 v[24:25], v[24:25], s[72:73]
    v_pk_fma_f32 v[18:19], v[72:73], s[70:71], v[18:19]
    v_pk_fma_f32 v[20:21], v[74:75], s[70:71], v[20:21]
    v_pk_fma_f32 v[22:23], v[76:77], s[70:71], v[22:23]
    v_pk_fma_f32 v[24:25], v[78:79], s[70:71], v[24:25]
    v_cvt_pk_bf16_f32 v72, v18, v19
    v_cvt_pk_bf16_f32 v73, v20, v21
    v_cvt_pk_bf16_f32 v74, v22, v23
    v_cvt_pk_bf16_f32 v75, v24, v25
    v_pk_mul_f32 v[80:81], v[80:81], v[48:49]
    v_pk_mul_f32 v[82:83], v[82:83], v[50:51]
    v_pk_mul_f32 v[84:85], v[84:85], v[52:53]
    v_pk_mul_f32 v[86:87], v[86:87], v[54:55]
    v_exp_f32_e64 v18, v80 clamp
    v_exp_f32_e64 v19, v81 clamp
    v_exp_f32_e64 v20, v82 clamp
    v_exp_f32_e64 v21, v83 clamp
    v_exp_f32_e64 v22, v84 clamp
    v_exp_f32_e64 v23, v85 clamp
    v_exp_f32_e64 v24, v86 clamp
    v_exp_f32_e64 v25, v87 clamp
    v_max_f32 v80, 0, v80
    v_max_f32 v81, 0, v81
    v_max_f32 v82, 0, v82
    v_max_f32 v83, 0, v83
    v_max_f32 v84, 0, v84
    v_max_f32 v85, 0, v85
    v_max_f32 v86, 0, v86
    v_max_f32 v87, 0, v87
    v_pk_add_f32 v[18:19], v[18:19], s[72:73]
    v_pk_add_f32 v[20:21], v[20:21], s[72:73]
    v_pk_add_f32 v[22:23], v[22:23], s[72:73]
    v_pk_add_f32 v[24:25], v[24:25], s[72:73]
    v_pk_fma_f32 v[18:19], v[80:81], s[70:71], v[18:19]
    v_pk_fma_f32 v[20:21], v[82:83], s[70:71], v[20:21]
    v_pk_fma_f32 v[22:23], v[84:85], s[70:71], v[22:23]
    v_pk_fma_f32 v[24:25], v[86:87], s[70:71], v[24:25]
    v_cvt_pk_bf16_f32 v80, v18, v19
    v_cvt_pk_bf16_f32 v81, v20, v21
    v_cvt_pk_bf16_f32 v82, v22, v23
    v_cvt_pk_bf16_f32 v83, v24, v25
    v_pk_mul_f32 v[88:89], v[88:89], v[56:57]
    v_pk_mul_f32 v[90:91], v[90:91], v[58:59]
    v_pk_mul_f32 v[92:93], v[92:93], v[60:61]
    v_pk_mul_f32 v[94:95], v[94:95], v[62:63]
    v_exp_f32_e64 v18, v88 clamp
    v_exp_f32_e64 v19, v89 clamp
    v_exp_f32_e64 v20, v90 clamp
    v_exp_f32_e64 v21, v91 clamp
    v_exp_f32_e64 v22, v92 clamp
    v_exp_f32_e64 v23, v93 clamp
    v_exp_f32_e64 v24, v94 clamp
    v_exp_f32_e64 v25, v95 clamp
    v_max_f32 v88, 0, v88
    v_max_f32 v89, 0, v89
    v_max_f32 v90, 0, v90
    v_max_f32 v91, 0, v91
    v_max_f32 v92, 0, v92
    v_max_f32 v93, 0, v93
    v_max_f32 v94, 0, v94
    v_max_f32 v95, 0, v95
    v_pk_add_f32 v[18:19], v[18:19], s[72:73]
    v_pk_add_f32 v[20:21], v[20:21], s[72:73]
    v_pk_add_f32 v[22:23], v[22:23], s[72:73]
    v_pk_add_f32 v[24:25], v[24:25], s[72:73]
    v_pk_fma_f32 v[18:19], v[88:89], s[70:71], v[18:19]
    v_pk_fma_f32 v[20:21], v[90:91], s[70:71], v[20:21]
    v_pk_fma_f32 v[22:23], v[92:93], s[70:71], v[22:23]
    v_pk_fma_f32 v[24:25], v[94:95], s[70:71], v[24:25]
    v_cvt_pk_bf16_f32 v88, v18, v19
    v_cvt_pk_bf16_f32 v89, v20, v21
    v_cvt_pk_bf16_f32 v90, v22, v23
    v_cvt_pk_bf16_f32 v91, v24, v25
    s_waitcnt lgkmcnt(3)
    v_pk_mul_f32 v[96:97], v[96:97], v[32:33]
    v_pk_mul_f32 v[98:99], v[98:99], v[34:35]
    s_waitcnt lgkmcnt(2)
    v_pk_mul_f32 v[100:101], v[100:101], v[36:37]
    v_pk_mul_f32 v[102:103], v[102:103], v[38:39]
    s_waitcnt lgkmcnt(1)
    v_pk_mul_f32 v[104:105], v[104:105], v[40:41]
    v_pk_mul_f32 v[106:107], v[106:107], v[42:43]
    s_waitcnt lgkmcnt(0)
    v_pk_mul_f32 v[108:109], v[108:109], v[44:45]
    v_pk_mul_f32 v[110:111], v[110:111], v[46:47]
    v_cvt_pk_bf16_f32 v96, v96, v97
    v_cvt_pk_bf16_f32 v97, v98, v99
    v_cvt_pk_bf16_f32 v98, v100, v101
    v_cvt_pk_bf16_f32 v99, v102, v103
    v_cvt_pk_bf16_f32 v104, v104, v105
    v_cvt_pk_bf16_f32 v105, v106, v107
    v_cvt_pk_bf16_f32 v106, v108, v109
    v_cvt_pk_bf16_f32 v107, v110, v111
    v_pk_mul_f32 v[112:113], v[112:113], v[32:33]
    v_pk_mul_f32 v[114:115], v[114:115], v[34:35]
    v_pk_mul_f32 v[116:117], v[116:117], v[36:37]
    v_pk_mul_f32 v[118:119], v[118:119], v[38:39]
    v_pk_mul_f32 v[120:121], v[120:121], v[40:41]
    v_pk_mul_f32 v[122:123], v[122:123], v[42:43]
    v_pk_mul_f32 v[124:125], v[124:125], v[44:45]
    v_pk_mul_f32 v[126:127], v[126:127], v[46:47]
    v_cvt_pk_bf16_f32 v112, v112, v113
    v_cvt_pk_bf16_f32 v113, v114, v115
    v_cvt_pk_bf16_f32 v114, v116, v117
    v_cvt_pk_bf16_f32 v115, v118, v119
    v_cvt_pk_bf16_f32 v120, v120, v121
    v_cvt_pk_bf16_f32 v121, v122, v123
    v_cvt_pk_bf16_f32 v122, v124, v125
    v_cvt_pk_bf16_f32 v123, v126, v127
    v_mov_b32 v19, 0x3f803f80
    v_cndmask_b32 v18, v19, 0, s[94:95]
    v_cndmask_b32 v22, 0, v19, s[94:95]
    ds_read_b32 v30, v26 offset:0
    s_waitcnt lgkmcnt(0)
    v_cmp_gt_u32 vcc, 1, v30
    s_nop 1
    s_cbranch_vccnz L_lslow23
L_lret24:
    v_mfma_f32_32x32x16_bf16 v[32:47], v[64:67], v[96:99], 0
    v_mov_b32 v19, v18
    v_mov_b32 v20, v18
    v_mov_b32_e64 v21, v18
    v_mfma_f32_32x32x16_bf16 v[32:47], v[72:75], v[104:107], v[32:47]
    v_mov_b32 v23, v22
    v_mov_b32 v24, v22
    v_mov_b32_e64 v25, v22
    v_mfma_f32_32x32x16_bf16 v[96:111], v[80:83], v[112:115], 0
    ds_read_b64_tr_b16 v[48:49], v3 offset:32768
    ds_read_b64_tr_b16 v[50:51], v3 offset:33024
    v_mfma_f32_32x32x16_bf16 v[96:111], v[88:91], v[120:123], v[96:111]
    ds_read_b64_tr_b16 v[52:53], v3 offset:33280
    ds_read_b64_tr_b16 v[54:55], v3 offset:33536
    ds_read_b64_tr_b16 v[56:57], v3 offset:34816
    ds_read_b64_tr_b16 v[58:59], v3 offset:35072
    v_mfma_f32_32x32x16_bf16 v[112:127], v[18:21], v[64:67], 0
    v_mfma_f32_32x32x16_bf16 v[112:127], v[18:21], v[72:75], v[112:127]
    v_mfma_f32_32x32x16_bf16 v[112:127], v[22:25], v[80:83], v[112:127]
    v_mfma_f32_32x32x16_bf16 v[112:127], v[22:25], v[88:91], v[112:127]
    s_waitcnt lgkmcnt(4)
    v_mfma_f32_32x32x16_bf16 v[64:79], v[48:51], a[0:3], 0
    ds_read_b64_tr_b16 v[60:61], v3 offset:35328
    ds_read_b64_tr_b16 v[62:63], v3 offset:35584
    v_cndmask_b32 v32, v32, v40, s[94:95]
    v_cndmask_b32 v33, v33, v41, s[94:95]
    v_cndmask_b32 v34, v34, v42, s[94:95]
    v_cndmask_b32 v35, v35, v43, s[94:95]
    v_cndmask_b32 v36, v36, v44, s[94:95]
    v_cndmask_b32 v37, v37, v45, s[94:95]
    v_cndmask_b32 v38, v38, v46, s[94:95]
    v_cndmask_b32 v39, v39, v47, s[94:95]
    ds_write_b128 v31, v[32:35] offset:0
    ds_write_b128 v31, v[36:39] offset:1024
    s_waitcnt lgkmcnt(6)
    v_mfma_f32_32x32x16_bf16 v[80:95], v[52:55], a[0:3], 0
    ds_read_b64_tr_b16 v[48:49], v3 offset:36864
    ds_read_b64_tr_b16 v[50:51], v3 offset:37120
    v_cndmask_b32 v96, v96, v104, s[94:95]
    v_cndmask_b32 v97, v97, v105, s[94:95]
    v_cndmask_b32 v98, v98, v106, s[94:95]
    v_cndmask_b32 v99, v99, v107, s[94:95]
    v_cndmask_b32 v100, v100, v108, s[94:95]
    v_cndmask_b32 v101, v101, v109, s[94:95]
    v_cndmask_b32 v102, v102, v110, s[94:95]
    v_cndmask_b32 v103, v103, v111, s[94:95]
    ds_write_b128 v31, v[96:99] offset:2048
    ds_write_b128 v31, v[100:103] offset:3072
    v_cndmask_b32 v112, v112, v120, s[96:97]
    s_waitcnt lgkmcnt(8)
    v_mfma_f32_32x32x16_bf16 v[64:79], v[56:59], a[4:7], v[64:79]
    ds_read_b64_tr_b16 v[52:53], v3 offset:37376
    ds_read_b64_tr_b16 v[54:55], v3 offset:37632
    ds_write_b32 v8, v112
    v_mov_b32 v28, 1
    ds_write_b32 v27, v28
    s_lshl_b32 s92, s42, 10
    s_add_u32 s90, s92, 32768
    v_add_u32 v31, s90, v1
    v_add_u32 v8, 153600, v5
    s_lshl_b32 s90, s3, 4
    s_add_u32 s90, s90, s43
    s_lshl_b32 s90, s90, 13
    s_add_u32 s90, s90, 1048576
    s_add_u32 s101, s90, s92
    s_add_u32 s90, s90, 4096
    s_cmp_eq_u32 s42, 0
    s_cselect_b32 s100, s90, 0x8000000
    s_waitcnt lgkmcnt(10)
    v_mfma_f32_32x32x16_bf16 v[80:95], v[60:63], a[4:7], v[80:95]
    ds_read_b64_tr_b16 v[56:57], v3 offset:38912
    ds_read_b64_tr_b16 v[58:59], v3 offset:39168
    ds_read_b32 v20, v26 offset:16
    s_waitcnt lgkmcnt(9)
    v_mfma_f32_32x32x16_bf16 v[64:79], v[48:51], a[8:11], v[64:79]
    ds_read_b64_tr_b16 v[60:61], v3 offset:39424
    ds_read_b64_tr_b16 v[62:63], v3 offset:39680
    s_waitcnt lgkmcnt(2)
    v_cmp_gt_u32 vcc, 1, v20
    s_nop 1
    s_cbranch_vccnz L_lslow25
L_lret26:
    ds_read_b128 v[32:35], v31 offset:0
    ds_read_b128 v[36:39], v31 offset:4096
    ds_read_b128 v[40:43], v31 offset:8192
    ds_read_b128 v[44:47], v31 offset:12288
    ds_read_b32 v112, v8 offset:0
    ds_read_b32 v113, v8 offset:2304
    ds_read_b32 v114, v8 offset:4608
    ds_read_b32 v115, v8 offset:6912
    v_mov_b32 v28, 2
    ds_write_b32 v27, v28
    v_mfma_f32_32x32x16_bf16 v[80:95], v[52:55], a[8:11], v[80:95]
    ds_read_b64_tr_b16 v[48:49], v3 offset:49152
    ds_read_b64_tr_b16 v[50:51], v3 offset:49408
    s_waitcnt lgkmcnt(9)
    v_add_f32 v32, v32, v36
    v_add_f32 v33, v33, v37
    v_add_f32 v34, v34, v38
    v_add_f32 v35, v35, v39
    s_waitcnt lgkmcnt(7)
    v_add_f32 v40, v40, v44
    v_add_f32 v41, v41, v45
    v_add_f32 v42, v42, v46
    v_add_f32 v43, v43, v47
    v_add_f32 v32, v32, v40
    v_add_f32 v33, v33, v41
    v_add_f32 v34, v34, v42
    v_add_f32 v35, v35, v43
    s_waitcnt lgkmcnt(5)
    v_add_f32 v112, v112, v113
    s_waitcnt lgkmcnt(3)
    v_add_f32 v114, v114, v115
    v_add_f32_e64 v112, v112, v114
    buffer_atomic_add_f32 v32, v5, s[24:27], s81 offen offset:0
    buffer_atomic_add_f32 v33, v5, s[24:27], s81 offen offset:256
    buffer_atomic_add_f32 v34, v5, s[24:27], s81 offen offset:512
    buffer_atomic_add_f32 v35, v5, s[24:27], s81 offen offset:768
    buffer_atomic_add_f32 v112, v5, s[24:27], s80 offen
    v_mfma_f32_32x32x16_bf16 v[64:79], v[56:59], a[12:15], v[64:79]
    ds_read_b64_tr_b16 v[52:53], v3 offset:49664
    ds_read_b64_tr_b16 v[54:55], v3 offset:49920
    v_mfma_f32_32x32x16_bf16 v[80:95], v[60:63], a[12:15], v[80:95]
    ds_read_b64_tr_b16 v[56:57], v3 offset:51200
    ds_read_b64_tr_b16 v[58:59], v3 offset:51456
    s_waitcnt lgkmcnt(4)
    v_mfma_f32_32x32x16_bf16 v[64:79], v[48:51], a[16:19], v[64:79]
    ds_read_b64_tr_b16 v[60:61], v3 offset:51712
    ds_read_b64_tr_b16 v[62:63], v3 offset:51968
    s_waitcnt lgkmcnt(4)
    v_mfma_f32_32x32x16_bf16 v[80:95], v[52:55], a[16:19], v[80:95]
    ds_read_b64_tr_b16 v[48:49], v3 offset:53248
    ds_read_b64_tr_b16 v[50:51], v3 offset:53504
    s_waitcnt lgkmcnt(4)
    v_mfma_f32_32x32x16_bf16 v[64:79], v[56:59], a[20:23], v[64:79]
    ds_read_b64_tr_b16 v[52:53], v3 offset:53760
    ds_read_b64_tr_b16 v[54:55], v3 offset:54016
    s_waitcnt lgkmcnt(4)
    v_mfma_f32_32x32x16_bf16 v[80:95], v[60:63], a[20:23], v[80:95]
    ds_read_b64_tr_b16 v[56:57], v3 offset:55296
    ds_read_b64_tr_b16 v[58:59], v3 offset:55552
    s_waitcnt lgkmcnt(4)
    v_mfma_f32_32x32x16_bf16 v[64:79], v[48:51], a[24:27], v[64:79]
    ds_read_b64_tr_b16 v[60:61], v3 offset:55808
    ds_read_b64_tr_b16 v[62:63], v3 offset:56064
    s_waitcnt lgkmcnt(4)
    v_mfma_f32_32x32x16_bf16 v[80:95], v[52:55], a[24:27], v[80:95]
    ds_read_b64_tr_b16 v[48:49], v3 offset:57344
    ds_read_b64_tr_b16 v[50:51], v3 offset:57600
    s_waitcnt lgkmcnt(4)
    v_mfma_f32_32x32x16_bf16 v[64:79], v[56:59], a[28:31], v[64:79]
    ds_read_b64_tr_b16 v[52:53], v3 offset:57856
    ds_read_b64_tr_b16 v[54:55], v3 offset:58112
    s_waitcnt lgkmcnt(4)
    v_mfma_f32_32x32x16_bf16 v[80:95], v[60:63], a[28:31], v[80:95]
    ds_read_b64_tr_b16 v[56:57], v3 offset:59392
    ds_read_b64_tr_b16 v[58:59], v3 offset:59648
    s_waitcnt lgkmcnt(4)
    v_mfma_f32_32x32x16_bf16 v[64:79], v[48:51], a[32:35], v[64:79]
    ds_read_b64_tr_b16 v[60:61], v3 offset:59904
    ds_read_b64_tr_b16 v[62:63], v3 offset:60160
    s_waitcnt lgkmcnt(4)
    v_mfma_f32_32x32x16_bf16 v[80:95], v[52:55], a[32:35], v[80:95]
    ds_read_b64_tr_b16 v[48:49], v3 offset:61440
    ds_read_b64_tr_b16 v[50:51], v3 offset:61696
    s_waitcnt lgkmcnt(4)
    v_mfma_f32_32x32x16_bf16 v[64:79], v[56:59], a[36:39], v[64:79]
    ds_read_b64_tr_b16 v[52:53], v3 offset:61952
    ds_read_b64_tr_b16 v[54:55], v3 offset:62208
    s_waitcnt lgkmcnt(4)
    v_mfma_f32_32x32x16_bf16 v[80:95], v[60:63], a[36:39], v[80:95]
    ds_read_b64_tr_b16 v[56:57], v3 offset:63488
    ds_read_b64_tr_b16 v[58:59], v3 offset:63744
    s_waitcnt lgkmcnt(4)
    v_mfma_f32_32x32x16_bf16 v[64:79], v[48:51], a[40:43], v[64:79]
    ds_read_b64_tr_b16 v[60:61], v3 offset:64000
    ds_read_b64_tr_b16 v[62:63], v3 offset:64256
    s_waitcnt lgkmcnt(4)
    v_mfma_f32_32x32x16_bf16 v[80:95], v[52:55], a[40:43], v[80:95]
    ds_read_b64_tr_b16 v[48:49], v4 offset:0
    ds_read_b64_tr_b16 v[50:51], v4 offset:256
    s_waitcnt lgkmcnt(4)
    v_mfma_f32_32x32x16_bf16 v[64:79], v[56:59], a[44:47], v[64:79]
    ds_read_b64_tr_b16 v[52:53], v4 offset:512
    ds_read_b64_tr_b16 v[54:55], v4 offset:768
    s_waitcnt lgkmcnt(4)
    v_mfma_f32_32x32x16_bf16 v[80:95], v[60:63], a[44:47], v[80:95]
    ds_read_b64_tr_b16 v[56:57], v4 offset:2048
    ds_read_b64_tr_b16 v[58:59], v4 offset:2304
    s_waitcnt lgkmcnt(4)
    v_mfma_f32_32x32x16_bf16 v[64:79], v[48:51], a[48:51], v[64:79]
    ds_read_b64_tr_b16 v[60:61], v4 offset:2560
    ds_read_b64_tr_b16 v[62:63], v4 offset:2816
    s_waitcnt lgkmcnt(4)
    v_mfma_f32_32x32x16_bf16 v[80:95], v[52:55], a[48:51], v[80:95]
    ds_read_b64_tr_b16 v[48:49], v4 offset:4096
    ds_read_b64_tr_b16 v[50:51], v4 offset:4352
    s_waitcnt lgkmcnt(4)
    v_mfma_f32_32x32x16_bf16 v[64:79], v[56:59], a[52:55], v[64:79]
    ds_read_b64_tr_b16 v[52:53], v4 offset:4608
    ds_read_b64_tr_b16 v[54:55], v4 offset:4864
    s_waitcnt lgkmcnt(4)
    v_mfma_f32_32x32x16_bf16 v[80:95], v[60:63], a[52:55], v[80:95]
    ds_read_b64_tr_b16 v[56:57], v4 offset:6144
    ds_read_b64_tr_b16 v[58:59], v4 offset:6400
    s_waitcnt lgkmcnt(4)
    v_mfma_f32_32x32x16_bf16 v[64:79], v[48:51], a[56:59], v[64:79]
    ds_read_b64_tr_b16 v[60:61], v4 offset:6656
    ds_read_b64_tr_b16 v[62:63], v4 offset:6912
    v_mov_b32 v28, 3
    ds_write_b32 v27, v28
    s_waitcnt lgkmcnt(5)
    v_mfma_f32_32x32x16_bf16 v[80:95], v[52:55], a[56:59], v[80:95]
    ds_read_b64_tr_b16 v[48:49], v4 offset:8192
    ds_read_b64_tr_b16 v[50:51], v4 offset:8448
    s_waitcnt lgkmcnt(5)
    v_mfma_f32_32x32x16_bf16 v[64:79], v[56:59], a[60:63], v[64:79]
    ds_read_b64_tr_b16 v[52:53], v4 offset:8704
    ds_read_b64_tr_b16 v[54:55], v4 offset:8960
    s_waitcnt lgkmcnt(5)
    v_mfma_f32_32x32x16_bf16 v[80:95], v[60:63], a[60:63], v[80:95]
    ds_read_b64_tr_b16 v[56:57], v4 offset:10240
    ds_read_b64_tr_b16 v[58:59], v4 offset:10496
    s_waitcnt lgkmcnt(4)
    v_mfma_f32_32x32x16_bf16 v[64:79], v[48:51], a[64:67], v[64:79]
    ds_read_b64_tr_b16 v[60:61], v4 offset:10752
    ds_read_b64_tr_b16 v[62:63], v4 offset:11008
    s_waitcnt lgkmcnt(4)
    v_mfma_f32_32x32x16_bf16 v[80:95], v[52:55], a[64:67], v[80:95]
    ds_read_b64_tr_b16 v[48:49], v4 offset:12288
    ds_read_b64_tr_b16 v[50:51], v4 offset:12544
    s_waitcnt lgkmcnt(4)
    v_mfma_f32_32x32x16_bf16 v[64:79], v[56:59], a[68:71], v[64:79]
    ds_read_b64_tr_b16 v[52:53], v4 offset:12800
    ds_read_b64_tr_b16 v[54:55], v4 offset:13056
    s_waitcnt lgkmcnt(4)
    v_mfma_f32_32x32x16_bf16 v[80:95], v[60:63], a[68:71], v[80:95]
    ds_read_b64_tr_b16 v[56:57], v4 offset:14336
    ds_read_b64_tr_b16 v[58:59], v4 offset:14592
    s_waitcnt lgkmcnt(4)
    v_mfma_f32_32x32x16_bf16 v[64:79], v[48:51], a[72:75], v[64:79]
    ds_read_b64_tr_b16 v[60:61], v4 offset:14848
    ds_read_b64_tr_b16 v[62:63], v4 offset:15104
    s_waitcnt vmcnt(0)
    v_mov_b32_e64 v30, 1
    s_mov_b64 exec, 1
    buffer_atomic_add v30, off, s[24:27], s82
    s_mov_b64 exec, -1
    s_waitcnt lgkmcnt(4)
    v_mfma_f32_32x32x16_bf16 v[80:95], v[52:55], a[72:75], v[80:95]
    ds_read_b64_tr_b16 v[48:49], v3 offset:0
    ds_read_b64_tr_b16 v[50:51], v3 offset:256
    s_waitcnt lgkmcnt(4)
    v_mfma_f32_32x32x16_bf16 v[64:79], v[56:59], a[76:79], v[64:79]
    ds_read_b64_tr_b16 v[52:53], v3 offset:512
    ds_read_b64_tr_b16 v[54:55], v3 offset:768
    s_waitcnt lgkmcnt(4)
    v_mfma_f32_32x32x16_bf16 v[80:95], v[60:63], a[76:79], v[80:95]
    ds_read_b64_tr_b16 v[56:57], v3 offset:2048
    ds_read_b64_tr_b16 v[58:59], v3 offset:2304
    s_waitcnt lgkmcnt(4)
    v_mfma_f32_32x32x16_bf16 v[64:79], v[48:51], a[80:83], v[64:79]
    ds_read_b64_tr_b16 v[60:61], v3 offset:2560
    ds_read_b64_tr_b16 v[62:63], v3 offset:2816
    s_waitcnt lgkmcnt(4)
    v_mfma_f32_32x32x16_bf16 v[80:95], v[52:55], a[80:83], v[80:95]
    ds_read_b64_tr_b16 v[48:49], v3 offset:4096
    ds_read_b64_tr_b16 v[50:51], v3 offset:4352
    s_waitcnt lgkmcnt(4)
    v_mfma_f32_32x32x16_bf16 v[64:79], v[56:59], a[84:87], v[64:79]
    ds_read_b64_tr_b16 v[52:53], v3 offset:4608
    ds_read_b64_tr_b16 v[54:55], v3 offset:4864
    s_waitcnt lgkmcnt(4)
    v_mfma_f32_32x32x16_bf16 v[80:95], v[60:63], a[84:87], v[80:95]
    ds_read_b64_tr_b16 v[56:57], v3 offset:6144
    ds_read_b64_tr_b16 v[58:59], v3 offset:6400
    s_waitcnt lgkmcnt(4)
    v_mfma_f32_32x32x16_bf16 v[64:79], v[48:51], a[88:91], v[64:79]
    ds_read_b64_tr_b16 v[60:61], v3 offset:6656
    ds_read_b64_tr_b16 v[62:63], v3 offset:6912
    s_waitcnt lgkmcnt(4)
    v_mfma_f32_32x32x16_bf16 v[80:95], v[52:55], a[88:91], v[80:95]
    ds_read_b64_tr_b16 v[48:49], v3 offset:8192
    ds_read_b64_tr_b16 v[50:51], v3 offset:8448
    s_waitcnt lgkmcnt(4)
    v_mfma_f32_32x32x16_bf16 v[64:79], v[56:59], a[92:95], v[64:79]
    ds_read_b64_tr_b16 v[52:53], v3 offset:8704
    ds_read_b64_tr_b16 v[54:55], v3 offset:8960
    s_waitcnt lgkmcnt(4)
    v_mfma_f32_32x32x16_bf16 v[80:95], v[60:63], a[92:95], v[80:95]
    ds_read_b64_tr_b16 v[56:57], v3 offset:10240
    ds_read_b64_tr_b16 v[58:59], v3 offset:10496
    s_waitcnt lgkmcnt(4)
    v_mfma_f32_32x32x16_bf16 v[64:79], v[48:51], a[96:99], v[64:79]
    ds_read_b64_tr_b16 v[60:61], v3 offset:10752
    ds_read_b64_tr_b16 v[62:63], v3 offset:11008
    s_waitcnt lgkmcnt(4)
    v_mfma_f32_32x32x16_bf16 v[80:95], v[52:55], a[96:99], v[80:95]
    ds_read_b64_tr_b16 v[48:49], v3 offset:12288
    ds_read_b64_tr_b16 v[50:51], v3 offset:12544
    s_waitcnt lgkmcnt(4)
    v_mfma_f32_32x32x16_bf16 v[64:79], v[56:59], a[100:103], v[64:79]
    ds_read_b64_tr_b16 v[52:53], v3 offset:12800
    ds_read_b64_tr_b16 v[54:55], v3 offset:13056
    s_waitcnt lgkmcnt(4)
    v_mfma_f32_32x32x16_bf16 v[80:95], v[60:63], a[100:103], v[80:95]
    ds_read_b64_tr_b16 v[56:57], v3 offset:14336
    ds_read_b64_tr_b16 v[58:59], v3 offset:14592
    s_waitcnt lgkmcnt(4)
    v_mfma_f32_32x32x16_bf16 v[64:79], v[48:51], a[104:107], v[64:79]
    ds_read_b64_tr_b16 v[60:61], v3 offset:14848
    ds_read_b64_tr_b16 v[62:63], v3 offset:15104
    s_waitcnt lgkmcnt(4)
    v_mfma_f32_32x32x16_bf16 v[80:95], v[52:55], a[104:107], v[80:95]
    ds_read_b64_tr_b16 v[48:49], v3 offset:16384
    ds_read_b64_tr_b16 v[50:51], v3 offset:16640
    s_waitcnt lgkmcnt(4)
    v_mfma_f32_32x32x16_bf16 v[64:79], v[56:59], a[108:111], v[64:79]
    ds_read_b64_tr_b16 v[52:53], v3 offset:16896
    ds_read_b64_tr_b16 v[54:55], v3 offset:17152
    s_waitcnt lgkmcnt(4)
    v_mfma_f32_32x32x16_bf16 v[80:95], v[60:63], a[108:111], v[80:95]
    ds_read_b64_tr_b16 v[56:57], v3 offset:18432
    ds_read_b64_tr_b16 v[58:59], v3 offset:18688
    s_waitcnt lgkmcnt(4)
    v_mfma_f32_32x32x16_bf16 v[64:79], v[48:51], a[112:115], v[64:79]
    ds_read_b64_tr_b16 v[60:61], v3 offset:18944
    ds_read_b64_tr_b16 v[62:63], v3 offset:19200
    s_waitcnt lgkmcnt(4)
    v_mfma_f32_32x32x16_bf16 v[80:95], v[52:55], a[112:115], v[80:95]
    ds_read_b64_tr_b16 v[48:49], v3 offset:20480
    ds_read_b64_tr_b16 v[50:51], v3 offset:20736
    s_waitcnt lgkmcnt(4)
    v_mfma_f32_32x32x16_bf16 v[64:79], v[56:59], a[116:119], v[64:79]
    ds_read_b64_tr_b16 v[52:53], v3 offset:20992
    ds_read_b64_tr_b16 v[54:55], v3 offset:21248
    s_waitcnt lgkmcnt(4)
    v_mfma_f32_32x32x16_bf16 v[80:95], v[60:63], a[116:119], v[80:95]
    ds_read_b64_tr_b16 v[56:57], v3 offset:22528
    ds_read_b64_tr_b16 v[58:59], v3 offset:22784
    s_waitcnt lgkmcnt(4)
    v_mfma_f32_32x32x16_bf16 v[64:79], v[48:51], a[120:123], v[64:79]
    ds_read_b64_tr_b16 v[60:61], v3 offset:23040
    ds_read_b64_tr_b16 v[62:63], v3 offset:23296
    v_mov_b32_e64 v28, 4
    ds_write_b32 v27, v28
    s_waitcnt lgkmcnt(5)
    v_mfma_f32_32x32x16_bf16 v[80:95], v[52:55], a[120:123], v[80:95]
    ds_read_b128 v[48:51], v9 offset:2048
    s_waitcnt lgkmcnt(4)
    v_mfma_f32_32x32x16_bf16 v[64:79], v[56:59], a[124:127], v[64:79]
    ds_read_b128 v[52:55], v9 offset:2560
    s_waitcnt lgkmcnt(3)
    v_mfma_f32_32x32x16_bf16 v[80:95], v[60:63], a[124:127], v[80:95]
    ds_read_b64_tr_b16 v[56:57], v3 offset:40960
    ds_read_b64_tr_b16 v[58:59], v3 offset:41216
    s_waitcnt lgkmcnt(3)
    v_mfma_f32_32x32x16_bf16 v[64:79], v[48:51], v[10:13], v[64:79]
    ds_read_b64_tr_b16 v[60:61], v3 offset:41472
    ds_read_b64_tr_b16 v[62:63], v3 offset:41728
    s_waitcnt lgkmcnt(4)
    v_mfma_f32_32x32x16_bf16 v[80:95], v[52:55], v[10:13], v[80:95]
    ds_read_b64_tr_b16 v[48:49], v3 offset:43008
    ds_read_b64_tr_b16 v[50:51], v3 offset:43264
    s_waitcnt lgkmcnt(4)
    v_mfma_f32_32x32x16_bf16 v[96:111], v[56:59], a[0:3], 0
    ds_read_b64_tr_b16 v[52:53], v3 offset:43520
    ds_read_b64_tr_b16 v[54:55], v3 offset:43776
    s_waitcnt lgkmcnt(4)
    v_mfma_f32_32x32x16_bf16 v[112:127], v[60:63], a[4:7], 0
    ds_read_b64_tr_b16 v[56:57], v3 offset:45056
    ds_read_b64_tr_b16 v[58:59], v3 offset:45312
    s_waitcnt lgkmcnt(4)
    v_mfma_f32_32x32x16_bf16 v[96:111], v[48:51], a[8:11], v[96:111]
    ds_read_b64_tr_b16 v[60:61], v3 offset:45568
    ds_read_b64_tr_b16 v[62:63], v3 offset:45824
    s_mul_i32 s100, s63, 114688
    s_lshl_b32 s101, s3, 12
    s_add_u32 s100, s100, 4259840
    s_add_u32 s101, s101, s100
    v_mul_f32 v18, v64, v64
    v_mul_f32 v19, v65, v65
    v_mul_f32 v20, v66, v66
    s_waitcnt lgkmcnt(4)
    v_mfma_f32_32x32x16_bf16 v[112:127], v[52:55], a[12:15], v[112:127]
    ds_read_b64_tr_b16 v[48:49], v3 offset:47104
    ds_read_b64_tr_b16 v[50:51], v3 offset:47360
    v_mul_f32 v21, v67, v67
    v_fma_f32 v18, v18, v16, v14
    v_fma_f32 v19, v19, v16, v14
    v_fma_f32 v20, v20, v16, v14
    v_fma_f32 v21, v21, v16, v14
    s_waitcnt lgkmcnt(4)
    v_mfma_f32_32x32x16_bf16 v[96:111], v[56:59], a[16:19], v[96:111]
    ds_read_b64_tr_b16 v[52:53], v3 offset:47616
    ds_read_b64_tr_b16 v[54:55], v3 offset:47872
    v_mul_f32 v18, v64, v18
    v_mul_f32 v19, v65, v19
    v_mul_f32 v20, v66, v20
    v_mul_f32 v21, v67, v21
    s_waitcnt lgkmcnt(4)
    v_mfma_f32_32x32x16_bf16 v[112:127], v[60:63], a[20:23], v[112:127]
    ds_read_b64_tr_b16 v[56:57], v3 offset:24576
    ds_read_b64_tr_b16 v[58:59], v3 offset:24832
    v_exp_f32 v18, v18
    v_exp_f32 v19, v19
    v_exp_f32 v20, v20
    s_waitcnt lgkmcnt(4)
    v_mfma_f32_32x32x16_bf16 v[96:111], v[48:51], a[24:27], v[96:111]
    ds_read_b64_tr_b16 v[60:61], v3 offset:25088
    ds_read_b64_tr_b16 v[62:63], v3 offset:25344
    v_exp_f32_e64 v21, v21
    v_fma_f32 v18, v18, v6, v6
    v_fma_f32 v19, v19, v6, v6
    v_fma_f32 v20, v20, v6, v6
    s_waitcnt lgkmcnt(4)
    v_mfma_f32_32x32x16_bf16 v[112:127], v[52:55], a[28:31], v[112:127]
    ds_read_b64_tr_b16 v[48:49], v3 offset:26624
    ds_read_b64_tr_b16 v[50:51], v3 offset:26880
    v_fma_f32 v21, v21, v6, v6
    v_rcp_f32 v18, v18
    v_rcp_f32 v19, v19
    s_waitcnt lgkmcnt(4)
    v_mfma_f32_32x32x16_bf16 v[96:111], v[56:59], a[32:35], v[96:111]
    ds_read_b64_tr_b16 v[52:53], v3 offset:27136
    ds_read_b64_tr_b16 v[54:55], v3 offset:27392
    v_rcp_f32 v20, v20
    v_rcp_f32 v21, v21
    v_mul_f32 v18, v64, v18
    s_waitcnt lgkmcnt(4)
    v_mfma_f32_32x32x16_bf16 v[112:127], v[60:63], a[36:39], v[112:127]
    ds_read_b32 v30, v26 offset:0
    ds_read_b64_tr_b16 v[56:57], v3 offset:28672
    ds_read_b64_tr_b16 v[58:59], v3 offset:28928
    v_mul_f32 v19, v65, v19
    v_mul_f32 v20, v66, v20
    v_mul_f32_e64 v21, v67, v21
    v_cvt_pk_bf16_f32 v64, v18, v19
    v_cvt_pk_bf16_f32 v65, v20, v21
    s_waitcnt lgkmcnt(5)
    v_mfma_f32_32x32x16_bf16 v[96:111], v[48:51], a[40:43], v[96:111]
    ds_read_b64_tr_b16 v[60:61], v3 offset:29184
    ds_read_b64_tr_b16 v[62:63], v3 offset:29440
    v_mul_f32 v18, v68, v68
    v_mul_f32 v19, v69, v69
    v_mul_f32 v20, v70, v70
    v_mul_f32 v21, v71, v71
    v_fma_f32 v18, v18, v16, v14
    s_waitcnt lgkmcnt(5)
    v_mfma_f32_32x32x16_bf16 v[112:127], v[52:55], a[44:47], v[112:127]
    ds_read_b64_tr_b16 v[48:49], v3 offset:30720
    ds_read_b64_tr_b16 v[50:51], v3 offset:30976
    v_fma_f32 v19, v19, v16, v14
    v_fma_f32 v20, v20, v16, v14
    v_fma_f32 v21, v21, v16, v14
    v_mul_f32 v18, v68, v18
    v_mul_f32_e64 v19, v69, v19
    s_waitcnt lgkmcnt(4)
    v_mfma_f32_32x32x16_bf16 v[96:111], v[56:59], a[48:51], v[96:111]
    ds_read_b64_tr_b16 v[52:53], v3 offset:31232
    ds_read_b64_tr_b16 v[54:55], v3 offset:31488
    v_mul_f32 v20, v70, v20
    v_mul_f32 v21, v71, v21
    v_exp_f32_e64 v18, v18
    s_waitcnt lgkmcnt(4)
    v_mfma_f32_32x32x16_bf16 v[112:127], v[60:63], a[52:55], v[112:127]
    v_cmp_gt_u32 vcc, 2, v30
    s_nop 1
    s_cbranch_vccnz L_lslow21
L_lret22:
    ds_read_b64_tr_b16 v[56:57], v2 offset:49152
    ds_read_b64_tr_b16 v[58:59], v2 offset:49408
    v_exp_f32 v19, v19
    v_exp_f32 v20, v20
    v_exp_f32 v21, v21
    s_waitcnt lgkmcnt(4)
    v_mfma_f32_32x32x16_bf16 v[96:111], v[48:51], a[56:59], v[96:111]
    ds_read_b64_tr_b16 v[60:61], v2 offset:49664
    ds_read_b64_tr_b16 v[62:63], v2 offset:49920
    v_fma_f32 v18, v18, v6, v6
    v_fma_f32 v19, v19, v6, v6
    v_fma_f32 v20, v20, v6, v6
    v_fma_f32 v21, v21, v6, v6
    s_waitcnt lgkmcnt(4)
    v_mfma_f32_32x32x16_bf16 v[112:127], v[52:55], a[60:63], v[112:127]
    ds_read_b64_tr_b16 v[48:49], v2 offset:51200
    ds_read_b64_tr_b16 v[50:51], v2 offset:51456
    v_rcp_f32 v18, v18
    v_rcp_f32 v19, v19
    v_rcp_f32 v20, v20
    s_waitcnt lgkmcnt(4)
    v_mfma_f32_32x32x16_bf16 v[96:111], v[56:59], a[64:67], v[96:111]
    ds_read_b64_tr_b16 v[52:53], v2 offset:51712
    ds_read_b64_tr_b16 v[54:55], v2 offset:51968
    v_rcp_f32 v21, v21
    v_mul_f32 v18, v68, v18
    v_mul_f32_e64 v19, v69, v19
    s_waitcnt lgkmcnt(4)
    v_mfma_f32_32x32x16_bf16 v[112:127], v[60:63], a[68:71], v[112:127]
    ds_read_b64_tr_b16 v[56:57], v2 offset:53248
    ds_read_b64_tr_b16 v[58:59], v2 offset:53504
    v_mul_f32 v20, v70, v20
    v_mul_f32 v21, v71, v21
    v_cvt_pk_bf16_f32 v66, v18, v19
    v_cvt_pk_bf16_f32 v67, v20, v21
    v_mul_f32 v18, v72, v72
    s_waitcnt lgkmcnt(4)
    v_mfma_f32_32x32x16_bf16 v[96:111], v[48:51], a[72:75], v[96:111]
    ds_read_b64_tr_b16 v[60:61], v2 offset:53760
    ds_read_b64_tr_b16 v[62:63], v2 offset:54016
    v_mul_f32 v19, v73, v73
    v_mul_f32 v20, v74, v74
    v_mul_f32 v21, v75, v75
    v_fma_f32 v18, v18, v16, v14
    v_fma_f32 v19, v19, v16, v14
    s_waitcnt lgkmcnt(4)
    v_mfma_f32_32x32x16_bf16 v[112:127], v[52:55], a[76:79], v[112:127]
    ds_read_b64_tr_b16 v[48:49], v2 offset:55296
    ds_read_b64_tr_b16 v[50:51], v2 offset:55552
    v_fma_f32 v20, v20, v16, v14
    v_fma_f32 v21, v21, v16, v14
    v_mul_f32 v18, v72, v18
    v_mul_f32 v19, v73, v19
    v_mul_f32 v20, v74, v20
    s_waitcnt lgkmcnt(4)
    v_mfma_f32_32x32x16_bf16 v[96:111], v[56:59], a[80:83], v[96:111]
    ds_read_b64_tr_b16 v[52:53], v2 offset:55808
    ds_read_b64_tr_b16 v[54:55], v2 offset:56064
    v_mul_f32 v21, v75, v21
    v_exp_f32 v18, v18
    v_exp_f32 v19, v19
    s_waitcnt lgkmcnt(4)
    v_mfma_f32_32x32x16_bf16 v[112:127], v[60:63], a[84:87], v[112:127]
    ds_read_b64_tr_b16 v[56:57], v2 offset:57344
    ds_read_b64_tr_b16 v[58:59], v2 offset:57600
    v_exp_f32 v20, v20
    v_exp_f32_e64 v21, v21
    v_fma_f32 v18, v18, v6, v6
    s_waitcnt lgkmcnt(4)
    v_mfma_f32_32x32x16_bf16 v[96:111], v[48:51], a[88:91], v[96:111]
    ds_read_b64_tr_b16 v[60:61], v2 offset:57856
    ds_read_b64_tr_b16 v[62:63], v2 offset:58112
    v_fma_f32 v19, v19, v6, v6
    v_fma_f32 v20, v20, v6, v6
    v_fma_f32 v21, v21, v6, v6
    v_rcp_f32 v18, v18
    s_waitcnt lgkmcnt(4)
    v_mfma_f32_32x32x16_bf16 v[112:127], v[52:55], a[92:95], v[112:127]
    ds_read_b64_tr_b16 v[48:49], v2 offset:59392
    ds_read_b64_tr_b16 v[50:51], v2 offset:59648
    v_rcp_f32 v19, v19
    v_rcp_f32 v20, v20
    v_rcp_f32 v21, v21
    s_waitcnt lgkmcnt(4)
    v_mfma_f32_32x32x16_bf16 v[96:111], v[56:59], a[96:99], v[96:111]
    ds_read_b64_tr_b16 v[52:53], v2 offset:59904
    ds_read_b64_tr_b16 v[54:55], v2 offset:60160
    v_mul_f32 v18, v72, v18
    v_mul_f32 v19, v73, v19
    v_mul_f32 v20, v74, v20
    v_mul_f32_e64 v21, v75, v21
    s_waitcnt lgkmcnt(4)
    v_mfma_f32_32x32x16_bf16 v[112:127], v[60:63], a[100:103], v[112:127]
    ds_read_b64_tr_b16 v[56:57], v2 offset:61440
    ds_read_b64_tr_b16 v[58:59], v2 offset:61696
    v_cvt_pk_bf16_f32 v72, v18, v19
    v_cvt_pk_bf16_f32 v73, v20, v21
    v_mul_f32 v18, v76, v76
    v_mul_f32 v19, v77, v77
    v_mul_f32 v20, v78, v78
    s_waitcnt lgkmcnt(4)
    v_mfma_f32_32x32x16_bf16 v[96:111], v[48:51], a[104:107], v[96:111]
    ds_read_b64_tr_b16 v[60:61], v2 offset:61952
    ds_read_b64_tr_b16 v[62:63], v2 offset:62208
    v_mul_f32_e64 v21, v79, v79
    v_fma_f32 v18, v18, v16, v14
    v_fma_f32 v19, v19, v16, v14
    v_fma_f32 v20, v20, v16, v14
    v_fma_f32 v21, v21, v16, v14
    s_waitcnt lgkmcnt(4)
    v_mfma_f32_32x32x16_bf16 v[112:127], v[52:55], a[108:111], v[112:127]
    ds_read_b64_tr_b16 v[48:49], v2 offset:63488
    ds_read_b64_tr_b16 v[50:51], v2 offset:63744
    v_mul_f32 v18, v76, v18
    v_mul_f32 v19, v77, v19
    v_mul_f32 v20, v78, v20
    v_mul_f32 v21, v79, v21
    v_exp_f32_e64 v18, v18
    s_waitcnt lgkmcnt(4)
    v_mfma_f32_32x32x16_bf16 v[96:111], v[56:59], a[112:115], v[96:111]
    ds_read_b64_tr_b16 v[52:53], v2 offset:64000
    ds_read_b64_tr_b16 v[54:55], v2 offset:64256
    v_exp_f32 v19, v19
    v_exp_f32_e64 v20, v20
    s_waitcnt lgkmcnt(4)
    v_mfma_f32_32x32x16_bf16 v[112:127], v[60:63], a[116:119], v[112:127]
    ds_read_b128 v[56:59], v9 offset:3072
    v_exp_f32_e64 v21, v21
    v_fma_f32 v18, v18, v6, v6
    v_fma_f32 v19, v19, v6, v6
    v_fma_f32 v20, v20, v6, v6
    s_waitcnt lgkmcnt(3)
    v_mfma_f32_32x32x16_bf16 v[96:111], v[48:51], a[120:123], v[96:111]
    v_fma_f32 v21, v21, v6, v6
    v_rcp_f32 v18, v18
    v_rcp_f32 v19, v19
    s_waitcnt lgkmcnt(1)
    v_mfma_f32_32x32x16_bf16 v[112:127], v[52:55], a[124:127], v[112:127]
    v_rcp_f32 v20, v20
    v_rcp_f32 v21, v21
    v_mul_f32 v18, v76, v18
    s_waitcnt lgkmcnt(0)
    v_mfma_f32_32x32x16_bf16 v[96:111], v[56:59], v[10:13], v[96:111]
    v_mul_f32 v19, v77, v19
    v_mul_f32 v20, v78, v20
    v_mul_f32_e64 v21, v79, v21
    v_cvt_pk_bf16_f32 v74, v18, v19
    v_cvt_pk_bf16_f32 v75, v20, v21
    v_pk_mul_f32 v[18:19], v[80:81], v[80:81]
    v_pk_mul_f32 v[20:21], v[82:83], v[82:83]
    v_pk_mul_f32 v[22:23], v[84:85], v[84:85]
    v_pk_mul_f32 v[24:25], v[86:87], v[86:87]
    v_pk_fma_f32 v[18:19], v[18:19], v[16:17], v[14:15]
    v_pk_fma_f32 v[20:21], v[20:21], v[16:17], v[14:15]
    v_pk_fma_f32 v[22:23], v[22:23], v[16:17], v[14:15]
    v_pk_fma_f32 v[24:25], v[24:25], v[16:17], v[14:15]
    v_pk_mul_f32 v[18:19], v[80:81], v[18:19]
    v_pk_mul_f32 v[20:21], v[82:83], v[20:21]
    v_pk_mul_f32 v[22:23], v[84:85], v[22:23]
    v_pk_mul_f32 v[24:25], v[86:87], v[24:25]
    v_exp_f32 v18, v18
    v_exp_f32 v19, v19
    v_exp_f32 v20, v20
    v_exp_f32 v21, v21
    v_exp_f32 v22, v22
    v_exp_f32 v23, v23
    v_exp_f32 v24, v24
    v_exp_f32 v25, v25
    v_pk_fma_f32 v[18:19], v[18:19], v[6:7], v[6:7]
    v_pk_fma_f32 v[20:21], v[20:21], v[6:7], v[6:7]
    v_pk_fma_f32 v[22:23], v[22:23], v[6:7], v[6:7]
    v_pk_fma_f32 v[24:25], v[24:25], v[6:7], v[6:7]
    v_rcp_f32 v18, v18
    v_rcp_f32 v19, v19
    v_rcp_f32 v20, v20
    v_rcp_f32 v21, v21
    v_rcp_f32 v22, v22
    v_rcp_f32 v23, v23
    v_rcp_f32 v24, v24
    v_rcp_f32 v25, v25
    v_pk_mul_f32 v[18:19], v[80:81], v[18:19]
    v_pk_mul_f32 v[20:21], v[82:83], v[20:21]
    v_pk_mul_f32 v[22:23], v[84:85], v[22:23]
    v_pk_mul_f32 v[24:25], v[86:87], v[24:25]
    v_cvt_pk_bf16_f32 v80, v18, v19
    v_cvt_pk_bf16_f32 v81, v20, v21
    v_cvt_pk_bf16_f32 v82, v22, v23
    v_cvt_pk_bf16_f32 v83, v24, v25
    v_pk_mul_f32 v[18:19], v[88:89], v[88:89]
    v_pk_mul_f32 v[20:21], v[90:91], v[90:91]
    v_pk_mul_f32 v[22:23], v[92:93], v[92:93]
    v_pk_mul_f32 v[24:25], v[94:95], v[94:95]
    v_pk_fma_f32 v[18:19], v[18:19], v[16:17], v[14:15]
    v_pk_fma_f32 v[20:21], v[20:21], v[16:17], v[14:15]
    v_pk_fma_f32 v[22:23], v[22:23], v[16:17], v[14:15]
    v_pk_fma_f32 v[24:25], v[24:25], v[16:17], v[14:15]
    v_pk_mul_f32 v[18:19], v[88:89], v[18:19]
    v_pk_mul_f32 v[20:21], v[90:91], v[20:21]
    v_pk_mul_f32 v[22:23], v[92:93], v[22:23]
    v_pk_mul_f32 v[24:25], v[94:95], v[24:25]
    v_exp_f32 v18, v18
    v_exp_f32 v19, v19
    v_exp_f32 v20, v20
    v_exp_f32 v21, v21
    v_exp_f32 v22, v22
    v_exp_f32 v23, v23
    v_exp_f32 v24, v24
    v_exp_f32 v25, v25
    v_pk_fma_f32 v[18:19], v[18:19], v[6:7], v[6:7]
    v_pk_fma_f32 v[20:21], v[20:21], v[6:7], v[6:7]
    v_pk_fma_f32 v[22:23], v[22:23], v[6:7], v[6:7]
    v_pk_fma_f32 v[24:25], v[24:25], v[6:7], v[6:7]
    v_rcp_f32 v18, v18
    v_rcp_f32 v19, v19
    v_rcp_f32 v20, v20
    v_rcp_f32 v21, v21
    v_rcp_f32 v22, v22
    v_rcp_f32 v23, v23
    v_rcp_f32 v24, v24
    v_rcp_f32 v25, v25
    v_pk_mul_f32 v[18:19], v[88:89], v[18:19]
    v_pk_mul_f32 v[20:21], v[90:91], v[20:21]
    v_pk_mul_f32 v[22:23], v[92:93], v[22:23]
    v_pk_mul_f32 v[24:25], v[94:95], v[24:25]
    v_cvt_pk_bf16_f32 v88, v18, v19
    v_cvt_pk_bf16_f32 v89, v20, v21
    v_cvt_pk_bf16_f32 v90, v22, v23
    v_cvt_pk_bf16_f32 v91, v24, v25
    buffer_store_dwordx4 v[64:67], v1, s[24:27], s101 offen offset:0 sc1
    buffer_store_dwordx4 v[72:75], v1, s[24:27], s101 offen offset:1024 sc1
    buffer_store_dwordx4 v[80:83], v1, s[24:27], s101 offen offset:2048 sc1
    buffer_store_dwordx4 v[88:91], v1, s[24:27], s101 offen offset:3072 sc1
    s_mul_i32 s100, s63, 114688
    s_lshl_b32 s101, s3, 11
    s_add_u32 s100, s100, 4292608
    s_add_u32 s101, s101, s100
    v_pk_add_f32 v[96:97], v[96:97], v[112:113]
    v_pk_add_f32 v[98:99], v[98:99], v[114:115]
    v_pk_add_f32 v[100:101], v[100:101], v[116:117]
    v_pk_add_f32 v[102:103], v[102:103], v[118:119]
    v_pk_add_f32 v[104:105], v[104:105], v[120:121]
    v_pk_add_f32 v[106:107], v[106:107], v[122:123]
    v_pk_add_f32 v[108:109], v[108:109], v[124:125]
    v_pk_add_f32 v[110:111], v[110:111], v[126:127]
    v_pk_mul_f32 v[18:19], v[96:97], v[96:97]
    v_pk_mul_f32 v[20:21], v[98:99], v[98:99]
    v_pk_mul_f32 v[22:23], v[100:101], v[100:101]
    v_pk_mul_f32 v[24:25], v[102:103], v[102:103]
    v_pk_fma_f32 v[18:19], v[18:19], v[16:17], v[14:15]
    v_pk_fma_f32 v[20:21], v[20:21], v[16:17], v[14:15]
    v_pk_fma_f32 v[22:23], v[22:23], v[16:17], v[14:15]
    v_pk_fma_f32 v[24:25], v[24:25], v[16:17], v[14:15]
    v_pk_mul_f32 v[18:19], v[96:97], v[18:19]
    v_pk_mul_f32 v[20:21], v[98:99], v[20:21]
    v_pk_mul_f32 v[22:23], v[100:101], v[22:23]
    v_pk_mul_f32 v[24:25], v[102:103], v[24:25]
    v_exp_f32 v18, v18
    v_exp_f32 v19, v19
    v_exp_f32 v20, v20
    v_exp_f32 v21, v21
    v_exp_f32 v22, v22
    v_exp_f32 v23, v23
    v_exp_f32 v24, v24
    v_exp_f32 v25, v25
    v_pk_fma_f32 v[18:19], v[18:19], v[6:7], v[6:7]
    v_pk_fma_f32 v[20:21], v[20:21], v[6:7], v[6:7]
    v_pk_fma_f32 v[22:23], v[22:23], v[6:7], v[6:7]
    v_pk_fma_f32 v[24:25], v[24:25], v[6:7], v[6:7]
    v_rcp_f32 v18, v18
    v_rcp_f32 v19, v19
    v_rcp_f32 v20, v20
    v_rcp_f32 v21, v21
    v_rcp_f32 v22, v22
    v_rcp_f32 v23, v23
    v_rcp_f32 v24, v24
    v_rcp_f32 v25, v25
    v_pk_mul_f32 v[18:19], v[96:97], v[18:19]
    v_pk_mul_f32 v[20:21], v[98:99], v[20:21]
    v_pk_mul_f32 v[22:23], v[100:101], v[22:23]
    v_pk_mul_f32 v[24:25], v[102:103], v[24:25]
    v_cvt_pk_bf16_f32 v96, v18, v19
    v_cvt_pk_bf16_f32 v97, v20, v21
    v_cvt_pk_bf16_f32 v98, v22, v23
    v_cvt_pk_bf16_f32 v99, v24, v25
    v_pk_mul_f32 v[18:19], v[104:105], v[104:105]
    v_pk_mul_f32 v[20:21], v[106:107], v[106:107]
    v_pk_mul_f32 v[22:23], v[108:109], v[108:109]
    v_pk_mul_f32 v[24:25], v[110:111], v[110:111]
    v_pk_fma_f32 v[18:19], v[18:19], v[16:17], v[14:15]
    v_pk_fma_f32 v[20:21], v[20:21], v[16:17], v[14:15]
    v_pk_fma_f32 v[22:23], v[22:23], v[16:17], v[14:15]
    v_pk_fma_f32 v[24:25], v[24:25], v[16:17], v[14:15]
    v_pk_mul_f32 v[18:19], v[104:105], v[18:19]
    v_pk_mul_f32 v[20:21], v[106:107], v[20:21]
    v_pk_mul_f32 v[22:23], v[108:109], v[22:23]
    v_pk_mul_f32 v[24:25], v[110:111], v[24:25]
    v_exp_f32 v18, v18
    v_exp_f32 v19, v19
    v_exp_f32 v20, v20
    v_exp_f32 v21, v21
    v_exp_f32 v22, v22
    v_exp_f32 v23, v23
    v_exp_f32 v24, v24
    v_exp_f32 v25, v25
    v_pk_fma_f32 v[18:19], v[18:19], v[6:7], v[6:7]
    v_pk_fma_f32 v[20:21], v[20:21], v[6:7], v[6:7]
    v_pk_fma_f32 v[22:23], v[22:23], v[6:7], v[6:7]
    v_pk_fma_f32 v[24:25], v[24:25], v[6:7], v[6:7]
    v_rcp_f32 v18, v18
    v_rcp_f32 v19, v19
    v_rcp_f32 v20, v20
    v_rcp_f32 v21, v21
    v_rcp_f32 v22, v22
    v_rcp_f32 v23, v23
    v_rcp_f32 v24, v24
    v_rcp_f32 v25, v25
    v_pk_mul_f32 v[18:19], v[104:105], v[18:19]
    v_pk_mul_f32 v[20:21], v[106:107], v[20:21]
    v_pk_mul_f32 v[22:23], v[108:109], v[22:23]
    v_pk_mul_f32 v[24:25], v[110:111], v[24:25]
    v_cvt_pk_bf16_f32 v104, v18, v19
    v_cvt_pk_bf16_f32 v105, v20, v21
    v_cvt_pk_bf16_f32 v106, v22, v23
    v_cvt_pk_bf16_f32 v107, v24, v25
    buffer_store_dwordx4 v[96:99], v1, s[24:27], s101 offen offset:0 sc1
    buffer_store_dwordx4 v[104:107], v1, s[24:27], s101 offen offset:1024 sc1
    s_waitcnt vmcnt(0)
    s_lshl_b32 s92, s63, 4
    s_add_u32 s92, s92, s44
    s_lshl_b32 s92, s92, 7
    s_add_u32 s92, s92, 589824
    v_mov_b32 v18, s40
    v_mov_b32 v19, s41
    s_mov_b64 exec, 1
    buffer_store_dwordx2 v[18:19], off, s[24:27], s92 sc1
    s_mov_b64 exec, -1
    ds_read_b32 v30, v26 offset:0
    s_and_b32 s93, s42, 1
    s_lshl_b32 s90, s93, 9
    v_and_b32 v5, 0xff, v2
    v_lshrrev_b32_e64 v6, 5, v0
    v_lshl_or_b32 v5, v6, 8, v5
    v_add_u32_e64 v5, s90, v5
    v_add_u32 v6, 0x10000, v5
    v_add_u32 v7, 0x20000, v5
    v_xor_b32 v10, 512, v5
    v_xor_b32 v11, 512, v6
    v_xor_b32 v12, 512, v7
    s_waitcnt lgkmcnt(0)
    v_cmp_gt_u32 vcc, 3, v30
    s_nop 1
    s_cbranch_vccnz L_lslow27
L_lret28:
    s_cmp_eq_u32 s93, 1
    s_cbranch_scc1 L_park1KV
    ds_read_b64_tr_b16 a[0:1], v6 offset:32768
    ds_read_b64_tr_b16 a[2:3], v6 offset:33792
    ds_read_b64_tr_b16 a[4:5], v11 offset:32768
    ds_read_b64_tr_b16 a[6:7], v11 offset:33792
    ds_read_b64_tr_b16 a[8:9], v6 offset:34816
    ds_read_b64_tr_b16 a[10:11], v6 offset:35840
    ds_read_b64_tr_b16 a[12:13], v11 offset:34816
    ds_read_b64_tr_b16 a[14:15], v11 offset:35840
    ds_read_b64_tr_b16 a[16:17], v6 offset:36864
    ds_read_b64_tr_b16 a[18:19], v6 offset:37888
    ds_read_b64_tr_b16 a[20:21], v11 offset:36864
    ds_read_b64_tr_b16 a[22:23], v11 offset:37888
    ds_read_b64_tr_b16 a[24:25], v6 offset:38912
    ds_read_b64_tr_b16 a[26:27], v6 offset:39936
    ds_read_b64_tr_b16 a[28:29], v11 offset:38912
    ds_read_b64_tr_b16 a[30:31], v11 offset:39936
    ds_read_b64_tr_b16 a[32:33], v6 offset:49152
    ds_read_b64_tr_b16 a[34:35], v6 offset:50176
    ds_read_b64_tr_b16 a[36:37], v11 offset:49152
    ds_read_b64_tr_b16 a[38:39], v11 offset:50176
    ds_read_b64_tr_b16 a[40:41], v6 offset:51200
    ds_read_b64_tr_b16 a[42:43], v6 offset:52224
    ds_read_b64_tr_b16 a[44:45], v11 offset:51200
    ds_read_b64_tr_b16 a[46:47], v11 offset:52224
    ds_read_b64_tr_b16 a[48:49], v6 offset:53248
    ds_read_b64_tr_b16 a[50:51], v6 offset:54272
    ds_read_b64_tr_b16 a[52:53], v11 offset:53248
    ds_read_b64_tr_b16 a[54:55], v11 offset:54272
    ds_read_b64_tr_b16 a[56:57], v6 offset:55296
    ds_read_b64_tr_b16 a[58:59], v6 offset:56320
    ds_read_b64_tr_b16 a[60:61], v11 offset:55296
    ds_read_b64_tr_b16 a[62:63], v11 offset:56320
    ds_read_b64_tr_b16 a[64:65], v6 offset:57344
    ds_read_b64_tr_b16 a[66:67], v6 offset:58368
    ds_read_b64_tr_b16 a[68:69], v11 offset:57344
    ds_read_b64_tr_b16 a[70:71], v11 offset:58368
    ds_read_b64_tr_b16 a[72:73], v6 offset:59392
    ds_read_b64_tr_b16 a[74:75], v6 offset:60416
    ds_read_b64_tr_b16 a[76:77], v11 offset:59392
    ds_read_b64_tr_b16 a[78:79], v11 offset:60416
    ds_read_b64_tr_b16 a[80:81], v6 offset:61440
    ds_read_b64_tr_b16 a[82:83], v6 offset:62464
    ds_read_b64_tr_b16 a[84:85], v11 offset:61440
    ds_read_b64_tr_b16 a[86:87], v11 offset:62464
    ds_read_b64_tr_b16 a[88:89], v6 offset:63488
    ds_read_b64_tr_b16 a[90:91], v6 offset:64512
    ds_read_b64_tr_b16 a[92:93], v11 offset:63488
    ds_read_b64_tr_b16 a[94:95], v11 offset:64512
    ds_read_b64_tr_b16 a[96:97], v7 offset:0
    ds_read_b64_tr_b16 a[98:99], v7 offset:1024
    ds_read_b64_tr_b16 a[100:101], v12 offset:0
    ds_read_b64_tr_b16 a[102:103], v12 offset:1024
    ds_read_b64_tr_b16 a[104:105], v7 offset:2048
    ds_read_b64_tr_b16 a[106:107], v7 offset:3072
    ds_read_b64_tr_b16 a[108:109], v12 offset:2048
    ds_read_b64_tr_b16 a[110:111], v12 offset:3072
    ds_read_b64_tr_b16 a[112:113], v7 offset:4096
    ds_read_b64_tr_b16 a[114:115], v7 offset:5120
    ds_read_b64_tr_b16 a[116:117], v12 offset:4096
    ds_read_b64_tr_b16 a[118:119], v12 offset:5120
    ds_read_b64_tr_b16 a[120:121], v7 offset:6144
    ds_read_b64_tr_b16 a[122:123], v7 offset:7168
    ds_read_b64_tr_b16 a[124:125], v12 offset:6144
    ds_read_b64_tr_b16 a[126:127], v12 offset:7168
L_parkedKV:
    v_mov_b32_e64 v28, 5
    ds_write_b32 v27, v28
    ds_read_b32 v30, v26 offset:16
    s_lshl_b32 s90, s45, 6
    s_lshr_b32 s92, s42, 1
    s_lshl_b32 s92, s92, 5
    s_add_u32 s90, s90, s92
    s_lshl_b32 s90, s90, 10
    s_lshl_b32 s92, s46, 1
    s_add_u32 s92, s92, s93
    s_lshl_b32 s92, s92, 6
    s_add_u32 s91, s90, s92
    v_lshrrev_b32 v2, 2, v0
    v_lshlrev_b32 v2, 10, v2
    v_and_b32 v3, 3, v0
    v_lshl_or_b32 v2, v3, 4, v2
    v_lshlrev_b32 v7, 7, v3
    v_add_u32 v3, 15360, v2
    s_lshr_b32 s90, s62, 1
    s_add_u32 s90, s90, 131072
    s_mov_b32 m0, s90
    v_and_b32 v4, 31, v0
    v_lshlrev_b32 v4, 6, v4
    v_lshrrev_b32 v31, 5, v0
    v_lshl_or_b32 v4, v31, 3, v4
    v_add_u32 v4, s90, v4
    v_add_u32_e64 v9, s90, v1
    s_waitcnt lgkmcnt(0)
    v_cmp_gt_u32 vcc, 5, v30
    s_nop 1
    s_cbranch_vccnz L_lslow29
L_lret30:
    buffer_load_dwordx4 v2, s[4:7], s91 offen lds
    buffer_load_dwordx4 v3, s[4:7], s91 offen offset:1024 lds
    s_lshl_b32 s100, s45, 1
    s_lshr_b32 s92, s42, 1
    s_add_u32 s100, s100, s92
    s_lshl_b32 s100, s100, 1
    s_add_u32 s100, s100, s93
    s_lshl_b32 s101, s100, 14
    s_lshl_b32 s100, s100, 9
    s_add_u32 s100, s100, 851968
    s_add_u32 s101, s101, 2097152
    s_xor_b32 s90, s62, 4096
    s_add_u32 s90, s90, 65536
    v_add_u32 v8, s90, v1
    s_lshl_b32 s90, s42, 14
    s_add_u32 s90, s90, 0
    v_add_u32 v6, s90, v1
    ds_read_b32 v30, v26 offset:0
    s_waitcnt lgkmcnt(0)
    v_cmp_gt_u32 vcc, 4, v30
    s_nop 1
    s_cbranch_vccnz L_lslow31
L_lret32:
    s_buffer_load_dwordx2 s[48:49], s[24:27], s100 offset:0 glc
    s_buffer_load_dwordx2 s[50:51], s[24:27], s100 offset:128 glc
    s_buffer_load_dwordx2 s[52:53], s[24:27], s100 offset:256 glc
    s_buffer_load_dwordx2 s[54:55], s[24:27], s100 offset:384 glc
    s_waitcnt lgkmcnt(0)
    s_xor_b64 s[48:49], s[48:49], s[40:41]
    s_xor_b64 s[50:51], s[50:51], s[40:41]
    s_xor_b64 s[52:53], s[52:53], s[40:41]
    s_xor_b64 s[54:55], s[54:55], s[40:41]
    s_or_b64 s[48:49], s[48:49], s[50:51]
    s_or_b64 s[48:49], s[48:49], s[52:53]
    s_or_b64 s[48:49], s[48:49], s[54:55]
    s_cbranch_scc1 L_slow_o33
L_ret_o34:
    s_mul_i32 s84, s46, 1
    s_add_u32 s84, s84, 0
    s_and_b32 s84, s84, 7
    s_lshl_b32 s84, s84, 11
    s_add_u32 s84, s84, s101
    buffer_load_dwordx4 v[32:35], v1, s[24:27], s84 offen offset:0 sc1
    buffer_load_dwordx4 v[36:39], v1, s[24:27], s84 offen offset:1024 sc1
    s_mul_i32 s84, s46, 1
    s_add_u32 s84, s84, 1
    s_and_b32 s84, s84, 7
    s_lshl_b32 s84, s84, 11
    s_add_u32 s84, s84, s101
    buffer_load_dwordx4 v[40:43], v1, s[24:27], s84 offen offset:0 sc1
    buffer_load_dwordx4 v[44:47], v1, s[24:27], s84 offen offset:1024 sc1
    s_mul_i32 s84, s46, 1
    s_add_u32 s84, s84, 2
    s_and_b32 s84, s84, 7
    s_lshl_b32 s84, s84, 11
    s_add_u32 s84, s84, s101
    buffer_load_dwordx4 v[48:51], v1, s[24:27], s84 offen offset:0 sc1
    buffer_load_dwordx4 v[52:55], v1, s[24:27], s84 offen offset:1024 sc1
    s_mul_i32 s84, s46, 1
    s_add_u32 s84, s84, 3
    s_and_b32 s84, s84, 7
    s_lshl_b32 s84, s84, 11
    s_add_u32 s84, s84, s101
    buffer_load_dwordx4 v[56:59], v1, s[24:27], s84 offen offset:0 sc1
    buffer_load_dwordx4 v[60:63], v1, s[24:27], s84 offen offset:1024 sc1
    s_waitcnt vmcnt(7)
    v_mfma_f32_32x32x16_bf16 v[80:95], a[4:7], v[32:35], 0
    v_mfma_f32_32x32x16_bf16 v[64:79], a[0:3], v[32:35], 0
    s_mul_i32 s84, s46, 1
    s_add_u32 s84, s84, 4
    s_and_b32 s84, s84, 7
    s_lshl_b32 s84, s84, 11
    s_add_u32 s84, s84, s101
    buffer_load_dwordx4 v[32:35], v1, s[24:27], s84 offen offset:0 sc1
    ds_read_b64 v[96:97], v4 offset:0
    ds_read_b64 v[98:99], v4 offset:16
    ds_read_b64 v[100:101], v4 offset:32
    ds_read_b64 v[102:103], v4 offset:48
    s_waitcnt vmcnt(7)
    v_mfma_f32_32x32x16_bf16 v[80:95], a[12:15], v[36:39], v[80:95]
    v_mfma_f32_32x32x16_bf16 v[64:79], a[8:11], v[36:39], v[64:79]
    buffer_load_dwordx4 v[36:39], v1, s[24:27], s84 offen offset:1024 sc1
    s_waitcnt vmcnt(7)
    v_mfma_f32_32x32x16_bf16 v[80:95], a[20:23], v[40:43], v[80:95]
    v_mfma_f32_32x32x16_bf16 v[64:79], a[16:19], v[40:43], v[64:79]
    s_mul_i32 s84, s46, 1
    s_add_u32 s84, s84, 5
    s_and_b32 s84, s84, 7
    s_lshl_b32 s84, s84, 11
    s_add_u32 s84, s84, s101
    buffer_load_dwordx4 v[40:43], v1, s[24:27], s84 offen offset:0 sc1
    s_waitcnt lgkmcnt(3)
    v_lshlrev_b32 v112, 16, v96
    v_and_b32 v113, 0xffff0000, v96
    s_waitcnt vmcnt(7)
    v_mfma_f32_32x32x16_bf16 v[80:95], a[28:31], v[44:47], v[80:95]
    v_mfma_f32_32x32x16_bf16 v[64:79], a[24:27], v[44:47], v[64:79]
    buffer_load_dwordx4 v[44:47], v1, s[24:27], s84 offen offset:1024 sc1
    v_lshlrev_b32 v114, 16, v97
    v_and_b32 v115, 0xffff0000, v97
    s_waitcnt vmcnt(7)
    v_mfma_f32_32x32x16_bf16 v[80:95], a[36:39], v[48:51], v[80:95]
    v_mfma_f32_32x32x16_bf16 v[64:79], a[32:35], v[48:51], v[64:79]
    s_mul_i32 s84, s46, 1
    s_add_u32 s84, s84, 6
    s_and_b32 s84, s84, 7
    s_lshl_b32 s84, s84, 11
    s_add_u32 s84, s84, s101
    buffer_load_dwordx4 v[48:51], v1, s[24:27], s84 offen offset:0 sc1
    s_waitcnt lgkmcnt(2)
    v_lshlrev_b32_e64 v116, 16, v98
    v_and_b32 v117, 0xffff0000, v98
    s_waitcnt vmcnt(7)
    v_mfma_f32_32x32x16_bf16 v[80:95], a[44:47], v[52:55], v[80:95]
    v_mfma_f32_32x32x16_bf16 v[64:79], a[40:43], v[52:55], v[64:79]
    buffer_load_dwordx4 v[52:55], v1, s[24:27], s84 offen offset:1024 sc1
    v_lshlrev_b32 v118, 16, v99
    v_and_b32 v119, 0xffff0000, v99
    s_waitcnt vmcnt(7)
    v_mfma_f32_32x32x16_bf16 v[80:95], a[52:55], v[56:59], v[80:95]
    v_mfma_f32_32x32x16_bf16 v[64:79], a[48:51], v[56:59], v[64:79]
    s_mul_i32 s84, s46, 1
    s_add_u32 s84, s84, 7
    s_and_b32 s84, s84, 7
    s_lshl_b32 s84, s84, 11
    s_add_u32 s84, s84, s101
    buffer_load_dwordx4 v[56:59], v1, s[24:27], s84 offen offset:0 sc1
    s_waitcnt lgkmcnt(1)
    v_lshlrev_b32 v120, 16, v100
    v_and_b32 v121, 0xffff0000, v100
    s_waitcnt vmcnt(7)
    v_mfma_f32_32x32x16_bf16 v[80:95], a[60:63], v[60:63], v[80:95]
    v_mfma_f32_32x32x16_bf16 v[64:79], a[56:59], v[60:63], v[64:79]
    buffer_load_dwordx4 v[60:63], v1, s[24:27], s84 offen offset:1024 sc1
    v_lshlrev_b32 v122, 16, v101
    v_and_b32 v123, 0xffff0000, v101
    s_waitcnt vmcnt(7)
    v_mfma_f32_32x32x16_bf16 v[80:95], a[68:71], v[32:35], v[80:95]
    v_mfma_f32_32x32x16_bf16 v[64:79], a[64:67], v[32:35], v[64:79]
    s_waitcnt lgkmcnt(0)
    v_lshlrev_b32 v124, 16, v102
    v_and_b32 v125, 0xffff0000, v102
    s_waitcnt vmcnt(6)
    v_mfma_f32_32x32x16_bf16 v[80:95], a[76:79], v[36:39], v[80:95]
    v_mfma_f32_32x32x16_bf16 v[64:79], a[72:75], v[36:39], v[64:79]
    v_lshlrev_b32 v126, 16, v103
    v_and_b32 v127, 0xffff0000, v103
    s_waitcnt vmcnt(5)
    v_mfma_f32_32x32x16_bf16 v[80:95], a[84:87], v[40:43], v[80:95]
    v_mfma_f32_32x32x16_bf16 v[64:79], a[80:83], v[40:43], v[64:79]
    s_waitcnt vmcnt(4)
    v_mfma_f32_32x32x16_bf16 v[80:95], a[92:95], v[44:47], v[80:95]
    v_mfma_f32_32x32x16_bf16 v[64:79], a[88:91], v[44:47], v[64:79]
    s_waitcnt vmcnt(3)
    v_mfma_f32_32x32x16_bf16 v[80:95], a[100:103], v[48:51], v[80:95]
    v_mfma_f32_32x32x16_bf16 v[64:79], a[96:99], v[48:51], v[64:79]
    s_waitcnt vmcnt(2)
    v_mfma_f32_32x32x16_bf16 v[80:95], a[108:111], v[52:55], v[80:95]
    v_mfma_f32_32x32x16_bf16 v[64:79], a[104:107], v[52:55], v[64:79]
    ds_read_b32 v30, v26 offset:0
    s_waitcnt vmcnt(1)
    v_mfma_f32_32x32x16_bf16 v[80:95], a[116:119], v[56:59], v[80:95]
    v_mfma_f32_32x32x16_bf16 v[64:79], a[112:115], v[56:59], v[64:79]
    s_waitcnt vmcnt(0)
    v_mfma_f32_32x32x16_bf16 v[80:95], a[124:127], v[60:63], v[80:95]
    v_mfma_f32_32x32x16_bf16 v[64:79], a[120:123], v[60:63], v[64:79]
    s_waitcnt lgkmcnt(0)
    v_cmp_gt_u32 vcc, 6, v30
    s_nop 1
    s_cbranch_vccnz L_lslow35
L_lret36:
    ds_read_b128 v[32:35], v6 offset:0
    ds_read_b128 v[96:99], v6 offset:4096
    ds_read_b128 v[10:13], v6 offset:8192
    ds_read_b128 v[48:51], v6 offset:12288
    ds_read_b128 v[36:39], v6 offset:1024
    ds_read_b128 v[100:103], v6 offset:5120
    ds_read_b128 v[14:17], v6 offset:9216
    ds_read_b128 v[52:55], v6 offset:13312
    ds_write_b128 v8, v[80:83] offset:0
    ds_write_b128 v8, v[84:87] offset:1024
    ds_write_b128 v8, v[88:91] offset:2048
    ds_write_b128 v8, v[92:95] offset:3072
    v_mov_b32_e64 v28, 6
    ds_write_b32 v27, v28
    v_xor_b32 v8, 4096, v8
    v_add_u32 v3, 1024, v3
    s_waitcnt lgkmcnt(11)
    v_pk_add_f32 v[32:33], v[32:33], v[96:97]
    v_pk_add_f32 v[34:35], v[34:35], v[98:99]
    s_waitcnt lgkmcnt(9)
    v_pk_add_f32 v[18:19], v[10:11], v[48:49]
    v_pk_add_f32 v[20:21], v[12:13], v[50:51]
    ds_read_b128 v[40:43], v6 offset:2048
    ds_read_b128 v[104:107], v6 offset:6144
    ds_read_b128 v[10:13], v6 offset:10240
    ds_read_b128 v[56:59], v6 offset:14336
    v_pk_add_f32 v[32:33], v[32:33], v[18:19]
    v_pk_add_f32 v[34:35], v[34:35], v[20:21]
    v_pk_mul_f32 v[18:19], v[32:33], s[76:77]
    v_pk_mul_f32 v[20:21], v[34:35], s[76:77]
    v_exp_f32 v18, v18
    v_exp_f32 v19, v19
    v_exp_f32 v20, v20
    v_exp_f32 v21, v21
    v_pk_add_f32 v[18:19], v[18:19], s[78:79]
    v_pk_add_f32 v[20:21], v[20:21], s[78:79]
    v_rcp_f32 v18, v18
    v_rcp_f32 v19, v19
    v_rcp_f32_e64 v20, v20
    v_rcp_f32_e64 v21, v21
    v_pk_mul_f32 v[32:33], v[32:33], v[18:19]
    v_pk_mul_f32 v[34:35], v[34:35], v[20:21]
    s_waitcnt lgkmcnt(11)
    v_pk_add_f32 v[36:37], v[36:37], v[100:101]
    v_pk_add_f32 v[38:39], v[38:39], v[102:103]
    s_waitcnt lgkmcnt(9)
    v_pk_add_f32 v[18:19], v[14:15], v[52:53]
    v_pk_add_f32 v[20:21], v[16:17], v[54:55]
    ds_read_b128 v[44:47], v6 offset:3072
    ds_read_b128 v[108:111], v6 offset:7168
    ds_read_b128 v[14:17], v6 offset:11264
    ds_read_b128 v[60:63], v6 offset:15360
    v_pk_add_f32 v[36:37], v[36:37], v[18:19]
    v_pk_add_f32 v[38:39], v[38:39], v[20:21]
    v_pk_mul_f32 v[18:19], v[36:37], s[76:77]
    v_pk_mul_f32 v[20:21], v[38:39], s[76:77]
    v_exp_f32 v18, v18
    v_exp_f32 v19, v19
    v_exp_f32 v20, v20
    v_exp_f32 v21, v21
    v_pk_add_f32 v[18:19], v[18:19], s[78:79]
    v_pk_add_f32 v[20:21], v[20:21], s[78:79]
    v_rcp_f32 v18, v18
    v_rcp_f32 v19, v19
    v_rcp_f32 v20, v20
    v_rcp_f32 v21, v21
    v_pk_mul_f32 v[36:37], v[36:37], v[18:19]
    v_pk_mul_f32 v[38:39], v[38:39], v[20:21]
    s_waitcnt lgkmcnt(6)
    v_pk_add_f32 v[40:41], v[40:41], v[104:105]
    v_pk_add_f32 v[42:43], v[42:43], v[106:107]
    s_waitcnt lgkmcnt(4)
    v_pk_add_f32 v[18:19], v[10:11], v[56:57]
    v_pk_add_f32 v[20:21], v[12:13], v[58:59]
    ds_read_b32 v30, v26 offset:16
    v_pk_add_f32 v[40:41], v[40:41], v[18:19]
    v_pk_add_f32 v[42:43], v[42:43], v[20:21]
    v_pk_mul_f32 v[18:19], v[40:41], s[76:77]
    v_pk_mul_f32 v[20:21], v[42:43], s[76:77]
    v_exp_f32 v18, v18
    v_exp_f32 v19, v19
    v_exp_f32 v20, v20
    v_exp_f32 v21, v21
    v_pk_add_f32 v[18:19], v[18:19], s[78:79]
    v_pk_add_f32 v[20:21], v[20:21], s[78:79]
    v_rcp_f32 v18, v18
    v_rcp_f32 v19, v19
    v_rcp_f32_e64 v20, v20
    v_rcp_f32_e64 v21, v21
    v_pk_mul_f32 v[40:41], v[40:41], v[18:19]
    v_pk_mul_f32 v[42:43], v[42:43], v[20:21]
    s_waitcnt lgkmcnt(3)
    v_pk_add_f32 v[44:45], v[44:45], v[108:109]
    v_pk_add_f32 v[46:47], v[46:47], v[110:111]
    s_waitcnt lgkmcnt(1)
    v_pk_add_f32 v[18:19], v[14:15], v[60:61]
    v_pk_add_f32 v[20:21], v[16:17], v[62:63]
    v_pk_add_f32 v[44:45], v[44:45], v[18:19]
    v_pk_add_f32 v[46:47], v[46:47], v[20:21]
    v_pk_mul_f32 v[18:19], v[44:45], s[76:77]
    v_pk_mul_f32 v[20:21], v[46:47], s[76:77]
    v_exp_f32 v18, v18
    v_exp_f32 v19, v19
    v_exp_f32 v20, v20
    v_exp_f32 v21, v21
    s_waitcnt lgkmcnt(0)
    v_cmp_gt_u32 vcc, 6, v30
    s_nop 1
    s_cbranch_vccnz L_lslow37
L_lret38:
    ds_read_b128 v[80:83], v8 offset:0
    ds_read_b128 v[84:87], v8 offset:1024
    ds_read_b128 v[88:91], v8 offset:2048
    ds_read_b128 v[92:95], v8 offset:3072
    v_pk_add_f32 v[18:19], v[18:19], s[78:79]
    v_pk_add_f32 v[20:21], v[20:21], s[78:79]
    v_rcp_f32 v18, v18
    v_rcp_f32 v19, v19
    v_rcp_f32 v20, v20
    v_rcp_f32_e64 v21, v21
    v_pk_mul_f32 v[44:45], v[44:45], v[18:19]
    v_pk_mul_f32 v[46:47], v[46:47], v[20:21]
    s_waitcnt lgkmcnt(3)
    v_pk_add_f32 v[64:65], v[64:65], v[80:81]
    v_pk_add_f32 v[66:67], v[66:67], v[82:83]
    v_pk_fma_f32 v[112:113], v[64:65], v[32:33], v[112:113]
    v_pk_fma_f32 v[114:115], v[66:67], v[34:35], v[114:115]
    v_cvt_pk_bf16_f32 v18, v112, v113
    v_cvt_pk_bf16_f32 v19, v114, v115
    ds_write_b64 v4, v[18:19] offset:0
    s_waitcnt lgkmcnt(3)
    v_pk_add_f32 v[68:69], v[68:69], v[84:85]
    v_pk_add_f32 v[70:71], v[70:71], v[86:87]
    v_pk_fma_f32 v[116:117], v[68:69], v[36:37], v[116:117]
    v_pk_fma_f32 v[118:119], v[70:71], v[38:39], v[118:119]
    v_cvt_pk_bf16_f32 v20, v116, v117
    v_cvt_pk_bf16_f32 v21, v118, v119
    ds_write_b64 v4, v[20:21] offset:16
    s_waitcnt lgkmcnt(3)
    v_pk_add_f32 v[72:73], v[72:73], v[88:89]
    v_pk_add_f32 v[74:75], v[74:75], v[90:91]
    v_pk_fma_f32 v[120:121], v[72:73], v[40:41], v[120:121]
    v_pk_fma_f32 v[122:123], v[74:75], v[42:43], v[122:123]
    v_cvt_pk_bf16_f32 v22, v120, v121
    v_cvt_pk_bf16_f32 v23, v122, v123
    ds_write_b64 v4, v[22:23] offset:32
    s_waitcnt lgkmcnt(3)
    v_pk_add_f32 v[76:77], v[76:77], v[92:93]
    v_pk_add_f32 v[78:79], v[78:79], v[94:95]
    v_pk_fma_f32 v[124:125], v[76:77], v[44:45], v[124:125]
    v_pk_fma_f32 v[126:127], v[78:79], v[46:47], v[126:127]
    v_cvt_pk_bf16_f32 v24, v124, v125
    v_cvt_pk_bf16_f32 v25, v126, v127
    ds_write_b64 v4, v[24:25] offset:48
    ds_read_b128 v[48:51], v9
    ds_read_b128 v[52:55], v9 offset:1024
    s_waitcnt lgkmcnt(1)
    buffer_store_dwordx4 v[48:51], v2, s[28:31], s91 offen sc1
    s_waitcnt lgkmcnt(0)
    buffer_store_dwordx4 v[52:55], v3, s[28:31], s91 offen sc1
    s_or_b32 s90, s2, s42
    s_cmp_lg_u32 s90, 0
    s_cbranch_scc1 L_end
    v_mov_b32 v30, s40
    v_mov_b32 v31, s41
    s_mov_b64 exec, 1
    buffer_store_dwordx2 v[30:31], off, s[24:27], 0 sc1
    s_endpgm
L_slow_st17:
s_mov_b32 s67, 0
L_slow_st17_loop:
s_sleep 4
buffer_load_dwordx4 v[18:21], v31, s[24:27], s101 offen sc1
s_waitcnt vmcnt(0)
s_add_u32 s67, s67, 1
s_cmp_ge_u32 s67, 0x8000
s_cbranch_scc1 L_ret_st18
v_cmp_ne_u64 vcc, s[40:41], v[20:21]
s_nop 1
s_cbranch_vccnz L_slow_st17_loop
s_branch L_ret_st18
L_slow_init19:
s_mov_b32 s67, 0
L_slow_init19_loop:
s_sleep 4
buffer_load_dword v29, off, s[24:27], s82 sc1
s_waitcnt vmcnt(0)
s_add_u32 s67, s67, 1
s_cmp_ge_u32 s67, 0x8000
s_cbranch_scc1 L_ret_init20
v_subrev_u32 v29, s40, v29
v_cmp_lt_u32 vcc, 15, v29
s_nop 1
s_cbranch_vccnz L_slow_init19_loop
s_branch L_ret_init20
L_lslow21:
s_mov_b32 s67, 0
L_lslow21_loop:
ds_read_b32 v30, v26 offset:0
s_add_u32 s67, s67, 1
s_cmp_ge_u32 s67, 0x100000
s_cbranch_scc1 L_lret22
s_waitcnt lgkmcnt(0)
v_cmp_gt_u32 vcc, 2, v30
s_nop 1
s_cbranch_vccnz L_lslow21_loop
s_branch L_lret22
L_lslow23:
s_mov_b32 s67, 0
L_lslow23_loop:
ds_read_b32 v30, v26 offset:0
s_add_u32 s67, s67, 1
s_cmp_ge_u32 s67, 0x100000
s_cbranch_scc1 L_lret24
s_waitcnt lgkmcnt(0)
v_cmp_gt_u32 vcc, 1, v30
s_nop 1
s_cbranch_vccnz L_lslow23_loop
s_branch L_lret24
L_lslow25:
s_mov_b32 s67, 0
L_lslow25_loop:
ds_read_b32 v20, v26 offset:16
s_add_u32 s67, s67, 1
s_cmp_ge_u32 s67, 0x100000
s_cbranch_scc1 L_lret26
s_waitcnt lgkmcnt(0)
v_cmp_gt_u32 vcc, 1, v20
s_nop 1
s_cbranch_vccnz L_lslow25_loop
s_branch L_lret26
L_lslow27:
s_mov_b32 s67, 0
L_lslow27_loop:
ds_read_b32 v30, v26 offset:0
s_add_u32 s67, s67, 1
s_cmp_ge_u32 s67, 0x100000
s_cbranch_scc1 L_lret28
s_waitcnt lgkmcnt(0)
v_cmp_gt_u32 vcc, 3, v30
s_nop 1
s_cbranch_vccnz L_lslow27_loop
s_branch L_lret28
L_park1KV:
ds_read_b64_tr_b16 a[0:1], v7 offset:8192
ds_read_b64_tr_b16 a[2:3], v7 offset:9216
ds_read_b64_tr_b16 a[4:5], v12 offset:8192
ds_read_b64_tr_b16 a[6:7], v12 offset:9216
ds_read_b64_tr_b16 a[8:9], v7 offset:10240
ds_read_b64_tr_b16 a[10:11], v7 offset:11264
ds_read_b64_tr_b16 a[12:13], v12 offset:10240
ds_read_b64_tr_b16 a[14:15], v12 offset:11264
ds_read_b64_tr_b16 a[16:17], v7 offset:12288
ds_read_b64_tr_b16 a[18:19], v7 offset:13312
ds_read_b64_tr_b16 a[20:21], v12 offset:12288
ds_read_b64_tr_b16 a[22:23], v12 offset:13312
ds_read_b64_tr_b16 a[24:25], v7 offset:14336
ds_read_b64_tr_b16 a[26:27], v7 offset:15360
ds_read_b64_tr_b16 a[28:29], v12 offset:14336
ds_read_b64_tr_b16 a[30:31], v12 offset:15360
ds_read_b64_tr_b16 a[32:33], v6 offset:0
ds_read_b64_tr_b16 a[34:35], v6 offset:1024
ds_read_b64_tr_b16 a[36:37], v11 offset:0
ds_read_b64_tr_b16 a[38:39], v11 offset:1024
ds_read_b64_tr_b16 a[40:41], v6 offset:2048
ds_read_b64_tr_b16 a[42:43], v6 offset:3072
ds_read_b64_tr_b16 a[44:45], v11 offset:2048
ds_read_b64_tr_b16 a[46:47], v11 offset:3072
ds_read_b64_tr_b16 a[48:49], v6 offset:4096
ds_read_b64_tr_b16 a[50:51], v6 offset:5120
ds_read_b64_tr_b16 a[52:53], v11 offset:4096
ds_read_b64_tr_b16 a[54:55], v11 offset:5120
ds_read_b64_tr_b16 a[56:57], v6 offset:6144
ds_read_b64_tr_b16 a[58:59], v6 offset:7168
ds_read_b64_tr_b16 a[60:61], v11 offset:6144
ds_read_b64_tr_b16 a[62:63], v11 offset:7168
ds_read_b64_tr_b16 a[64:65], v6 offset:8192
ds_read_b64_tr_b16 a[66:67], v6 offset:9216
ds_read_b64_tr_b16 a[68:69], v11 offset:8192
ds_read_b64_tr_b16 a[70:71], v11 offset:9216
ds_read_b64_tr_b16 a[72:73], v6 offset:10240
ds_read_b64_tr_b16 a[74:75], v6 offset:11264
ds_read_b64_tr_b16 a[76:77], v11 offset:10240
ds_read_b64_tr_b16 a[78:79], v11 offset:11264
ds_read_b64_tr_b16 a[80:81], v6 offset:12288
ds_read_b64_tr_b16 a[82:83], v6 offset:13312
ds_read_b64_tr_b16 a[84:85], v11 offset:12288
ds_read_b64_tr_b16 a[86:87], v11 offset:13312
ds_read_b64_tr_b16 a[88:89], v6 offset:14336
ds_read_b64_tr_b16 a[90:91], v6 offset:15360
ds_read_b64_tr_b16 a[92:93], v11 offset:14336
ds_read_b64_tr_b16 a[94:95], v11 offset:15360
ds_read_b64_tr_b16 a[96:97], v6 offset:16384
ds_read_b64_tr_b16 a[98:99], v6 offset:17408
ds_read_b64_tr_b16 a[100:101], v11 offset:16384
ds_read_b64_tr_b16 a[102:103], v11 offset:17408
ds_read_b64_tr_b16 a[104:105], v6 offset:18432
ds_read_b64_tr_b16 a[106:107], v6 offset:19456
ds_read_b64_tr_b16 a[108:109], v11 offset:18432
ds_read_b64_tr_b16 a[110:111], v11 offset:19456
ds_read_b64_tr_b16 a[112:113], v6 offset:20480
ds_read_b64_tr_b16 a[114:115], v6 offset:21504
ds_read_b64_tr_b16 a[116:117], v11 offset:20480
ds_read_b64_tr_b16 a[118:119], v11 offset:21504
ds_read_b64_tr_b16 a[120:121], v6 offset:22528
ds_read_b64_tr_b16 a[122:123], v6 offset:23552
ds_read_b64_tr_b16 a[124:125], v11 offset:22528
ds_read_b64_tr_b16 a[126:127], v11 offset:23552
s_branch L_parkedKV
L_lslow29:
s_mov_b32 s67, 0
L_lslow29_loop:
ds_read_b32 v30, v26 offset:16
s_add_u32 s67, s67, 1
s_cmp_ge_u32 s67, 0x100000
s_cbranch_scc1 L_lret30
s_waitcnt lgkmcnt(0)
v_cmp_gt_u32 vcc, 5, v30
s_nop 1
s_cbranch_vccnz L_lslow29_loop
s_branch L_lret30
L_lslow31:
s_mov_b32 s67, 0
L_lslow31_loop:
ds_read_b32 v30, v26 offset:0
s_add_u32 s67, s67, 1
s_cmp_ge_u32 s67, 0x100000
s_cbranch_scc1 L_lret32
s_waitcnt lgkmcnt(0)
v_cmp_gt_u32 vcc, 4, v30
s_nop 1
s_cbranch_vccnz L_lslow31_loop
s_branch L_lret32
L_slow_o33:
s_mov_b32 s67, 0
L_slow_o33_loop:
s_sleep 2
s_buffer_load_dwordx2 s[48:49], s[24:27], s100 offset:0 glc
s_buffer_load_dwordx2 s[50:51], s[24:27], s100 offset:128 glc
s_buffer_load_dwordx2 s[52:53], s[24:27], s100 offset:256 glc
s_buffer_load_dwordx2 s[54:55], s[24:27], s100 offset:384 glc
s_waitcnt lgkmcnt(0)
s_add_u32 s67, s67, 1
s_cmp_ge_u32 s67, 0x8000
s_cbranch_scc1 L_ret_o34
s_xor_b64 s[48:49], s[48:49], s[40:41]
s_xor_b64 s[50:51], s[50:51], s[40:41]
s_xor_b64 s[52:53], s[52:53], s[40:41]
s_xor_b64 s[54:55], s[54:55], s[40:41]
s_or_b64 s[48:49], s[48:49], s[50:51]
s_or_b64 s[48:49], s[48:49], s[52:53]
s_or_b64 s[48:49], s[48:49], s[54:55]
s_cbranch_scc1 L_slow_o33_loop
s_branch L_ret_o34
L_lslow35:
s_mov_b32 s67, 0
L_lslow35_loop:
ds_read_b32 v30, v26 offset:0
s_add_u32 s67, s67, 1
s_cmp_ge_u32 s67, 0x100000
s_cbranch_scc1 L_lret36
s_waitcnt lgkmcnt(0)
v_cmp_gt_u32 vcc, 6, v30
s_nop 1
s_cbranch_vccnz L_lslow35_loop
s_branch L_lret36
L_lslow37:
s_mov_b32 s67, 0
L_lslow37_loop:
ds_read_b32 v30, v26 offset:16
s_add_u32 s67, s67, 1
s_cmp_ge_u32 s67, 0x100000
s_cbranch_scc1 L_lret38
s_waitcnt lgkmcnt(0)
v_cmp_gt_u32 vcc, 6, v30
s_nop 1
s_cbranch_vccnz L_lslow37_loop
s_branch L_lret38
.p2align 6
L_typeQ:
    s_cmp_lt_u32 s42, 4
    s_cbranch_scc1 L_AQ
    s_and_b32 s42, s42, 3
L_BQ:
    s_and_b32 s90, s2, 7
    s_lshr_b32 s91, s2, 3
    s_lshr_b32 s70, s90, 2
    s_and_b32 s71, s91, 7
    s_lshl_b32 s43, s70, 3
    s_add_u32 s43, s43, s71
    s_and_b32 s72, s2, 3
    s_lshl_b32 s72, s72, 1
    s_lshr_b32 s92, s2, 7
    s_add_u32 s3, s72, s92
    v_lshrrev_b32 v28, 5, v0
    v_and_b32 v29, 3, v0
    s_add_u32 s47, s71, s72
    s_lshl_b32 s93, s43, 2
    s_add_u32 s93, s93, s42
    s_lshl_b32 s92, s93, 15
    v_lshrrev_b32 v27, 3, v0
    v_lshlrev_b32 v27, 12, v27
    v_and_b32 v26, 7, v0
    v_lshlrev_b32 v8, 2, v28
    v_xor_b32 v26, v26, v8
    v_lshl_or_b32 v27, v26, 4, v27
    v_add_u32 v8, s92, v27
    v_xor_b32 v9, 16, v8
    v_xor_b32 v10, 32, v8
    v_xor_b32 v11, 48, v8
    s_lshl_b32 s73, s3, 1
    s_lshr_b32 s92, s42, 1
    s_add_u32 s73, s73, s92
    s_lshl_b32 s73, s73, 7
    s_and_b32 s92, s42, 1
    s_mul_i32 s92, s92, 114688
    s_add_u32 s74, s73, s92
    v_bfe_u32 v25, v0, 2, 3
    v_lshlrev_b32_e64 v26, 6, v28
    v_lshl_or_b32 v26, v29, 4, v26
    v_mul_u32_u24 v27, 3584, v25
    v_add3_u32 v12, v26, v27, s74
    v_add_u32 v13, 27648, v12
    v_add_u32 v14, 55296, v12
    v_add_u32 v15, 82944, v12
    s_and_b32 s92, s47, 7
    s_mul_i32 s76, s92, 229376
    s_lshl_b32 s92, s92, 7
    s_lshl_b32 s100, s42, 12
    s_mov_b32 s6, 2097152
    s_mov_b32 s7, 0x20000
    s_mov_b32 s31, 0x20000
    s_mov_b32 s30, 1835008
    s_waitcnt lgkmcnt(0)
    s_mov_b32 s4, s48
    s_mov_b32 s5, s49
    s_mov_b32 s28, s56
    s_mov_b32 s29, s57
    s_mov_b32 m0, s100
    s_nop 0
    buffer_load_dwordx4 v8, s[4:7], s92 offen offset:0 lds
    s_load_dwordx2 s[40:41], s[66:67], 0
    s_mov_b32 s8, s50
    s_mov_b32 s9, s51
    s_mov_b32 s10, 1572864
    s_mov_b32 s11, 0x20000
    buffer_load_dwordx4 v9, s[4:7], s92 offen offset:1024 lds
    s_mov_b32 s20, s52
    s_mov_b32 s21, s53
    s_mov_b32 s22, 524288
    s_mov_b32 s23, 0x20000
    buffer_load_dwordx4 v10, s[4:7], s92 offen offset:2048 lds
    buffer_load_dwordx4 v11, s[4:7], s92 offen offset:3072 lds
    s_mov_b32 s32, s58
    s_mov_b32 s33, s59
    s_mov_b32 s34, 3584
    s_mov_b32 s35, 0x20000
    s_add_u32 m0, s100, 16384
    s_nop 0
    buffer_load_dwordx4 v12, s[28:31], s76 offen offset:0 lds
    s_mov_b32 s16, s60
    s_mov_b32 s17, s61
    s_mov_b32 s18, 1835008
    s_mov_b32 s19, 0x20000
    buffer_load_dwordx4 v13, s[28:31], s76 offen offset:1024 lds
    s_mov_b32 s36, s62
    s_mov_b32 s37, s63
    s_mov_b32 s38, 1024
    s_mov_b32 s39, 0x20000
    buffer_load_dwordx4 v14, s[28:31], s76 offen offset:2048 lds
    s_mov_b32 s24, s66
    s_mov_b32 s25, s67
    s_mov_b32 s26, 16777216
    s_mov_b32 s27, 0x20000
    buffer_load_dwordx4 v15, s[28:31], s76 offen offset:3072 lds
    s_mov_b32 s64, s70
    s_mov_b32 s65, s71
    s_mov_b32 s62, s100
    s_mov_b32 s63, s93
    s_add_u32 s92, s47, 1
    s_and_b32 s92, s92, 7
    s_lshl_b32 s69, s92, 7
    s_mul_i32 s77, s92, 229376
    s_add_u32 s92, s47, 2
    s_and_b32 s92, s92, 7
    s_lshl_b32 s70, s92, 7
    s_mul_i32 s78, s92, 229376
    s_add_u32 s92, s47, 3
    s_and_b32 s92, s92, 7
    s_lshl_b32 s71, s92, 7
    s_mul_i32 s79, s92, 229376
    s_add_u32 s92, s47, 4
    s_and_b32 s92, s92, 7
    s_lshl_b32 s72, s92, 7
    s_mul_i32 s80, s92, 229376
    s_add_u32 s92, s47, 5
    s_and_b32 s92, s92, 7
    s_lshl_b32 s73, s92, 7
    s_mul_i32 s81, s92, 229376
    s_add_u32 s92, s47, 6
    s_and_b32 s92, s92, 7
    s_lshl_b32 s74, s92, 7
    s_mul_i32 s82, s92, 229376
    s_add_u32 s92, s47, 7
    s_and_b32 s92, s92, 7
    s_lshl_b32 s75, s92, 7
    s_mul_i32 s83, s92, 229376
    s_lshl_b32 s44, s3, 1
    s_add_u32 s44, s44, 1
    s_and_b32 s45, s2, 7
    s_lshl_b32 s45, s45, 2
    s_bfe_u32 s92, s2, 0x10003
    s_add_u32 s45, s45, s92
    s_add_u32 s45, s45, 2
    s_bfe_u32 s46, s2, 0x20004
    s_lshr_b32 s92, s2, 7
    s_lshl_b32 s92, s92, 2
    s_add_u32 s46, s46, s92
    v_lshlrev_b32 v1, 4, v0
    s_add_u32 m0, s62, 32768
    s_nop 0
    buffer_load_dwordx4 v8, s[4:7], s69 offen offset:0 lds
    v_and_b32 v29, 3, v0
    v_bfe_u32 v30, v0, 2, 2
    v_lshlrev_b32_e64 v30, 6, v30
    v_bfe_u32 v31, v0, 4, 1
    v_lshl_or_b32 v30, v31, 5, v30
    v_lshl_or_b32 v30, v29, 3, v30
    v_lshl_or_b32 v2, v28, 10, v30
    v_lshl_or_b32 v20, v28, 8, v30
    v_mul_u32_u24 v4, 3072, v25
    v_add_u32_e64 v4, v4, v26
    buffer_load_dwordx4 v9, s[4:7], s69 offen offset:1024 lds
    v_add_u32 v5, 23552, v4
    v_add_u32 v6, 47104, v4
    buffer_load_dwordx4 v10, s[4:7], s69 offen offset:2048 lds
    v_add_u32 v7, 70656, v4
    s_and_b32 s100, s42, 1
    s_mul_i32 s100, s100, 98304
    s_lshl_b32 s101, s3, 7
    s_add_u32 s100, s100, s101
    buffer_load_dwordx4 v11, s[4:7], s69 offen offset:3072 lds
    s_lshl_b32 s90, s42, 2
    s_lshr_b32 s92, 0x1100, s90
    s_add_u32 s92, s92, s47
    s_and_b32 s92, s92, 7
    s_mul_i32 s92, s92, 196608
    s_add_u32 s84, s92, s100
    s_lshr_b32 s92, 0x3322, s90
    s_add_u32 s92, s92, s47
    s_and_b32 s92, s92, 7
    s_mul_i32 s92, s92, 196608
    s_add_u32 s85, s92, s100
    s_add_u32 m0, s62, 49152
    s_nop 0
    buffer_load_dwordx4 v12, s[28:31], s77 offen offset:0 lds
    s_lshr_b32 s92, 0x5544, s90
    s_add_u32 s92, s92, s47
    s_and_b32 s92, s92, 7
    s_mul_i32 s92, s92, 196608
    s_add_u32 s86, s92, s100
    s_lshr_b32 s92, 0x7766, s90
    s_add_u32 s92, s92, s47
    s_and_b32 s92, s92, 7
    s_mul_i32 s92, s92, 196608
    s_add_u32 s87, s92, s100
    v_bfe_u32 v49, v0, 4, 1
    v_bfe_u32 v50, v0, 2, 1
    v_cmp_eq_u32 vcc, v49, v50
    v_mov_b32 v49, 0x3f803f80
    s_nop 0
    v_cndmask_b32 v48, 0, v49, vcc
    buffer_load_dwordx4 v13, s[28:31], s77 offen offset:1024 lds
    v_mov_b32 v49, v48
    v_mov_b32 v50, v48
    v_mov_b32 v51, v48
    s_lshr_b32 s90, s42, 1
    s_lshl_b32 s90, s90, 13
    s_and_b32 s92, s42, 1
    s_lshl_b32 s92, s92, 9
    s_add_u32 s90, s90, s92
    v_add_u32_e64 v52, s90, v2
    buffer_load_dwordx4 v14, s[28:31], s77 offen offset:2048 lds
    s_add_u32 s92, s92, 98304
    v_add_u32 v53, s92, v2
    s_lshl_b32 s90, s64, 4
    s_add_u32 s90, s90, s44
    s_lshl_b32 s90, s90, 14
    s_lshl_b32 s92, s42, 9
    s_add_u32 s90, s90, s92
    s_add_u32 s100, s90, 65536
    s_lshl_b32 s90, s65, 11
    s_add_u32 s101, s100, s90
    buffer_load_dwordx4 v15, s[28:31], s77 offen offset:3072 lds
    v_and_b32 v123, 31, v0
    v_lshlrev_b32 v120, 4, v123
    v_lshrrev_b32 v121, 5, v0
    v_lshl_or_b32 v121, v121, 12, v120
    v_add_u32 v122, 8192, v121
    v_lshlrev_b32 v123, 1, v123
    s_lshl_b32 s90, s42, 9
    s_add_u32 s90, s90, 147456
    v_add_u32 v120, s90, v120
    v_lshrrev_b32_e64 v59, 5, v0
    v_lshl_add_u32 v59, v59, 11, v120
    s_mov_b32 s96, 0
    s_mov_b32 s97, -1
    s_lshl_b32 s90, s3, 8
    s_lshl_b32 s92, s42, 6
    s_add_u32 s90, s90, s92
    buffer_load_ushort v60, v123, s[32:35], s90 offen
    s_waitcnt lgkmcnt(0)
    s_mul_i32 s40, s40, 1664525
    s_add_u32 s40, s40, 1013904223
    s_mul_i32 s41, s41, 22695477
    s_add_u32 s41, s41, 1
    v_lshlrev_b32 v31, 10, v25
    v_add_u32 v31, v31, v26
    s_lshl_b32 s90, s46, 7
    v_add_u32_e64 v16, s90, v31
    v_add_u32 v17, 7168, v16
    v_add_u32 v18, 14336, v16
    v_add_u32 v19, 21504, v16
    s_lshr_b32 s64, s46, 0
    s_mul_i32 s64, s64, 1
    s_lshr_b32 s92, s45, 2
    s_mul_i32 s92, s92, 2
    s_add_u32 s64, s64, s92
    s_lshl_b32 s65, s42, 3
    s_add_u32 s92, s64, 0
    s_and_b32 s92, s92, 7
    s_add_u32 s92, s92, s65
    s_lshl_b32 s48, s92, 11
    s_add_u32 s92, s64, 1
    s_and_b32 s92, s92, 7
    s_add_u32 s92, s92, s65
    s_lshl_b32 s49, s92, 11
    s_add_u32 s92, s64, 2
    s_and_b32 s92, s92, 7
    s_add_u32 s92, s92, s65
    s_lshl_b32 s50, s92, 11
    v_and_b32 v26, 3, v0
    v_lshlrev_b32 v26, 2, v26
    v_add_u32 v26, 152576, v26
    s_lshl_b32 s92, s42, 2
    s_add_u32 s92, s92, 152576
    v_mov_b32 v27, s92
    v_mov_b32_e64 v28, 0
    ds_write_b32 v27, v28
    s_waitcnt vmcnt(9) lgkmcnt(0)
    s_barrier
    ds_read_b64_tr_b16 v[32:33], v52 offset:16384
    ds_read_b64_tr_b16 v[34:35], v52 offset:16640
    ds_read_b64_tr_b16 v[36:37], v52 offset:18432
    ds_read_b64_tr_b16 v[38:39], v52 offset:18688
    ds_read_b64_tr_b16 v[40:41], v52 offset:20480
    ds_read_b64_tr_b16 v[42:43], v52 offset:20736
    ds_read_b64_tr_b16 v[44:45], v52 offset:22528
    ds_read_b64_tr_b16 v[46:47], v52 offset:22784
    s_add_u32 m0, s62, 98304
    s_nop 0
    buffer_load_dwordx4 v4, s[8:11], s84 offen offset:0 lds
    buffer_load_dwordx4 v5, s[8:11], s84 offen offset:1024 lds
    buffer_load_dwordx4 v6, s[8:11], s84 offen offset:2048 lds
    buffer_load_dwordx4 v7, s[8:11], s84 offen offset:3072 lds
    s_add_u32 m0, s62, 65536
    s_nop 0
    buffer_load_dwordx4 v8, s[4:7], s70 offen offset:0 lds
    s_waitcnt lgkmcnt(0)
    s_setprio 2
    v_mfma_f32_16x16x32_bf16 v[64:67], v[48:51], v[32:35], 0
    v_mfma_f32_16x16x32_bf16 v[64:67], v[48:51], v[36:39], v[64:67]
    v_mfma_f32_16x16x32_bf16 v[64:67], v[48:51], v[40:43], v[64:67]
    v_mfma_f32_16x16x32_bf16 v[64:67], v[48:51], v[44:47], v[64:67]
    s_setprio 0
    buffer_load_dwordx4 v9, s[4:7], s70 offen offset:1024 lds
    buffer_load_dwordx4 v10, s[4:7], s70 offen offset:2048 lds
    buffer_load_dwordx4 v11, s[4:7], s70 offen offset:3072 lds
    s_add_u32 m0, s62, 81920
    s_nop 0
    buffer_load_dwordx4 v12, s[28:31], s78 offen offset:0 lds
    buffer_load_dwordx4 v13, s[28:31], s78 offen offset:1024 lds
    buffer_load_dwordx4 v14, s[28:31], s78 offen offset:2048 lds
    buffer_load_dwordx4 v15, s[28:31], s78 offen offset:3072 lds
    s_waitcnt vmcnt(8)
    s_barrier
    ds_read_b64_tr_b16 v[32:33], v53 offset:0
    ds_read_b64_tr_b16 v[34:35], v53 offset:256
    ds_read_b64_tr_b16 v[36:37], v53 offset:2048
    ds_read_b64_tr_b16 v[38:39], v53 offset:2304
    ds_read_b64_tr_b16 v[40:41], v53 offset:4096
    ds_read_b64_tr_b16 v[42:43], v53 offset:4352
    ds_read_b64_tr_b16 v[44:45], v53 offset:6144
    ds_read_b64_tr_b16 v[46:47], v53 offset:6400
    s_add_u32 m0, s62, 0
    s_nop 0
    buffer_load_dwordx4 v8, s[4:7], s71 offen offset:0 lds
    buffer_load_dwordx4 v9, s[4:7], s71 offen offset:1024 lds
    buffer_load_dwordx4 v10, s[4:7], s71 offen offset:2048 lds
    s_waitcnt lgkmcnt(0)
    s_setprio 2
    v_mfma_f32_16x16x32_bf16 v[80:83], v[48:51], v[32:35], 0
    v_mfma_f32_16x16x32_bf16 v[80:83], v[48:51], v[36:39], v[80:83]
    v_mfma_f32_16x16x32_bf16 v[80:83], v[48:51], v[40:43], v[80:83]
    v_mfma_f32_16x16x32_bf16 v[80:83], v[48:51], v[44:47], v[80:83]
    s_setprio 0
    buffer_load_dwordx4 v11, s[4:7], s71 offen offset:3072 lds
    s_add_u32 m0, s62, 16384
    s_nop 0
    buffer_load_dwordx4 v12, s[28:31], s79 offen offset:0 lds
    buffer_load_dwordx4 v13, s[28:31], s79 offen offset:1024 lds
    buffer_load_dwordx4 v14, s[28:31], s79 offen offset:2048 lds
    buffer_load_dwordx4 v15, s[28:31], s79 offen offset:3072 lds
    s_waitcnt vmcnt(8)
    s_barrier
    s_add_u32 m0, s62, 32768
    s_nop 0
    buffer_load_dwordx4 v8, s[4:7], s72 offen offset:0 lds
    v_mov_b32 v66, s40
    v_mov_b32 v67, s41
    v_mov_b32_e64 v65, v80
    buffer_load_dwordx4 v9, s[4:7], s72 offen offset:1024 lds
    s_mov_b32 exec_hi, 0
    buffer_store_dwordx4 v[64:67], v1, s[24:27], s101 offen sc1
    s_mov_b32 exec_hi, -1
    buffer_load_dwordx4 v10, s[4:7], s72 offen offset:2048 lds
    buffer_load_dwordx4 v11, s[4:7], s72 offen offset:3072 lds
    s_add_u32 m0, s62, 49152
    s_nop 0
    buffer_load_dwordx4 v12, s[28:31], s80 offen offset:0 lds
    buffer_load_dwordx4 v13, s[28:31], s80 offen offset:1024 lds
    buffer_load_dwordx4 v14, s[28:31], s80 offen offset:2048 lds
    buffer_load_dwordx4 v15, s[28:31], s80 offen offset:3072 lds
    s_waitcnt vmcnt(9)
    s_barrier
    s_add_u32 m0, s62, 65536
    s_nop 0
    buffer_load_dwordx4 v8, s[4:7], s73 offen offset:0 lds
    buffer_load_dwordx4 v9, s[4:7], s73 offen offset:1024 lds
    buffer_load_dwordx4 v10, s[4:7], s73 offen offset:2048 lds
    buffer_load_dwordx4 v11, s[4:7], s73 offen offset:3072 lds
    s_add_u32 m0, s62, 81920
    s_nop 0
    buffer_load_dwordx4 v12, s[28:31], s81 offen offset:0 lds
    buffer_load_dwordx4 v13, s[28:31], s81 offen offset:1024 lds
    buffer_load_dwordx4 v14, s[28:31], s81 offen offset:2048 lds
    buffer_load_dwordx4 v15, s[28:31], s81 offen offset:3072 lds
    s_waitcnt vmcnt(8)
    s_barrier
    s_add_u32 m0, s62, 0
    s_nop 0
    buffer_load_dwordx4 v8, s[4:7], s74 offen offset:0 lds
    buffer_load_dwordx4 v9, s[4:7], s74 offen offset:1024 lds
    buffer_load_dwordx4 v10, s[4:7], s74 offen offset:2048 lds
    buffer_load_dwordx4 v11, s[4:7], s74 offen offset:3072 lds
    s_add_u32 m0, s62, 16384
    s_nop 0
    buffer_load_dwordx4 v12, s[28:31], s82 offen offset:0 lds
    buffer_load_dwordx4 v[96:99], v121, s[24:27], s100 offen offset:0 sc1
    buffer_load_dwordx4 v13, s[28:31], s82 offen offset:1024 lds
    buffer_load_dwordx4 v[100:103], v121, s[24:27], s100 offen offset:2048 sc1
    buffer_load_dwordx4 v14, s[28:31], s82 offen offset:2048 lds
    buffer_load_dwordx4 v[104:107], v122, s[24:27], s100 offen offset:0 sc1
    buffer_load_dwordx4 v15, s[28:31], s82 offen offset:3072 lds
    buffer_load_dwordx4 v[108:111], v122, s[24:27], s100 offen offset:2048 sc1
    s_waitcnt vmcnt(12)
    s_barrier
    s_add_u32 m0, s62, 32768
    s_nop 0
    buffer_load_dwordx4 v8, s[4:7], s75 offen offset:0 lds
    buffer_load_dwordx4 v9, s[4:7], s75 offen offset:1024 lds
    buffer_load_dwordx4 v10, s[4:7], s75 offen offset:2048 lds
    buffer_load_dwordx4 v11, s[4:7], s75 offen offset:3072 lds
    s_add_u32 m0, s62, 49152
    s_nop 0
    buffer_load_dwordx4 v12, s[28:31], s83 offen offset:0 lds
    buffer_load_dwordx4 v13, s[28:31], s83 offen offset:1024 lds
    buffer_load_dwordx4 v14, s[28:31], s83 offen offset:2048 lds
    buffer_load_dwordx4 v15, s[28:31], s83 offen offset:3072 lds
    s_waitcnt vmcnt(9)
    s_barrier
    s_add_u32 m0, s62, 114688
    s_nop 0
    buffer_load_dwordx4 v4, s[8:11], s85 offen offset:0 lds
    buffer_load_dwordx4 v5, s[8:11], s85 offen offset:1024 lds
    buffer_load_dwordx4 v6, s[8:11], s85 offen offset:2048 lds
    buffer_load_dwordx4 v7, s[8:11], s85 offen offset:3072 lds
    v_xor_b32 v98, s40, v98
    v_xor_b32 v99, s41, v99
    v_xor_b32 v102, s40, v102
    v_xor_b32 v103, s41, v103
    v_xor_b32 v106, s40, v106
    v_xor_b32 v107, s41, v107
    s_waitcnt vmcnt(12)
    v_xor_b32 v110, s40, v110
    v_xor_b32 v111, s41, v111
    v_or_b32 v98, v98, v99
    v_or3_b32 v98, v98, v102, v103
    v_or3_b32 v98, v98, v106, v107
    v_or3_b32 v98, v98, v110, v111
    v_cmp_ne_u32 vcc, 0, v98
    s_nop 1
    s_cbranch_vccnz L_slow_eg39
L_ret_eg40:
    s_add_u32 m0, s62, 131072
    s_nop 0
    buffer_load_dwordx4 v4, s[8:11], s86 offen offset:0 lds
    v_add_f32 v36, v96, v100
    v_add_f32 v37, v104, v108
    v_add_f32 v44, v97, v101
    v_add_f32 v45, v105, v109
    v_add_f32 v36, v36, v37
    buffer_load_dwordx4 v5, s[8:11], s86 offen offset:1024 lds
    v_mov_b32 v35, 0
    v_add_f32 v44, v44, v45
    v_mov_b32 v43, 0
    v_mov_b32_e64 v37, v36
    v_lshl_or_b32 v32, v60, 16, v60
    v_mov_b32 v45, v44
    v_mov_b32 v40, 0
    v_permlane32_swap_b32 v36, v37
    buffer_load_dwordx4 v6, s[8:11], s86 offen offset:2048 lds
    v_permlane32_swap_b32 v44, v45
    v_add_f32 v36, v36, v37
    v_add_f32 v44, v44, v45
    v_cvt_pk_bf16_f32 v34, v36, v35
    v_cvt_pk_bf16_f32 v42, v44, v43
    v_lshlrev_b32 v37, 16, v34
    v_lshlrev_b32 v45, 16, v42
    buffer_load_dwordx4 v7, s[8:11], s86 offen offset:3072 lds
    v_sub_f32 v37, v36, v37
    v_sub_f32 v45, v44, v45
    v_cvt_pk_bf16_f32 v33, v36, v37
    v_cvt_pk_bf16_f32 v41, v44, v45
    v_cndmask_b32 v32, v32, v40, s[96:97]
    v_cndmask_b32 v33, v33, v41, s[96:97]
    v_cndmask_b32 v34, v34, v42, s[96:97]
    ds_write_b128 v59, v[32:35]
    s_waitcnt vmcnt(8)
    s_barrier
    s_add_u32 m0, s62, 65536
    s_nop 0
    buffer_load_dwordx4 v4, s[8:11], s87 offen offset:0 lds
    buffer_load_dwordx4 v5, s[8:11], s87 offen offset:1024 lds
    buffer_load_dwordx4 v6, s[8:11], s87 offen offset:2048 lds
    buffer_load_dwordx4 v7, s[8:11], s87 offen offset:3072 lds
    s_lshl_b32 s91, s48, 4
    s_add_u32 m0, s62, 0
    s_nop 0
    buffer_load_dwordx4 v16, s[16:19], s91 offen offset:0 lds
    buffer_load_dwordx4 v17, s[16:19], s91 offen offset:1024 lds
    buffer_load_dwordx4 v18, s[16:19], s91 offen offset:2048 lds
    buffer_load_dwordx4 v19, s[16:19], s91 offen offset:3072 lds
    s_waitcnt lgkmcnt(0)
    s_barrier
    s_lshl_b32 s91, s49, 4
    s_add_u32 m0, s62, 16384
    s_nop 0
    buffer_load_dwordx4 v16, s[16:19], s91 offen offset:0 lds
    s_and_b32 s90, s42, 1
    s_lshl_b32 s90, s90, 9
    s_add_u32 s90, s90, s62
    v_add_u32 v20, s90, v20
    v_xor_b32 v21, 512, v20
    s_mul_i32 s92, s45, 229376
    s_add_u32 s92, s92, 4194304
    v_add_u32 v23, s92, v1
    s_lshr_b32 s90, s42, 1
    s_mul_i32 s90, s90, 114688
    v_add_u32_e64 v22, s90, v23
    s_sub_u32 s90, 114688, s90
    v_add_u32 v23, s90, v23
    buffer_load_dwordx4 v17, s[16:19], s91 offen offset:1024 lds
    v_and_b32 v30, 1, v0
    v_lshlrev_b32_e64 v30, 8, v30
    v_bfe_u32 v31, v0, 1, 1
    v_lshl_or_b32 v30, v31, 11, v30
    s_lshl_b32 s90, s42, 9
    s_lshl_b32 s92, s45, 12
    s_add_u32 s90, s90, s92
    s_add_u32 s90, s90, 589824
    v_add_u32 v24, s90, v30
    s_mov_b32 s94, 0xffff0000
    s_mov_b32 s95, 0xffff0000
    s_mov_b32 s96, 0
    s_mov_b32 s97, -1
    buffer_load_dwordx4 v18, s[16:19], s91 offen offset:2048 lds
    s_add_u32 s92, s64, 3
    s_and_b32 s92, s92, 7
    s_add_u32 s92, s92, s65
    s_lshl_b32 s51, s92, 11
    s_add_u32 s92, s64, 4
    s_and_b32 s92, s92, 7
    s_add_u32 s92, s92, s65
    s_lshl_b32 s52, s92, 11
    s_add_u32 s92, s64, 5
    s_and_b32 s92, s92, 7
    s_add_u32 s92, s92, s65
    s_lshl_b32 s53, s92, 11
    buffer_load_dwordx4 v19, s[16:19], s91 offen offset:3072 lds
    s_add_u32 s92, s64, 6
    s_and_b32 s92, s92, 7
    s_add_u32 s92, s92, s65
    s_lshl_b32 s54, s92, 11
    s_add_u32 s92, s64, 7
    s_and_b32 s92, s92, 7
    s_add_u32 s92, s92, s65
    s_lshl_b32 s55, s92, 11
    s_mul_i32 s92, s64, 43
    s_lshr_b32 s92, s92, 8
    s_mul_i32 s92, s92, 6
    s_sub_u32 s64, s64, s92
    s_lshl_b32 s100, s42, 2
    s_add_u32 s100, s100, 32
    s_lshl_b32 s101, s42, 1
    s_add_u32 s101, s101, 44
    s_lshl_b32 s91, s50, 4
    s_add_u32 m0, s62, 32768
    s_nop 0
    buffer_load_dwordx4 v16, s[16:19], s91 offen offset:0 lds
    s_add_u32 s92, s64, 0
    s_cmp_ge_u32 s92, 6
    s_cselect_b32 s56, 6, 0
    s_sub_u32 s92, s92, s56
    s_cmp_lt_u32 s92, 4
    s_cselect_b32 s56, s100, s101
    s_add_u32 s92, s92, s56
    s_lshl_b32 s56, s92, 11
    buffer_load_dwordx4 v17, s[16:19], s91 offen offset:1024 lds
    s_add_u32 s92, s64, 1
    s_cmp_ge_u32 s92, 6
    s_cselect_b32 s57, 6, 0
    s_sub_u32 s92, s92, s57
    s_cmp_lt_u32 s92, 4
    s_cselect_b32 s57, s100, s101
    s_add_u32 s92, s92, s57
    s_lshl_b32 s57, s92, 11
    s_add_u32 s92, s64, 2
    s_cmp_ge_u32 s92, 6
    s_cselect_b32 s58, 6, 0
    s_sub_u32 s92, s92, s58
    s_cmp_lt_u32 s92, 4
    s_cselect_b32 s58, s100, s101
    s_add_u32 s92, s92, s58
    s_lshl_b32 s58, s92, 11
    buffer_load_dwordx4 v18, s[16:19], s91 offen offset:2048 lds
    s_add_u32 s92, s64, 3
    s_cmp_ge_u32 s92, 6
    s_cselect_b32 s59, 6, 0
    s_sub_u32 s92, s92, s59
    s_cmp_lt_u32 s92, 4
    s_cselect_b32 s59, s100, s101
    s_add_u32 s92, s92, s59
    s_lshl_b32 s59, s92, 11
    buffer_load_dwordx4 v19, s[16:19], s91 offen offset:3072 lds
    s_add_u32 s92, s64, 4
    s_cmp_ge_u32 s92, 6
    s_cselect_b32 s60, 6, 0
    s_sub_u32 s92, s92, s60
    s_cmp_lt_u32 s92, 4
    s_cselect_b32 s60, s100, s101
    s_add_u32 s92, s92, s60
    s_lshl_b32 s60, s92, 11
    s_add_u32 s92, s64, 5
    s_cmp_ge_u32 s92, 6
    s_cselect_b32 s61, 6, 0
    s_sub_u32 s92, s92, s61
    s_cmp_lt_u32 s92, 4
    s_cselect_b32 s61, s100, s101
    s_add_u32 s92, s92, s61
    s_lshl_b32 s61, s92, 11
    s_lshl_b32 s92, s42, 3
    s_lshr_b32 s92, 0x17161514, s92
    s_and_b32 s92, s92, 0xff
    s_mul_i32 s90, s46, 1
    s_add_u32 s90, s90, s42
    s_add_u32 s90, s90, 0
    s_and_b32 s90, s90, 7
    s_add_u32 s90, s90, 0
    s_lshl_b32 s90, s90, 15
    s_lshl_b32 m0, s92, 12
    s_nop 0
    buffer_load_dwordx4 v16, s[20:23], s90 offen offset:0 lds
    buffer_load_dwordx4 v17, s[20:23], s90 offen offset:1024 lds
    buffer_load_dwordx4 v18, s[20:23], s90 offen offset:2048 lds
    buffer_load_dwordx4 v19, s[20:23], s90 offen offset:3072 lds
    s_waitcnt vmcnt(12)
    ds_read_b64_tr_b16 a[0:1], v20 offset:0
    ds_read_b64_tr_b16 a[2:3], v20 offset:1024
    ds_read_b64_tr_b16 a[4:5], v21 offset:0
    ds_read_b64_tr_b16 a[6:7], v21 offset:1024
    ds_read_b64_tr_b16 a[8:9], v20 offset:2048
    ds_read_b64_tr_b16 a[10:11], v20 offset:3072
    ds_read_b64_tr_b16 a[12:13], v21 offset:2048
    ds_read_b64_tr_b16 a[14:15], v21 offset:3072
    v_mov_b32_e64 v28, 1
    ds_write_b32 v27, v28
    s_waitcnt lgkmcnt(1)
    s_lshl_b32 s91, s51, 4
    s_add_u32 m0, s62, 0
    s_nop 0
    buffer_load_dwordx4 v16, s[16:19], s91 offen offset:0 lds
    buffer_load_dwordx4 v17, s[16:19], s91 offen offset:1024 lds
    buffer_load_dwordx4 v18, s[16:19], s91 offen offset:2048 lds
    buffer_load_dwordx4 v19, s[16:19], s91 offen offset:3072 lds
    s_waitcnt vmcnt(12)
    ds_read_b64_tr_b16 a[16:17], v20 offset:16384
    ds_read_b64_tr_b16 a[18:19], v20 offset:17408
    ds_read_b64_tr_b16 a[20:21], v21 offset:16384
    ds_read_b64_tr_b16 a[22:23], v21 offset:17408
    ds_read_b64_tr_b16 a[24:25], v20 offset:18432
    ds_read_b64_tr_b16 a[26:27], v20 offset:19456
    ds_read_b64_tr_b16 a[28:29], v21 offset:18432
    ds_read_b64_tr_b16 a[30:31], v21 offset:19456
    s_waitcnt lgkmcnt(0)
    s_lshl_b32 s91, s52, 4
    s_add_u32 m0, s62, 16384
    s_nop 0
    buffer_load_dwordx4 v16, s[16:19], s91 offen offset:0 lds
    buffer_load_dwordx4 v17, s[16:19], s91 offen offset:1024 lds
    buffer_load_dwordx4 v18, s[16:19], s91 offen offset:2048 lds
    buffer_load_dwordx4 v19, s[16:19], s91 offen offset:3072 lds
    s_waitcnt vmcnt(12)
    ds_read_b64_tr_b16 a[32:33], v20 offset:32768
    ds_read_b64_tr_b16 a[34:35], v20 offset:33792
    ds_read_b64_tr_b16 a[36:37], v21 offset:32768
    ds_read_b64_tr_b16 a[38:39], v21 offset:33792
    ds_read_b64_tr_b16 a[40:41], v20 offset:34816
    ds_read_b64_tr_b16 a[42:43], v20 offset:35840
    ds_read_b64_tr_b16 a[44:45], v21 offset:34816
    ds_read_b64_tr_b16 a[46:47], v21 offset:35840
    s_waitcnt lgkmcnt(0)
    s_lshl_b32 s91, s53, 4
    s_add_u32 m0, s62, 32768
    s_nop 0
    buffer_load_dwordx4 v16, s[16:19], s91 offen offset:0 lds
    buffer_load_dwordx4 v17, s[16:19], s91 offen offset:1024 lds
    buffer_load_dwordx4 v18, s[16:19], s91 offen offset:2048 lds
    buffer_load_dwordx4 v19, s[16:19], s91 offen offset:3072 lds
    s_waitcnt vmcnt(8)
    ds_read_b64_tr_b16 a[48:49], v20 offset:0
    ds_read_b64_tr_b16 a[50:51], v20 offset:1024
    ds_read_b64_tr_b16 a[52:53], v21 offset:0
    ds_read_b64_tr_b16 a[54:55], v21 offset:1024
    ds_read_b64_tr_b16 a[56:57], v20 offset:2048
    ds_read_b64_tr_b16 a[58:59], v20 offset:3072
    ds_read_b64_tr_b16 a[60:61], v21 offset:2048
    ds_read_b64_tr_b16 a[62:63], v21 offset:3072
    s_waitcnt lgkmcnt(0)
    s_lshl_b32 s91, s54, 4
    s_add_u32 m0, s62, 0
    s_nop 0
    buffer_load_dwordx4 v16, s[16:19], s91 offen offset:0 lds
    buffer_load_dwordx4 v17, s[16:19], s91 offen offset:1024 lds
    buffer_load_dwordx4 v18, s[16:19], s91 offen offset:2048 lds
    buffer_load_dwordx4 v19, s[16:19], s91 offen offset:3072 lds
    s_waitcnt vmcnt(8)
    ds_read_b64_tr_b16 a[64:65], v20 offset:16384
    ds_read_b64_tr_b16 a[66:67], v20 offset:17408
    ds_read_b64_tr_b16 a[68:69], v21 offset:16384
    ds_read_b64_tr_b16 a[70:71], v21 offset:17408
    ds_read_b64_tr_b16 a[72:73], v20 offset:18432
    ds_read_b64_tr_b16 a[74:75], v20 offset:19456
    ds_read_b64_tr_b16 a[76:77], v21 offset:18432
    ds_read_b64_tr_b16 a[78:79], v21 offset:19456
    s_waitcnt lgkmcnt(0)
    s_lshl_b32 s91, s55, 4
    s_add_u32 m0, s62, 16384
    s_nop 0
    buffer_load_dwordx4 v16, s[16:19], s91 offen offset:0 lds
    buffer_load_dwordx4 v17, s[16:19], s91 offen offset:1024 lds
    buffer_load_dwordx4 v18, s[16:19], s91 offen offset:2048 lds
    buffer_load_dwordx4 v19, s[16:19], s91 offen offset:3072 lds
    s_waitcnt vmcnt(8)
    ds_read_b64_tr_b16 a[80:81], v20 offset:32768
    ds_read_b64_tr_b16 a[82:83], v20 offset:33792
    ds_read_b64_tr_b16 a[84:85], v21 offset:32768
    ds_read_b64_tr_b16 a[86:87], v21 offset:33792
    ds_read_b64_tr_b16 a[88:89], v20 offset:34816
    ds_read_b64_tr_b16 a[90:91], v20 offset:35840
    ds_read_b64_tr_b16 a[92:93], v21 offset:34816
    ds_read_b64_tr_b16 a[94:95], v21 offset:35840
    s_waitcnt lgkmcnt(0)
    s_lshl_b32 s91, s56, 4
    s_add_u32 m0, s62, 32768
    s_nop 0
    buffer_load_dwordx4 v16, s[16:19], s91 offen offset:0 lds
    buffer_load_dwordx4 v17, s[16:19], s91 offen offset:1024 lds
    buffer_load_dwordx4 v18, s[16:19], s91 offen offset:2048 lds
    buffer_load_dwordx4 v19, s[16:19], s91 offen offset:3072 lds
    s_waitcnt vmcnt(8)
    ds_read_b64_tr_b16 a[96:97], v20 offset:0
    ds_read_b64_tr_b16 a[98:99], v20 offset:1024
    ds_read_b64_tr_b16 a[100:101], v21 offset:0
    ds_read_b64_tr_b16 a[102:103], v21 offset:1024
    ds_read_b64_tr_b16 a[104:105], v20 offset:2048
    ds_read_b64_tr_b16 a[106:107], v20 offset:3072
    ds_read_b64_tr_b16 a[108:109], v21 offset:2048
    ds_read_b64_tr_b16 a[110:111], v21 offset:3072
    s_waitcnt lgkmcnt(0)
    s_lshl_b32 s91, s57, 4
    s_add_u32 m0, s62, 0
    s_nop 0
    buffer_load_dwordx4 v16, s[16:19], s91 offen offset:0 lds
    buffer_load_dwordx4 v17, s[16:19], s91 offen offset:1024 lds
    buffer_load_dwordx4 v18, s[16:19], s91 offen offset:2048 lds
    buffer_load_dwordx4 v19, s[16:19], s91 offen offset:3072 lds
    s_waitcnt vmcnt(8)
    ds_read_b64_tr_b16 a[112:113], v20 offset:16384
    ds_read_b64_tr_b16 a[114:115], v20 offset:17408
    ds_read_b64_tr_b16 a[116:117], v21 offset:16384
    ds_read_b64_tr_b16 a[118:119], v21 offset:17408
    ds_read_b64_tr_b16 a[120:121], v20 offset:18432
    ds_read_b64_tr_b16 a[122:123], v20 offset:19456
    ds_read_b64_tr_b16 a[124:125], v21 offset:18432
    ds_read_b64_tr_b16 a[126:127], v21 offset:19456
    s_waitcnt lgkmcnt(0)
    s_lshl_b32 s91, s58, 4
    s_add_u32 m0, s62, 16384
    s_nop 0
    buffer_load_dwordx4 v16, s[16:19], s91 offen offset:0 lds
    buffer_load_dwordx4 v17, s[16:19], s91 offen offset:1024 lds
    buffer_load_dwordx4 v18, s[16:19], s91 offen offset:2048 lds
    buffer_load_dwordx4 v19, s[16:19], s91 offen offset:3072 lds
    s_lshl_b32 s76, s42, 9
    s_lshl_b32 s92, s45, 12
    s_add_u32 s76, s76, s92
    s_add_u32 s76, s76, 589824
    s_lshl_b32 s92, s42, 3
    s_lshr_b32 s92, 0xf0e0d0c, s92
    s_and_b32 s92, s92, 0xff
    s_mul_i32 s90, s46, 1
    s_add_u32 s90, s90, s42
    s_add_u32 s90, s90, 4
    s_and_b32 s90, s90, 7
    s_add_u32 s90, s90, 0
    s_lshl_b32 s90, s90, 15
    s_lshl_b32 m0, s92, 12
    s_nop 0
    buffer_load_dwordx4 v16, s[20:23], s90 offen offset:0 lds
    buffer_load_dwordx4 v17, s[20:23], s90 offen offset:1024 lds
    buffer_load_dwordx4 v18, s[20:23], s90 offen offset:2048 lds
    buffer_load_dwordx4 v19, s[20:23], s90 offen offset:3072 lds
    ds_read_b32 v30, v26 offset:16
    s_waitcnt lgkmcnt(0)
    v_cmp_gt_u32 vcc, 2, v30
    s_nop 1
    s_cbranch_vccnz L_lslow45
L_lret46:
    s_lshl_b32 s92, s42, 3
    s_lshr_b32 s92, 0x1b1a1918, s92
    s_and_b32 s92, s92, 0xff
    s_mul_i32 s90, s46, 1
    s_add_u32 s90, s90, s42
    s_add_u32 s90, s90, 0
    s_and_b32 s90, s90, 7
    s_add_u32 s90, s90, 8
    s_lshl_b32 s90, s90, 15
    s_lshl_b32 m0, s92, 12
    s_nop 0
    buffer_load_dwordx4 v16, s[20:23], s90 offen offset:0 lds
    buffer_load_dwordx4 v17, s[20:23], s90 offen offset:1024 lds
    buffer_load_dwordx4 v18, s[20:23], s90 offen offset:2048 lds
    buffer_load_dwordx4 v19, s[20:23], s90 offen offset:3072 lds
    s_lshl_b32 s92, s42, 3
    s_lshr_b32 s92, 0x1f1e1d1c, s92
    s_and_b32 s92, s92, 0xff
    s_mul_i32 s90, s46, 1
    s_add_u32 s90, s90, s42
    s_add_u32 s90, s90, 4
    s_and_b32 s90, s90, 7
    s_add_u32 s90, s90, 8
    s_lshl_b32 s90, s90, 15
    s_lshl_b32 m0, s92, 12
    s_nop 0
    buffer_load_dwordx4 v16, s[20:23], s90 offen offset:0 lds
    buffer_load_dwordx4 v17, s[20:23], s90 offen offset:1024 lds
    buffer_load_dwordx4 v18, s[20:23], s90 offen offset:2048 lds
    buffer_load_dwordx4 v19, s[20:23], s90 offen offset:3072 lds
    s_buffer_load_dwordx2 s[68:69], s[24:27], s76 offset:128 glc
    s_buffer_load_dwordx2 s[70:71], s[24:27], s76 offset:384 glc
    s_buffer_load_dwordx2 s[72:73], s[24:27], s76 offset:2176 glc
    s_buffer_load_dwordx2 s[74:75], s[24:27], s76 offset:2432 glc
    s_waitcnt lgkmcnt(0)
    s_xor_b64 s[68:69], s[68:69], s[40:41]
    s_xor_b64 s[70:71], s[70:71], s[40:41]
    s_xor_b64 s[72:73], s[72:73], s[40:41]
    s_xor_b64 s[74:75], s[74:75], s[40:41]
    s_or_b64 s[68:69], s[68:69], s[70:71]
    s_or_b64 s[68:69], s[68:69], s[72:73]
    s_or_b64 s[68:69], s[68:69], s[74:75]
    s_cbranch_scc1 L_slow_h41
L_ret_h42:
    buffer_load_dwordx4 v[32:35], v22, s[24:27], s48 offen offset:0 sc1
    buffer_load_dwordx4 v[36:39], v23, s[24:27], s48 offen offset:0 sc1
    buffer_load_dwordx4 v[40:43], v22, s[24:27], s48 offen offset:1024 sc1
    buffer_load_dwordx4 v[44:47], v23, s[24:27], s48 offen offset:1024 sc1
    buffer_load_dwordx4 v[48:51], v22, s[24:27], s49 offen offset:0 sc1
    buffer_load_dwordx4 v[52:55], v23, s[24:27], s49 offen offset:0 sc1
    buffer_load_dwordx4 v[56:59], v22, s[24:27], s49 offen offset:1024 sc1
    buffer_load_dwordx4 v[60:63], v23, s[24:27], s49 offen offset:1024 sc1
    s_lshl_b32 s92, s46, 1
    s_and_b32 s93, s42, 1
    s_add_u32 s92, s92, s93
    s_lshl_b32 s92, s92, 6
    v_and_b32 v5, 31, v0
    v_lshlrev_b32 v5, 1, v5
    buffer_load_ushort v4, v5, s[36:39], s92 offen
    s_waitcnt vmcnt(9)
    v_mov_b32_e64 v28, 3
    ds_write_b32 v27, v28
    buffer_load_dwordx4 v[8:11], v22, s[24:27], s50 offen offset:0 sc1
    s_waitcnt vmcnt(9)
    v_mfma_f32_32x32x16_bf16 v[64:79], a[0:3], v[32:35], 0
    v_mfma_f32_32x32x16_bf16 v[80:95], a[4:7], v[32:35], 0
    buffer_load_dwordx4 v[12:15], v23, s[24:27], s50 offen offset:0 sc1
    s_waitcnt vmcnt(9)
    v_mfma_f32_32x32x16_bf16 v[96:111], a[0:3], v[36:39], 0
    v_mfma_f32_32x32x16_bf16 v[112:127], a[4:7], v[36:39], 0
    buffer_load_dwordx4 v[32:35], v22, s[24:27], s50 offen offset:1024 sc1
    s_waitcnt vmcnt(9)
    v_mfma_f32_32x32x16_bf16 v[64:79], a[8:11], v[40:43], v[64:79]
    v_mfma_f32_32x32x16_bf16 v[80:95], a[12:15], v[40:43], v[80:95]
    buffer_load_dwordx4 v[36:39], v23, s[24:27], s50 offen offset:1024 sc1
    s_waitcnt vmcnt(9)
    v_mfma_f32_32x32x16_bf16 v[96:111], a[8:11], v[44:47], v[96:111]
    v_mfma_f32_32x32x16_bf16 v[112:127], a[12:15], v[44:47], v[112:127]
    buffer_load_dwordx4 v[40:43], v22, s[24:27], s51 offen offset:0 sc1
    s_waitcnt vmcnt(9)
    v_mfma_f32_32x32x16_bf16 v[64:79], a[16:19], v[48:51], v[64:79]
    ds_read_b64_tr_b16 a[0:1], v20 offset:32768
    ds_read_b64_tr_b16 a[2:3], v20 offset:33792
    v_mfma_f32_32x32x16_bf16 v[80:95], a[20:23], v[48:51], v[80:95]
    ds_read_b64_tr_b16 a[4:5], v21 offset:32768
    ds_read_b64_tr_b16 a[6:7], v21 offset:33792
    buffer_load_dwordx4 v[44:47], v23, s[24:27], s51 offen offset:0 sc1
    s_waitcnt vmcnt(9)
    v_mfma_f32_32x32x16_bf16 v[96:111], a[16:19], v[52:55], v[96:111]
    ds_read_b64_tr_b16 a[8:9], v20 offset:34816
    ds_read_b64_tr_b16 a[10:11], v20 offset:35840
    v_mfma_f32_32x32x16_bf16 v[112:127], a[20:23], v[52:55], v[112:127]
    ds_read_b64_tr_b16 a[12:13], v21 offset:34816
    ds_read_b64_tr_b16 a[14:15], v21 offset:35840
    buffer_load_dwordx4 v[48:51], v22, s[24:27], s51 offen offset:1024 sc1
    s_waitcnt vmcnt(9)
    v_mfma_f32_32x32x16_bf16 v[64:79], a[24:27], v[56:59], v[64:79]
    v_mfma_f32_32x32x16_bf16 v[80:95], a[28:31], v[56:59], v[80:95]
    s_waitcnt lgkmcnt(0)
    s_lshl_b32 s91, s59, 4
    s_add_u32 m0, s62, 32768
    s_nop 0
    buffer_load_dwordx4 v16, s[16:19], s91 offen offset:0 lds
    buffer_load_dwordx4 v[52:55], v23, s[24:27], s51 offen offset:1024 sc1
    s_waitcnt vmcnt(10)
    v_mfma_f32_32x32x16_bf16 v[96:111], a[24:27], v[60:63], v[96:111]
    buffer_load_dwordx4 v17, s[16:19], s91 offen offset:1024 lds
    v_mfma_f32_32x32x16_bf16 v[112:127], a[28:31], v[60:63], v[112:127]
    buffer_load_dwordx4 v18, s[16:19], s91 offen offset:2048 lds
    buffer_load_dwordx4 v19, s[16:19], s91 offen offset:3072 lds
    buffer_load_dwordx4 v[56:59], v22, s[24:27], s52 offen offset:0 sc1
    s_waitcnt vmcnt(12)
    v_mfma_f32_32x32x16_bf16 v[64:79], a[32:35], v[8:11], v[64:79]
    ds_read_b64_tr_b16 a[16:17], v20 offset:0
    ds_read_b64_tr_b16 a[18:19], v20 offset:1024
    v_mfma_f32_32x32x16_bf16 v[80:95], a[36:39], v[8:11], v[80:95]
    ds_read_b64_tr_b16 a[20:21], v21 offset:0
    ds_read_b64_tr_b16 a[22:23], v21 offset:1024
    buffer_load_dwordx4 v[60:63], v23, s[24:27], s52 offen offset:0 sc1
    s_waitcnt vmcnt(12)
    v_mfma_f32_32x32x16_bf16 v[96:111], a[32:35], v[12:15], v[96:111]
    ds_read_b64_tr_b16 a[24:25], v20 offset:2048
    ds_read_b64_tr_b16 a[26:27], v20 offset:3072
    v_mfma_f32_32x32x16_bf16 v[112:127], a[36:39], v[12:15], v[112:127]
    ds_read_b64_tr_b16 a[28:29], v21 offset:2048
    ds_read_b64_tr_b16 a[30:31], v21 offset:3072
    buffer_load_dwordx4 v[8:11], v22, s[24:27], s52 offen offset:1024 sc1
    s_waitcnt vmcnt(12)
    v_mfma_f32_32x32x16_bf16 v[64:79], a[40:43], v[32:35], v[64:79]
    v_mfma_f32_32x32x16_bf16 v[80:95], a[44:47], v[32:35], v[80:95]
    s_waitcnt lgkmcnt(0)
    s_lshl_b32 s91, s60, 4
    s_add_u32 m0, s62, 0
    s_nop 0
    buffer_load_dwordx4 v16, s[16:19], s91 offen offset:0 lds
    buffer_load_dwordx4 v[12:15], v23, s[24:27], s52 offen offset:1024 sc1
    s_waitcnt vmcnt(13)
    v_mfma_f32_32x32x16_bf16 v[96:111], a[40:43], v[36:39], v[96:111]
    buffer_load_dwordx4 v17, s[16:19], s91 offen offset:1024 lds
    v_mfma_f32_32x32x16_bf16 v[112:127], a[44:47], v[36:39], v[112:127]
    buffer_load_dwordx4 v18, s[16:19], s91 offen offset:2048 lds
    buffer_load_dwordx4 v19, s[16:19], s91 offen offset:3072 lds
    buffer_load_dwordx4 v[32:35], v22, s[24:27], s53 offen offset:0 sc1
    s_waitcnt vmcnt(16)
    v_mfma_f32_32x32x16_bf16 v[64:79], a[48:51], v[40:43], v[64:79]
    ds_read_b64_tr_b16 a[32:33], v20 offset:16384
    ds_read_b64_tr_b16 a[34:35], v20 offset:17408
    v_mfma_f32_32x32x16_bf16 v[80:95], a[52:55], v[40:43], v[80:95]
    ds_read_b64_tr_b16 a[36:37], v21 offset:16384
    ds_read_b64_tr_b16 a[38:39], v21 offset:17408
    buffer_load_dwordx4 v[36:39], v23, s[24:27], s53 offen offset:0 sc1
    s_waitcnt vmcnt(16)
    v_mfma_f32_32x32x16_bf16 v[96:111], a[48:51], v[44:47], v[96:111]
    ds_read_b64_tr_b16 a[40:41], v20 offset:18432
    ds_read_b64_tr_b16 a[42:43], v20 offset:19456
    v_mfma_f32_32x32x16_bf16 v[112:127], a[52:55], v[44:47], v[112:127]
    ds_read_b64_tr_b16 a[44:45], v21 offset:18432
    ds_read_b64_tr_b16 a[46:47], v21 offset:19456
    buffer_load_dwordx4 v[40:43], v22, s[24:27], s53 offen offset:1024 sc1
    s_waitcnt vmcnt(16)
    v_mfma_f32_32x32x16_bf16 v[64:79], a[56:59], v[48:51], v[64:79]
    v_mfma_f32_32x32x16_bf16 v[80:95], a[60:63], v[48:51], v[80:95]
    s_waitcnt lgkmcnt(0)
    s_lshl_b32 s91, s61, 4
    s_add_u32 m0, s62, 16384
    s_nop 0
    buffer_load_dwordx4 v16, s[16:19], s91 offen offset:0 lds
    buffer_load_dwordx4 v[44:47], v23, s[24:27], s53 offen offset:1024 sc1
    s_waitcnt vmcnt(16)
    v_mfma_f32_32x32x16_bf16 v[96:111], a[56:59], v[52:55], v[96:111]
    buffer_load_dwordx4 v17, s[16:19], s91 offen offset:1024 lds
    v_mfma_f32_32x32x16_bf16 v[112:127], a[60:63], v[52:55], v[112:127]
    buffer_load_dwordx4 v18, s[16:19], s91 offen offset:2048 lds
    buffer_load_dwordx4 v19, s[16:19], s91 offen offset:3072 lds
    buffer_load_dwordx4 v[48:51], v22, s[24:27], s54 offen offset:0 sc1
    s_waitcnt vmcnt(16)
    v_mfma_f32_32x32x16_bf16 v[64:79], a[64:67], v[56:59], v[64:79]
    ds_read_b64_tr_b16 a[48:49], v20 offset:32768
    ds_read_b64_tr_b16 a[50:51], v20 offset:33792
    v_mfma_f32_32x32x16_bf16 v[80:95], a[68:71], v[56:59], v[80:95]
    ds_read_b64_tr_b16 a[52:53], v21 offset:32768
    ds_read_b64_tr_b16 a[54:55], v21 offset:33792
    buffer_load_dwordx4 v[52:55], v23, s[24:27], s54 offen offset:0 sc1
    s_waitcnt vmcnt(16)
    v_mfma_f32_32x32x16_bf16 v[96:111], a[64:67], v[60:63], v[96:111]
    ds_read_b64_tr_b16 a[56:57], v20 offset:34816
    ds_read_b64_tr_b16 a[58:59], v20 offset:35840
    v_mfma_f32_32x32x16_bf16 v[112:127], a[68:71], v[60:63], v[112:127]
    ds_read_b64_tr_b16 a[60:61], v21 offset:34816
    ds_read_b64_tr_b16 a[62:63], v21 offset:35840
    buffer_load_dwordx4 v[56:59], v22, s[24:27], s54 offen offset:1024 sc1
    s_waitcnt vmcnt(16)
    v_mfma_f32_32x32x16_bf16 v[64:79], a[72:75], v[8:11], v[64:79]
    s_buffer_load_dwordx2 s[68:69], s[24:27], s76 offset:0 glc
    v_mfma_f32_32x32x16_bf16 v[80:95], a[76:79], v[8:11], v[80:95]
    s_buffer_load_dwordx2 s[70:71], s[24:27], s76 offset:256 glc
    buffer_load_dwordx4 v[60:63], v23, s[24:27], s54 offen offset:1024 sc1
    s_waitcnt vmcnt(15)
    v_mfma_f32_32x32x16_bf16 v[96:111], a[72:75], v[12:15], v[96:111]
    s_buffer_load_dwordx2 s[72:73], s[24:27], s76 offset:2048 glc
    v_mfma_f32_32x32x16_bf16 v[112:127], a[76:79], v[12:15], v[112:127]
    s_buffer_load_dwordx2 s[74:75], s[24:27], s76 offset:2304 glc
    buffer_load_dwordx4 v[8:11], v22, s[24:27], s55 offen offset:0 sc1
    s_waitcnt vmcnt(12)
    v_mfma_f32_32x32x16_bf16 v[64:79], a[80:83], v[32:35], v[64:79]
    ds_read_b64_tr_b16 a[64:65], v20 offset:0
    ds_read_b64_tr_b16 a[66:67], v20 offset:1024
    v_mfma_f32_32x32x16_bf16 v[80:95], a[84:87], v[32:35], v[80:95]
    ds_read_b64_tr_b16 a[68:69], v21 offset:0
    ds_read_b64_tr_b16 a[70:71], v21 offset:1024
    buffer_load_dwordx4 v[12:15], v23, s[24:27], s55 offen offset:0 sc1
    s_waitcnt vmcnt(12)
    v_mfma_f32_32x32x16_bf16 v[96:111], a[80:83], v[36:39], v[96:111]
    ds_read_b64_tr_b16 a[72:73], v20 offset:2048
    ds_read_b64_tr_b16 a[74:75], v20 offset:3072
    v_mfma_f32_32x32x16_bf16 v[112:127], a[84:87], v[36:39], v[112:127]
    ds_read_b64_tr_b16 a[76:77], v21 offset:2048
    ds_read_b64_tr_b16 a[78:79], v21 offset:3072
    buffer_load_dwordx4 v[32:35], v22, s[24:27], s55 offen offset:1024 sc1
    s_waitcnt vmcnt(12)
    v_mfma_f32_32x32x16_bf16 v[64:79], a[88:91], v[40:43], v[64:79]
    v_mfma_f32_32x32x16_bf16 v[80:95], a[92:95], v[40:43], v[80:95]
    buffer_load_dwordx4 v[36:39], v23, s[24:27], s55 offen offset:1024 sc1
    s_waitcnt vmcnt(11)
    v_mfma_f32_32x32x16_bf16 v[96:111], a[88:91], v[44:47], v[96:111]
    v_mfma_f32_32x32x16_bf16 v[112:127], a[92:95], v[44:47], v[112:127]
    s_waitcnt lgkmcnt(0)
    s_xor_b64 s[68:69], s[68:69], s[40:41]
    s_xor_b64 s[70:71], s[70:71], s[40:41]
    s_xor_b64 s[72:73], s[72:73], s[40:41]
    s_xor_b64 s[74:75], s[74:75], s[40:41]
    s_or_b64 s[68:69], s[68:69], s[70:71]
    s_or_b64 s[68:69], s[68:69], s[72:73]
    s_or_b64 s[68:69], s[68:69], s[74:75]
    s_cbranch_scc1 L_slow_h243
L_ret_h244:
    buffer_load_dwordx4 v[40:43], v22, s[24:27], s56 offen offset:0 sc1
    s_waitcnt vmcnt(8)
    v_mfma_f32_32x32x16_bf16 v[64:79], a[96:99], v[48:51], v[64:79]
    ds_read_b64_tr_b16 a[80:81], v20 offset:16384
    ds_read_b64_tr_b16 a[82:83], v20 offset:17408
    v_mfma_f32_32x32x16_bf16 v[80:95], a[100:103], v[48:51], v[80:95]
    ds_read_b64_tr_b16 a[84:85], v21 offset:16384
    ds_read_b64_tr_b16 a[86:87], v21 offset:17408
    buffer_load_dwordx4 v[44:47], v23, s[24:27], s56 offen offset:0 sc1
    s_waitcnt vmcnt(8)
    v_mfma_f32_32x32x16_bf16 v[96:111], a[96:99], v[52:55], v[96:111]
    ds_read_b64_tr_b16 a[88:89], v20 offset:18432
    ds_read_b64_tr_b16 a[90:91], v20 offset:19456
    v_mfma_f32_32x32x16_bf16 v[112:127], a[100:103], v[52:55], v[112:127]
    ds_read_b64_tr_b16 a[92:93], v21 offset:18432
    ds_read_b64_tr_b16 a[94:95], v21 offset:19456
    buffer_load_dwordx4 v[48:51], v22, s[24:27], s56 offen offset:1024 sc1
    s_waitcnt vmcnt(8)
    v_mfma_f32_32x32x16_bf16 v[64:79], a[104:107], v[56:59], v[64:79]
    v_mfma_f32_32x32x16_bf16 v[80:95], a[108:111], v[56:59], v[80:95]
    buffer_load_dwordx4 v[52:55], v23, s[24:27], s56 offen offset:1024 sc1
    s_waitcnt vmcnt(8)
    v_mfma_f32_32x32x16_bf16 v[96:111], a[104:107], v[60:63], v[96:111]
    v_mov_b32 v28, 4
    ds_write_b32 v27, v28
    v_mfma_f32_32x32x16_bf16 v[112:127], a[108:111], v[60:63], v[112:127]
    s_setprio 2
    buffer_load_dwordx4 v[56:59], v22, s[24:27], s57 offen offset:0 sc1
    s_waitcnt vmcnt(8)
    v_mfma_f32_32x32x16_bf16 v[64:79], a[112:115], v[8:11], v[64:79]
    v_mfma_f32_32x32x16_bf16 v[80:95], a[116:119], v[8:11], v[80:95]
    buffer_load_dwordx4 v[60:63], v23, s[24:27], s57 offen offset:0 sc1
    s_waitcnt vmcnt(8)
    v_mfma_f32_32x32x16_bf16 v[96:111], a[112:115], v[12:15], v[96:111]
    s_waitcnt lgkmcnt(1)
    v_mov_b32_e64 v28, 5
    ds_write_b32 v27, v28
    v_mfma_f32_32x32x16_bf16 v[112:127], a[116:119], v[12:15], v[112:127]
    buffer_load_dwordx4 v[8:11], v22, s[24:27], s57 offen offset:1024 sc1
    s_waitcnt vmcnt(8)
    v_mfma_f32_32x32x16_bf16 v[64:79], a[120:123], v[32:35], v[64:79]
    v_mfma_f32_32x32x16_bf16 v[80:95], a[124:127], v[32:35], v[80:95]
    buffer_load_dwordx4 v[12:15], v23, s[24:27], s57 offen offset:1024 sc1
    s_waitcnt vmcnt(8)
    v_mfma_f32_32x32x16_bf16 v[96:111], a[120:123], v[36:39], v[96:111]
    v_mfma_f32_32x32x16_bf16 v[112:127], a[124:127], v[36:39], v[112:127]
    buffer_load_dwordx4 v[32:35], v22, s[24:27], s58 offen offset:0 sc1
    s_waitcnt vmcnt(8)
    v_mfma_f32_32x32x16_bf16 v[64:79], a[0:3], v[40:43], v[64:79]
    v_mfma_f32_32x32x16_bf16 v[80:95], a[4:7], v[40:43], v[80:95]
    buffer_load_dwordx4 v[36:39], v23, s[24:27], s58 offen offset:0 sc1
    s_waitcnt vmcnt(8)
    v_mfma_f32_32x32x16_bf16 v[96:111], a[0:3], v[44:47], v[96:111]
    v_mov_b32 v5, 0
    v_mov_b32 v6, 0
    v_mov_b32 v7, 0
    v_mov_b32 v17, 0
    v_mov_b32 v18, 0
    v_mov_b32 v19, 0
    v_mov_b32 v16, 0x3f80
    v_cndmask_b32 v16, v16, v5, s[96:97]
    v_mfma_f32_32x32x16_bf16 v[112:127], a[4:7], v[44:47], v[112:127]
    buffer_load_dwordx4 v[40:43], v22, s[24:27], s58 offen offset:1024 sc1
    s_waitcnt vmcnt(8)
    v_mfma_f32_32x32x16_bf16 v[64:79], a[8:11], v[48:51], v[64:79]
    v_mfma_f32_32x32x16_bf16 v[80:95], a[12:15], v[48:51], v[80:95]
    buffer_load_dwordx4 v[44:47], v23, s[24:27], s58 offen offset:1024 sc1
    s_waitcnt vmcnt(8)
    v_mfma_f32_32x32x16_bf16 v[96:111], a[8:11], v[52:55], v[96:111]
    v_mfma_f32_32x32x16_bf16 v[112:127], a[12:15], v[52:55], v[112:127]
    buffer_load_dwordx4 v[48:51], v22, s[24:27], s59 offen offset:0 sc1
    s_waitcnt vmcnt(8)
    v_mfma_f32_32x32x16_bf16 v[64:79], a[16:19], v[56:59], v[64:79]
    v_mfma_f32_32x32x16_bf16 v[80:95], a[20:23], v[56:59], v[80:95]
    buffer_load_dwordx4 v[52:55], v23, s[24:27], s59 offen offset:0 sc1
    s_waitcnt vmcnt(8)
    v_mfma_f32_32x32x16_bf16 v[96:111], a[16:19], v[60:63], v[96:111]
    v_mfma_f32_32x32x16_bf16 v[64:79], v[4:7], v[16:19], v[64:79]
    v_mfma_f32_32x32x16_bf16 v[112:127], a[20:23], v[60:63], v[112:127]
    buffer_load_dwordx4 v[56:59], v22, s[24:27], s59 offen offset:1024 sc1
    s_waitcnt vmcnt(8)
    v_mfma_f32_32x32x16_bf16 v[64:79], a[24:27], v[8:11], v[64:79]
    v_mfma_f32_32x32x16_bf16 v[80:95], a[28:31], v[8:11], v[80:95]
    buffer_load_dwordx4 v[60:63], v23, s[24:27], s59 offen offset:1024 sc1
    s_waitcnt vmcnt(8)
    v_mfma_f32_32x32x16_bf16 v[96:111], a[24:27], v[12:15], v[96:111]
    v_mfma_f32_32x32x16_bf16 v[112:127], a[28:31], v[12:15], v[112:127]
    buffer_load_dwordx4 v[8:11], v23, s[24:27], s60 offen offset:0 sc1
    s_waitcnt vmcnt(8)
    v_mfma_f32_32x32x16_bf16 v[64:79], a[32:35], v[32:35], v[64:79]
    v_mfma_f32_32x32x16_bf16 v[80:95], a[36:39], v[32:35], v[80:95]
    ds_read_b32 v30, v26 offset:0
    buffer_load_dwordx4 v[12:15], v23, s[24:27], s60 offen offset:1024 sc1
    s_waitcnt vmcnt(8)
    v_mfma_f32_32x32x16_bf16 v[96:111], a[32:35], v[36:39], v[96:111]
    v_mfma_f32_32x32x16_bf16 v[112:127], a[36:39], v[36:39], v[112:127]
    ds_read_b32 v31, v26 offset:16
    buffer_load_dwordx4 v[32:35], v23, s[24:27], s61 offen offset:0 sc1
    s_waitcnt vmcnt(8)
    v_mfma_f32_32x32x16_bf16 v[64:79], a[40:43], v[40:43], v[64:79]
    v_mfma_f32_32x32x16_bf16 v[80:95], a[44:47], v[40:43], v[80:95]
    buffer_load_dwordx4 v[36:39], v23, s[24:27], s61 offen offset:1024 sc1
    s_waitcnt vmcnt(8)
    v_mfma_f32_32x32x16_bf16 v[96:111], a[40:43], v[44:47], v[96:111]
    s_xor_b32 s90, s42, 0
    s_lshl_b32 s90, s90, 14
    s_add_u32 s90, s90, 0
    v_add_u32 v2, s90, v1
    s_xor_b32 s90, s42, 1
    s_lshl_b32 s90, s90, 14
    s_add_u32 s90, s90, 4096
    v_add_u32_e64 v3, s90, v1
    s_xor_b32 s90, s42, 2
    s_lshl_b32 s90, s90, 14
    s_add_u32 s90, s90, 8192
    v_add_u32 v24, s90, v1
    s_xor_b32 s90, s42, 3
    s_lshl_b32 s90, s90, 14
    s_add_u32 s90, s90, 12288
    v_add_u32_e64 v25, s90, v1
    v_mfma_f32_32x32x16_bf16 v[112:127], a[44:47], v[44:47], v[112:127]
    buffer_load_dwordx4 v[40:43], v22, s[24:27], s60 offen offset:0 sc1
    s_waitcnt vmcnt(8)
    v_mfma_f32_32x32x16_bf16 v[64:79], a[48:51], v[48:51], v[64:79]
    v_mfma_f32_32x32x16_bf16 v[80:95], a[52:55], v[48:51], v[80:95]
    buffer_load_dwordx4 v[44:47], v22, s[24:27], s60 offen offset:1024 sc1
    s_waitcnt vmcnt(8)
    v_mfma_f32_32x32x16_bf16 v[96:111], a[48:51], v[52:55], v[96:111]
    v_mfma_f32_32x32x16_bf16 v[112:127], a[52:55], v[52:55], v[112:127]
    buffer_load_dwordx4 v[48:51], v22, s[24:27], s61 offen offset:0 sc1
    s_waitcnt vmcnt(8)
    v_mfma_f32_32x32x16_bf16 v[64:79], a[56:59], v[56:59], v[64:79]
    v_mfma_f32_32x32x16_bf16 v[80:95], a[60:63], v[56:59], v[80:95]
    buffer_load_dwordx4 v[52:55], v22, s[24:27], s61 offen offset:1024 sc1
    s_waitcnt vmcnt(8)
    v_mfma_f32_32x32x16_bf16 v[96:111], a[56:59], v[60:63], v[96:111]
    v_mfma_f32_32x32x16_bf16 v[112:127], a[60:63], v[60:63], v[112:127]
    s_waitcnt lgkmcnt(1)
    v_cmp_gt_u32 vcc, 5, v30
    s_nop 1
    s_cbranch_vccnz L_lslow47
L_lret48:
    s_waitcnt lgkmcnt(0)
    v_cmp_gt_u32 vcc, 5, v31
    s_nop 1
    s_cbranch_vccnz L_lslow49
L_lret50:
    s_waitcnt vmcnt(7)
    v_mfma_f32_32x32x16_bf16 v[96:111], a[64:67], v[8:11], v[96:111]
    v_mfma_f32_32x32x16_bf16 v[112:127], a[68:71], v[8:11], v[112:127]
    s_waitcnt vmcnt(6)
    v_mfma_f32_32x32x16_bf16 v[96:111], a[72:75], v[12:15], v[96:111]
    v_mfma_f32_32x32x16_bf16 v[112:127], a[76:79], v[12:15], v[112:127]
    s_waitcnt vmcnt(5)
    v_mfma_f32_32x32x16_bf16 v[96:111], a[80:83], v[32:35], v[96:111]
    v_mfma_f32_32x32x16_bf16 v[112:127], a[84:87], v[32:35], v[112:127]
    s_waitcnt vmcnt(4)
    v_mfma_f32_32x32x16_bf16 v[96:111], a[88:91], v[36:39], v[96:111]
    v_mfma_f32_32x32x16_bf16 v[112:127], a[92:95], v[36:39], v[112:127]
    s_waitcnt vmcnt(3)
    v_mfma_f32_32x32x16_bf16 v[80:95], a[68:71], v[40:43], v[80:95]
    s_waitcnt vmcnt(2)
    v_mfma_f32_32x32x16_bf16 v[80:95], a[76:79], v[44:47], v[80:95]
    s_waitcnt vmcnt(1)
    v_mfma_f32_32x32x16_bf16 v[80:95], a[84:87], v[48:51], v[80:95]
    s_nop 4
    ds_write_b128 v24, v[96:99] offset:0
    ds_write_b128 v24, v[100:103] offset:1024
    s_waitcnt vmcnt(0)
    v_mfma_f32_32x32x16_bf16 v[80:95], a[92:95], v[52:55], v[80:95]
    ds_write_b128 v24, v[104:107] offset:2048
    v_mfma_f32_32x32x16_bf16 v[64:79], a[64:67], v[40:43], v[64:79]
    ds_write_b128 v24, v[108:111] offset:3072
    v_mfma_f32_32x32x16_bf16 v[64:79], a[72:75], v[44:47], v[64:79]
    ds_write_b128 v25, v[112:115] offset:0
    v_mfma_f32_32x32x16_bf16 v[64:79], a[80:83], v[48:51], v[64:79]
    ds_write_b128 v25, v[116:119] offset:1024
    ds_write_b128 v25, v[120:123] offset:2048
    v_mfma_f32_32x32x16_bf16 v[64:79], a[88:91], v[52:55], v[64:79]
    ds_write_b128 v25, v[124:127] offset:3072
    s_nop 1
    ds_write_b128 v3, v[80:83] offset:0
    ds_write_b128 v3, v[84:87] offset:1024
    ds_write_b128 v3, v[88:91] offset:2048
    ds_write_b128 v3, v[92:95] offset:3072
    s_nop 4
    ds_write_b128 v2, v[64:67] offset:0
    ds_write_b128 v2, v[68:71] offset:1024
    ds_write_b128 v2, v[72:75] offset:2048
    ds_write_b128 v2, v[76:79] offset:3072
    v_mov_b32 v28, 6
    ds_write_b32 v27, v28
    s_endpgm
L_slow_eg39:
s_mov_b32 s67, 0
L_slow_eg39_loop:
s_sleep 4
buffer_load_dwordx4 v[96:99], v121, s[24:27], s100 offen offset:0 sc1
buffer_load_dwordx4 v[100:103], v121, s[24:27], s100 offen offset:2048 sc1
buffer_load_dwordx4 v[104:107], v122, s[24:27], s100 offen offset:0 sc1
buffer_load_dwordx4 v[108:111], v122, s[24:27], s100 offen offset:2048 sc1
s_waitcnt vmcnt(0)
s_add_u32 s67, s67, 1
s_cmp_ge_u32 s67, 0x8000
s_cbranch_scc1 L_ret_eg40
v_cmp_ne_u64 vcc, s[40:41], v[98:99]
s_nop 1
s_cbranch_vccnz L_slow_eg39_loop
v_cmp_ne_u64 vcc, s[40:41], v[102:103]
s_nop 1
s_cbranch_vccnz L_slow_eg39_loop
v_cmp_ne_u64 vcc, s[40:41], v[106:107]
s_nop 1
s_cbranch_vccnz L_slow_eg39_loop
v_cmp_ne_u64 vcc, s[40:41], v[110:111]
s_nop 1
s_cbranch_vccnz L_slow_eg39_loop
s_branch L_ret_eg40
L_slow_h41:
s_mov_b32 s67, 0
L_slow_h41_loop:
s_sleep 2
s_buffer_load_dwordx2 s[68:69], s[24:27], s76 offset:128 glc
s_buffer_load_dwordx2 s[70:71], s[24:27], s76 offset:384 glc
s_buffer_load_dwordx2 s[72:73], s[24:27], s76 offset:2176 glc
s_buffer_load_dwordx2 s[74:75], s[24:27], s76 offset:2432 glc
s_waitcnt lgkmcnt(0)
s_add_u32 s67, s67, 1
s_cmp_ge_u32 s67, 0x8000
s_cbranch_scc1 L_ret_h42
s_xor_b64 s[68:69], s[68:69], s[40:41]
s_xor_b64 s[70:71], s[70:71], s[40:41]
s_xor_b64 s[72:73], s[72:73], s[40:41]
s_xor_b64 s[74:75], s[74:75], s[40:41]
s_or_b64 s[68:69], s[68:69], s[70:71]
s_or_b64 s[68:69], s[68:69], s[72:73]
s_or_b64 s[68:69], s[68:69], s[74:75]
s_cbranch_scc1 L_slow_h41_loop
s_branch L_ret_h42
L_slow_h243:
s_mov_b32 s67, 0
L_slow_h243_loop:
s_sleep 2
s_buffer_load_dwordx2 s[68:69], s[24:27], s76 offset:0 glc
s_buffer_load_dwordx2 s[70:71], s[24:27], s76 offset:256 glc
s_buffer_load_dwordx2 s[72:73], s[24:27], s76 offset:2048 glc
s_buffer_load_dwordx2 s[74:75], s[24:27], s76 offset:2304 glc
s_waitcnt lgkmcnt(0)
s_add_u32 s67, s67, 1
s_cmp_ge_u32 s67, 0x8000
s_cbranch_scc1 L_ret_h244
s_xor_b64 s[68:69], s[68:69], s[40:41]
s_xor_b64 s[70:71], s[70:71], s[40:41]
s_xor_b64 s[72:73], s[72:73], s[40:41]
s_xor_b64 s[74:75], s[74:75], s[40:41]
s_or_b64 s[68:69], s[68:69], s[70:71]
s_or_b64 s[68:69], s[68:69], s[72:73]
s_or_b64 s[68:69], s[68:69], s[74:75]
s_cbranch_scc1 L_slow_h243_loop
s_branch L_ret_h244
L_lslow45:
s_mov_b32 s67, 0
L_lslow45_loop:
ds_read_b32 v30, v26 offset:16
s_add_u32 s67, s67, 1
s_cmp_ge_u32 s67, 0x100000
s_cbranch_scc1 L_lret46
s_waitcnt lgkmcnt(0)
v_cmp_gt_u32 vcc, 2, v30
s_nop 1
s_cbranch_vccnz L_lslow45_loop
s_branch L_lret46
L_lslow47:
s_mov_b32 s67, 0
L_lslow47_loop:
ds_read_b32 v30, v26 offset:0
s_add_u32 s67, s67, 1
s_cmp_ge_u32 s67, 0x100000
s_cbranch_scc1 L_lret48
s_waitcnt lgkmcnt(0)
v_cmp_gt_u32 vcc, 5, v30
s_nop 1
s_cbranch_vccnz L_lslow47_loop
s_branch L_lret48
L_lslow49:
s_mov_b32 s67, 0
L_lslow49_loop:
ds_read_b32 v31, v26 offset:16
s_add_u32 s67, s67, 1
s_cmp_ge_u32 s67, 0x100000
s_cbranch_scc1 L_lret50
s_waitcnt lgkmcnt(0)
v_cmp_gt_u32 vcc, 5, v31
s_nop 1
s_cbranch_vccnz L_lslow49_loop
s_branch L_lret50
.p2align 6
L_AQ:
    s_and_b32 s90, s2, 7
    s_lshr_b32 s91, s2, 3
    s_lshr_b32 s70, s90, 2
    s_and_b32 s71, s91, 7
    s_lshl_b32 s43, s70, 3
    s_add_u32 s43, s43, s71
    s_and_b32 s72, s2, 3
    s_lshl_b32 s72, s72, 1
    s_lshr_b32 s92, s2, 7
    s_add_u32 s3, s72, s92
    v_lshrrev_b32 v28, 5, v0
    v_and_b32 v29, 3, v0
    s_lshl_b32 s44, s3, 1
    s_add_u32 s44, s44, 1
    s_and_b32 s45, s2, 7
    s_lshl_b32 s45, s45, 2
    s_bfe_u32 s92, s2, 0x10003
    s_add_u32 s45, s45, s92
    s_add_u32 s45, s45, 2
    s_bfe_u32 s46, s2, 0x20004
    s_lshr_b32 s92, s2, 7
    s_lshl_b32 s92, s92, 2
    s_add_u32 s46, s46, s92
    v_lshlrev_b32 v1, 4, v0
    v_and_b32 v29, 3, v0
    v_bfe_u32 v30, v0, 2, 2
    v_lshlrev_b32 v30, 6, v30
    v_bfe_u32 v31, v0, 4, 1
    v_lshl_or_b32 v30, v31, 5, v30
    v_lshl_or_b32 v30, v29, 3, v30
    s_lshl_b32 s92, s43, 7
    s_lshl_b32 s74, s44, 3
    s_add_u32 s92, s92, s74
    s_lshl_b32 s74, s42, 1
    s_add_u32 s74, s92, s74
    v_add_u32 v70, s74, v28
    v_and_b32 v71, 31, v0
    v_lshlrev_b32 v71, 4, v71
    v_lshl_or_b32 v72, v70, 10, v71
    s_mov_b32 s6, 2097152
    s_mov_b32 s7, 0x20000
    s_waitcnt lgkmcnt(0)
    s_mov_b32 s4, s48
    s_mov_b32 s5, s49
    buffer_load_dwordx4 v[64:67], v72, s[4:7], 0 offen
    s_load_dwordx2 s[40:41], s[66:67], 0
    buffer_load_dwordx4 v[76:79], v72, s[4:7], 0 offen offset:512
    s_lshr_b32 s90, s2, 3
    s_lshl_b32 s90, s90, 2
    s_add_u32 s90, s90, s42
    s_mul_i32 s90, s90, 18
    v_min_u32 v12, 17, v0
    v_add_u32 v12, s90, v12
    v_lshlrev_b32 v12, 10, v12
    v_subrev_u32 v13, 1835008, v12
    s_mov_b32 s16, s60
    s_mov_b32 s17, s61
    s_mov_b32 s18, 1835008
    s_mov_b32 s19, 0x20000
    s_mov_b32 s20, s52
    s_mov_b32 s21, s53
    s_mov_b32 s22, 524288
    s_mov_b32 s23, 0x20000
    s_sub_u32 s74, 0x180, s60
    s_and_b32 s74, s74, 0x380
    s_sub_u32 s75, 0x180, s52
    s_and_b32 s75, s75, 0x380
    s_mov_b32 s28, s64
    s_mov_b32 s29, s65
    s_mov_b32 s30, 2097152
    s_mov_b32 s31, 0x20000
    s_mov_b32 s24, s66
    s_mov_b32 s25, s67
    s_mov_b32 s26, 16777216
    s_mov_b32 s27, 0x20000
    v_lshl_or_b32 v2, v28, 10, v30
    v_add_u32 v3, 0x10000, v2
    v_add_u32 v4, 0x20000, v2
    s_lshl_b32 s63, s43, 2
    s_add_u32 s63, s63, s42
    s_lshl_b32 s62, s42, 12
    v_xor_b32 v31, v28, v29
    v_bfe_u32 v30, v0, 4, 1
    v_lshlrev_b32 v30, 2, v30
    v_xor_b32 v31, v31, v30
    v_lshlrev_b32_e64 v31, 4, v31
    v_lshl_or_b32 v31, v29, 10, v31
    v_bfe_u32 v30, v0, 2, 3
    v_lshl_or_b32 v31, v30, 7, v31
    v_add_u32 v5, s62, v31
    v_xor_b32 v6, 32, v5
    v_xor_b32_e64 v7, 64, v5
    v_xor_b32 v8, 96, v5
    v_add_u32 v9, 147456, v71
    v_mov_b32 v31, v71
    s_lshl_b32 s101, s63, 9
    s_add_u32 s101, s101, 4096
    v_and_b32 v26, 3, v0
    v_lshlrev_b32 v26, 2, v26
    v_add_u32 v26, 152576, v26
    s_lshl_b32 s92, s42, 2
    s_add_u32 s92, s92, 152592
    v_mov_b32 v27, s92
    v_mov_b32_e64 v28, 0
    ds_write_b32 v27, v28
    s_mov_b32 s94, 0xffff0000
    s_mov_b32 s95, 0xffff0000
    s_mov_b32 s96, 0
    s_mov_b32 s97, -1
    s_waitcnt lgkmcnt(0)
    s_mul_i32 s40, s40, 1664525
    s_add_u32 s40, s40, 1013904223
    s_mul_i32 s41, s41, 22695477
    s_add_u32 s41, s41, 1
    s_waitcnt vmcnt(1)
    v_lshlrev_b32 v80, 16, v64
    v_and_b32 v81, 0xffff0000, v64
    v_lshlrev_b32 v82, 16, v65
    v_and_b32 v83, 0xffff0000, v65
    v_lshlrev_b32 v84, 16, v66
    v_and_b32 v85, 0xffff0000, v66
    v_lshlrev_b32 v86, 16, v67
    v_and_b32 v87, 0xffff0000, v67
    s_waitcnt vmcnt(0)
    v_lshlrev_b32_e64 v88, 16, v76
    v_and_b32 v89, 0xffff0000, v76
    v_lshlrev_b32 v90, 16, v77
    v_and_b32 v91, 0xffff0000, v77
    v_lshlrev_b32 v92, 16, v78
    v_and_b32 v93, 0xffff0000, v78
    v_lshlrev_b32 v94, 16, v79
    v_and_b32 v95, 0xffff0000, v79
    v_add_f32 v96, v80, v81
    v_add_f32 v97, v82, v83
    v_add_f32 v96, v96, v84
    v_add_f32 v96, v96, v85
    v_add_f32 v97, v97, v86
    v_add_f32 v97, v97, v87
    v_add_f32 v96, v96, v88
    v_add_f32 v96, v96, v89
    v_add_f32 v97, v97, v90
    v_add_f32 v97, v97, v91
    v_add_f32 v96, v96, v92
    v_add_f32 v96, v96, v93
    v_add_f32 v97, v97, v94
    v_add_f32 v97, v97, v95
    v_add_f32 v96, v96, v97
    s_nop 1
    v_add_f32_dpp v96, v96, v96 quad_perm:[1,0,3,2] row_mask:0xf bank_mask:0xf
    s_nop 1
    v_add_f32_dpp v96, v96, v96 quad_perm:[2,3,0,1] row_mask:0xf bank_mask:0xf
    s_nop 1
    v_add_f32_dpp v96, v96, v96 row_half_mirror row_mask:0xf bank_mask:0xf
    s_nop 1
    v_add_f32_dpp v96, v96, v96 row_mirror row_mask:0xf bank_mask:0xf
    v_mov_b32 v97, v96
    s_nop 1
    v_permlane16_swap_b32 v96, v97
    v_add_f32 v96, v96, v97
    v_mul_f32 v100, 0x3b000000, v96
    v_sub_f32 v80, v80, v100
    v_sub_f32 v81, v81, v100
    v_sub_f32 v82, v82, v100
    v_sub_f32 v83, v83, v100
    v_sub_f32 v84, v84, v100
    v_sub_f32 v85, v85, v100
    v_sub_f32 v86, v86, v100
    v_sub_f32 v87, v87, v100
    v_sub_f32 v88, v88, v100
    v_sub_f32 v89, v89, v100
    v_sub_f32 v90, v90, v100
    v_sub_f32 v91, v91, v100
    v_sub_f32 v92, v92, v100
    v_sub_f32 v93, v93, v100
    v_sub_f32 v94, v94, v100
    v_sub_f32 v95, v95, v100
    v_mul_f32 v96, v80, v80
    v_mul_f32 v97, v81, v81
    v_fmac_f32 v96, v82, v82
    v_fmac_f32 v97, v83, v83
    v_fmac_f32 v96, v84, v84
    v_fmac_f32 v97, v85, v85
    v_fmac_f32 v96, v86, v86
    v_fmac_f32 v97, v87, v87
    v_fmac_f32 v96, v88, v88
    v_fmac_f32 v97, v89, v89
    v_fmac_f32 v96, v90, v90
    v_fmac_f32 v97, v91, v91
    v_fmac_f32 v96, v92, v92
    v_fmac_f32 v97, v93, v93
    v_fmac_f32 v96, v94, v94
    v_fmac_f32 v97, v95, v95
    v_add_f32 v96, v96, v97
    s_nop 1
    v_add_f32_dpp v96, v96, v96 quad_perm:[1,0,3,2] row_mask:0xf bank_mask:0xf
    s_nop 1
    v_add_f32_dpp v96, v96, v96 quad_perm:[2,3,0,1] row_mask:0xf bank_mask:0xf
    s_nop 1
    v_add_f32_dpp v96, v96, v96 row_half_mirror row_mask:0xf bank_mask:0xf
    s_nop 1
    v_add_f32_dpp v96, v96, v96 row_mirror row_mask:0xf bank_mask:0xf
    v_mov_b32 v97, v96
    s_nop 1
    v_permlane16_swap_b32 v96, v97
    v_add_f32_e64 v96, v96, v97
    v_mov_b32 v97, 0x3727c5ac
    v_fmac_f32 v97, 0x3b000000, v96
    v_sqrt_f32 v101, v97
    v_mov_b32 v102, s40
    v_mov_b32 v103, s41
    v_lshlrev_b32 v70, 4, v70
    v_add_u32 v70, 4096, v70
    v_mov_b32 v14, v100
    v_mov_b32 v15, v101
    v_mov_b32 v16, v102
    v_mov_b32 v17, v103
    v_mov_b32_e64 v18, v70
    s_setprio 1
    s_barrier
    ds_read_b128 a[0:3], v5 offset:0
    ds_read_b64_tr_b16 v[32:33], v2 offset:16384
    ds_read_b64_tr_b16 v[34:35], v2 offset:16640
    ds_read_b64_tr_b16 v[36:37], v2 offset:16896
    ds_read_b64_tr_b16 v[38:39], v2 offset:17152
    ds_read_b64_tr_b16 v[40:41], v2 offset:24576
    ds_read_b64_tr_b16 v[42:43], v2 offset:24832
    ds_read_b64_tr_b16 v[44:45], v2 offset:25088
    ds_read_b64_tr_b16 v[46:47], v2 offset:25344
    ds_read_b128 a[4:7], v6 offset:0
    ds_read_b128 a[8:11], v7 offset:0
    ds_read_b128 a[12:15], v8 offset:0
    s_mov_b32 exec_lo, 1
    s_mov_b32 exec_hi, 1
    buffer_store_dwordx4 v[14:17], v18, s[24:27], 0 offen sc1
    s_mov_b64 exec, -1
    s_waitcnt lgkmcnt(7)
    v_mfma_f32_32x32x16_bf16 v[64:79], v[32:35], a[0:3], 0
    ds_read_b64_tr_b16 v[48:49], v2 offset:18432
    ds_read_b64_tr_b16 v[50:51], v2 offset:18688
    v_mfma_f32_32x32x16_bf16 v[80:95], v[36:39], a[0:3], 0
    ds_read_b64_tr_b16 v[52:53], v2 offset:18944
    ds_read_b64_tr_b16 v[54:55], v2 offset:19200
    s_waitcnt lgkmcnt(7)
    v_mfma_f32_32x32x16_bf16 v[96:111], v[40:43], a[0:3], 0
    ds_read_b64_tr_b16 v[56:57], v2 offset:26624
    ds_read_b64_tr_b16 v[58:59], v2 offset:26880
    v_mfma_f32_32x32x16_bf16 v[112:127], v[44:47], a[0:3], 0
    ds_read_b64_tr_b16 v[60:61], v2 offset:27136
    ds_read_b64_tr_b16 v[62:63], v2 offset:27392
    s_waitcnt lgkmcnt(4)
    v_mfma_f32_32x32x16_bf16 v[64:79], v[48:51], a[4:7], v[64:79]
    ds_read_b64_tr_b16 v[32:33], v2 offset:20480
    ds_read_b64_tr_b16 v[34:35], v2 offset:20736
    v_mfma_f32_32x32x16_bf16 v[80:95], v[52:55], a[4:7], v[80:95]
    ds_read_b64_tr_b16 v[36:37], v2 offset:20992
    ds_read_b64_tr_b16 v[38:39], v2 offset:21248
    s_waitcnt lgkmcnt(4)
    v_mfma_f32_32x32x16_bf16 v[96:111], v[56:59], a[4:7], v[96:111]
    ds_read_b64_tr_b16 v[40:41], v2 offset:28672
    ds_read_b64_tr_b16 v[42:43], v2 offset:28928
    v_mfma_f32_32x32x16_bf16 v[112:127], v[60:63], a[4:7], v[112:127]
    ds_read_b64_tr_b16 v[44:45], v2 offset:29184
    ds_read_b64_tr_b16 v[46:47], v2 offset:29440
    s_waitcnt lgkmcnt(4)
    v_mfma_f32_32x32x16_bf16 v[64:79], v[32:35], a[8:11], v[64:79]
    ds_read_b64_tr_b16 v[48:49], v2 offset:22528
    ds_read_b64_tr_b16 v[50:51], v2 offset:22784
    v_mfma_f32_32x32x16_bf16 v[80:95], v[36:39], a[8:11], v[80:95]
    ds_read_b64_tr_b16 v[52:53], v2 offset:23040
    ds_read_b64_tr_b16 v[54:55], v2 offset:23296
    s_waitcnt lgkmcnt(4)
    v_mfma_f32_32x32x16_bf16 v[96:111], v[40:43], a[8:11], v[96:111]
    ds_read_b64_tr_b16 v[56:57], v2 offset:30720
    ds_read_b64_tr_b16 v[58:59], v2 offset:30976
    v_mfma_f32_32x32x16_bf16 v[112:127], v[44:47], a[8:11], v[112:127]
    ds_read_b64_tr_b16 v[60:61], v2 offset:31232
    ds_read_b64_tr_b16 v[62:63], v2 offset:31488
    s_waitcnt lgkmcnt(4)
    v_mfma_f32_32x32x16_bf16 v[64:79], v[48:51], a[12:15], v[64:79]
    v_mfma_f32_32x32x16_bf16 v[80:95], v[52:55], a[12:15], v[80:95]
    s_waitcnt lgkmcnt(0)
    s_barrier
    ds_read_b128 a[16:19], v5 offset:32768
    ds_read_b64_tr_b16 v[32:33], v2 offset:49152
    ds_read_b64_tr_b16 v[34:35], v2 offset:49408
    ds_read_b64_tr_b16 v[36:37], v2 offset:49664
    ds_read_b64_tr_b16 v[38:39], v2 offset:49920
    v_mfma_f32_32x32x16_bf16 v[96:111], v[56:59], a[12:15], v[96:111]
    ds_read_b64_tr_b16 v[40:41], v2 offset:57344
    ds_read_b64_tr_b16 v[42:43], v2 offset:57600
    ds_read_b64_tr_b16 v[44:45], v2 offset:57856
    ds_read_b64_tr_b16 v[46:47], v2 offset:58112
    v_mfma_f32_32x32x16_bf16 v[112:127], v[60:63], a[12:15], v[112:127]
    ds_read_b128 a[20:23], v6 offset:32768
    ds_read_b128 a[24:27], v7 offset:32768
    ds_read_b128 a[28:31], v8 offset:32768
    buffer_load_dword v24, v12, s[16:19], s74 offen
    buffer_load_dword v25, v13, s[20:23], s75 offen
    s_waitcnt lgkmcnt(7)
    v_mfma_f32_32x32x16_bf16 v[64:79], v[32:35], a[16:19], v[64:79]
    ds_read_b64_tr_b16 v[48:49], v2 offset:51200
    ds_read_b64_tr_b16 v[50:51], v2 offset:51456
    v_mfma_f32_32x32x16_bf16 v[80:95], v[36:39], a[16:19], v[80:95]
    ds_read_b64_tr_b16 v[52:53], v2 offset:51712
    ds_read_b64_tr_b16 v[54:55], v2 offset:51968
    s_waitcnt lgkmcnt(7)
    v_mfma_f32_32x32x16_bf16 v[96:111], v[40:43], a[16:19], v[96:111]
    ds_read_b64_tr_b16 v[56:57], v2 offset:59392
    ds_read_b64_tr_b16 v[58:59], v2 offset:59648
    v_mfma_f32_32x32x16_bf16 v[112:127], v[44:47], a[16:19], v[112:127]
    ds_read_b64_tr_b16 v[60:61], v2 offset:59904
    ds_read_b64_tr_b16 v[62:63], v2 offset:60160
    s_waitcnt lgkmcnt(4)
    v_mfma_f32_32x32x16_bf16 v[64:79], v[48:51], a[20:23], v[64:79]
    ds_read_b64_tr_b16 v[32:33], v2 offset:53248
    ds_read_b64_tr_b16 v[34:35], v2 offset:53504
    v_mfma_f32_32x32x16_bf16 v[80:95], v[52:55], a[20:23], v[80:95]
    ds_read_b64_tr_b16 v[36:37], v2 offset:53760
    ds_read_b64_tr_b16 v[38:39], v2 offset:54016
    s_waitcnt lgkmcnt(4)
    v_mfma_f32_32x32x16_bf16 v[96:111], v[56:59], a[20:23], v[96:111]
    ds_read_b64_tr_b16 v[40:41], v2 offset:61440
    ds_read_b64_tr_b16 v[42:43], v2 offset:61696
    v_mfma_f32_32x32x16_bf16 v[112:127], v[60:63], a[20:23], v[112:127]
    ds_read_b64_tr_b16 v[44:45], v2 offset:61952
    ds_read_b64_tr_b16 v[46:47], v2 offset:62208
    s_waitcnt lgkmcnt(4)
    v_mfma_f32_32x32x16_bf16 v[64:79], v[32:35], a[24:27], v[64:79]
    ds_read_b64_tr_b16 v[48:49], v2 offset:55296
    ds_read_b64_tr_b16 v[50:51], v2 offset:55552
    v_mfma_f32_32x32x16_bf16 v[80:95], v[36:39], a[24:27], v[80:95]
    ds_read_b64_tr_b16 v[52:53], v2 offset:55808
    ds_read_b64_tr_b16 v[54:55], v2 offset:56064
    s_waitcnt lgkmcnt(4)
    v_mfma_f32_32x32x16_bf16 v[96:111], v[40:43], a[24:27], v[96:111]
    ds_read_b64_tr_b16 v[56:57], v2 offset:63488
    ds_read_b64_tr_b16 v[58:59], v2 offset:63744
    v_mfma_f32_32x32x16_bf16 v[112:127], v[44:47], a[24:27], v[112:127]
    ds_read_b64_tr_b16 v[60:61], v2 offset:64000
    ds_read_b64_tr_b16 v[62:63], v2 offset:64256
    s_waitcnt lgkmcnt(4)
    v_mfma_f32_32x32x16_bf16 v[64:79], v[48:51], a[28:31], v[64:79]
    v_mfma_f32_32x32x16_bf16 v[80:95], v[52:55], a[28:31], v[80:95]
    s_waitcnt lgkmcnt(0)
    s_barrier
    v_add_u32 v30, 0x10000, v5
    ds_read_b128 a[32:35], v30
    ds_read_b64_tr_b16 v[32:33], v3 offset:16384
    ds_read_b64_tr_b16 v[34:35], v3 offset:16640
    ds_read_b64_tr_b16 v[36:37], v3 offset:16896
    ds_read_b64_tr_b16 v[38:39], v3 offset:17152
    v_mfma_f32_32x32x16_bf16 v[96:111], v[56:59], a[28:31], v[96:111]
    ds_read_b64_tr_b16 v[40:41], v3 offset:24576
    ds_read_b64_tr_b16 v[42:43], v3 offset:24832
    ds_read_b64_tr_b16 v[44:45], v3 offset:25088
    ds_read_b64_tr_b16 v[46:47], v3 offset:25344
    v_mfma_f32_32x32x16_bf16 v[112:127], v[60:63], a[28:31], v[112:127]
    v_add_u32 v30, 0x10000, v6
    ds_read_b128 a[36:39], v30
    v_add_u32 v30, 0x10000, v7
    ds_read_b128 a[40:43], v30
    v_add_u32 v30, 0x10000, v8
    ds_read_b128 a[44:47], v30
    s_waitcnt lgkmcnt(7)
    v_mfma_f32_32x32x16_bf16 v[64:79], v[32:35], a[32:35], v[64:79]
    ds_read_b64_tr_b16 v[48:49], v3 offset:18432
    ds_read_b64_tr_b16 v[50:51], v3 offset:18688
    v_mfma_f32_32x32x16_bf16 v[80:95], v[36:39], a[32:35], v[80:95]
    ds_read_b64_tr_b16 v[52:53], v3 offset:18944
    ds_read_b64_tr_b16 v[54:55], v3 offset:19200
    s_waitcnt lgkmcnt(7)
    v_mfma_f32_32x32x16_bf16 v[96:111], v[40:43], a[32:35], v[96:111]
    ds_read_b64_tr_b16 v[56:57], v3 offset:26624
    ds_read_b64_tr_b16 v[58:59], v3 offset:26880
    v_mfma_f32_32x32x16_bf16 v[112:127], v[44:47], a[32:35], v[112:127]
    ds_read_b64_tr_b16 v[60:61], v3 offset:27136
    ds_read_b64_tr_b16 v[62:63], v3 offset:27392
    s_waitcnt lgkmcnt(4)
    v_mfma_f32_32x32x16_bf16 v[64:79], v[48:51], a[36:39], v[64:79]
    ds_read_b64_tr_b16 v[32:33], v3 offset:20480
    ds_read_b64_tr_b16 v[34:35], v3 offset:20736
    v_mfma_f32_32x32x16_bf16 v[80:95], v[52:55], a[36:39], v[80:95]
    ds_read_b64_tr_b16 v[36:37], v3 offset:20992
    ds_read_b64_tr_b16 v[38:39], v3 offset:21248
    s_waitcnt lgkmcnt(4)
    v_mfma_f32_32x32x16_bf16 v[96:111], v[56:59], a[36:39], v[96:111]
    ds_read_b64_tr_b16 v[40:41], v3 offset:28672
    ds_read_b64_tr_b16 v[42:43], v3 offset:28928
    v_mfma_f32_32x32x16_bf16 v[112:127], v[60:63], a[36:39], v[112:127]
    ds_read_b64_tr_b16 v[44:45], v3 offset:29184
    ds_read_b64_tr_b16 v[46:47], v3 offset:29440
    s_waitcnt lgkmcnt(4)
    v_mfma_f32_32x32x16_bf16 v[64:79], v[32:35], a[40:43], v[64:79]
    ds_read_b64_tr_b16 v[48:49], v3 offset:22528
    ds_read_b64_tr_b16 v[50:51], v3 offset:22784
    v_mfma_f32_32x32x16_bf16 v[80:95], v[36:39], a[40:43], v[80:95]
    ds_read_b64_tr_b16 v[52:53], v3 offset:23040
    ds_read_b64_tr_b16 v[54:55], v3 offset:23296
    s_waitcnt lgkmcnt(4)
    v_mfma_f32_32x32x16_bf16 v[96:111], v[40:43], a[40:43], v[96:111]
    ds_read_b64_tr_b16 v[56:57], v3 offset:30720
    ds_read_b64_tr_b16 v[58:59], v3 offset:30976
    v_mfma_f32_32x32x16_bf16 v[112:127], v[44:47], a[40:43], v[112:127]
    ds_read_b64_tr_b16 v[60:61], v3 offset:31232
    ds_read_b64_tr_b16 v[62:63], v3 offset:31488
    s_waitcnt lgkmcnt(4)
    v_mfma_f32_32x32x16_bf16 v[64:79], v[48:51], a[44:47], v[64:79]
    v_mfma_f32_32x32x16_bf16 v[80:95], v[52:55], a[44:47], v[80:95]
    s_waitcnt lgkmcnt(0)
    s_barrier
    ds_read_b128 a[48:51], v5 offset:0
    ds_read_b64_tr_b16 v[32:33], v2 offset:16384
    ds_read_b64_tr_b16 v[34:35], v2 offset:16640
    ds_read_b64_tr_b16 v[36:37], v2 offset:16896
    ds_read_b64_tr_b16 v[38:39], v2 offset:17152
    v_mfma_f32_32x32x16_bf16 v[96:111], v[56:59], a[44:47], v[96:111]
    ds_read_b64_tr_b16 v[40:41], v2 offset:24576
    ds_read_b64_tr_b16 v[42:43], v2 offset:24832
    ds_read_b64_tr_b16 v[44:45], v2 offset:25088
    ds_read_b64_tr_b16 v[46:47], v2 offset:25344
    v_mfma_f32_32x32x16_bf16 v[112:127], v[60:63], a[44:47], v[112:127]
    ds_read_b128 a[52:55], v6 offset:0
    ds_read_b128 a[56:59], v7 offset:0
    ds_read_b128 a[60:63], v8 offset:0
    s_waitcnt lgkmcnt(7)
    v_mfma_f32_32x32x16_bf16 v[64:79], v[32:35], a[48:51], v[64:79]
    ds_read_b64_tr_b16 v[48:49], v2 offset:18432
    ds_read_b64_tr_b16 v[50:51], v2 offset:18688
    buffer_load_dwordx4 v[18:21], v31, s[24:27], s101 offen sc1
    v_mfma_f32_32x32x16_bf16 v[80:95], v[36:39], a[48:51], v[80:95]
    ds_read_b64_tr_b16 v[52:53], v2 offset:18944
    ds_read_b64_tr_b16 v[54:55], v2 offset:19200
    s_waitcnt lgkmcnt(7)
    v_mfma_f32_32x32x16_bf16 v[96:111], v[40:43], a[48:51], v[96:111]
    ds_read_b64_tr_b16 v[56:57], v2 offset:26624
    ds_read_b64_tr_b16 v[58:59], v2 offset:26880
    v_mfma_f32_32x32x16_bf16 v[112:127], v[44:47], a[48:51], v[112:127]
    ds_read_b64_tr_b16 v[60:61], v2 offset:27136
    ds_read_b64_tr_b16 v[62:63], v2 offset:27392
    s_waitcnt lgkmcnt(4)
    v_mfma_f32_32x32x16_bf16 v[64:79], v[48:51], a[52:55], v[64:79]
    ds_read_b64_tr_b16 v[32:33], v2 offset:20480
    ds_read_b64_tr_b16 v[34:35], v2 offset:20736
    v_mfma_f32_32x32x16_bf16 v[80:95], v[52:55], a[52:55], v[80:95]
    ds_read_b64_tr_b16 v[36:37], v2 offset:20992
    ds_read_b64_tr_b16 v[38:39], v2 offset:21248
    s_waitcnt lgkmcnt(4)
    v_mfma_f32_32x32x16_bf16 v[96:111], v[56:59], a[52:55], v[96:111]
    ds_read_b64_tr_b16 v[40:41], v2 offset:28672
    ds_read_b64_tr_b16 v[42:43], v2 offset:28928
    v_mfma_f32_32x32x16_bf16 v[112:127], v[60:63], a[52:55], v[112:127]
    ds_read_b64_tr_b16 v[44:45], v2 offset:29184
    ds_read_b64_tr_b16 v[46:47], v2 offset:29440
    s_waitcnt lgkmcnt(4)
    v_mfma_f32_32x32x16_bf16 v[64:79], v[32:35], a[56:59], v[64:79]
    ds_read_b64_tr_b16 v[48:49], v2 offset:22528
    ds_read_b64_tr_b16 v[50:51], v2 offset:22784
    v_mfma_f32_32x32x16_bf16 v[80:95], v[36:39], a[56:59], v[80:95]
    ds_read_b64_tr_b16 v[52:53], v2 offset:23040
    ds_read_b64_tr_b16 v[54:55], v2 offset:23296
    s_waitcnt lgkmcnt(4)
    v_mfma_f32_32x32x16_bf16 v[96:111], v[40:43], a[56:59], v[96:111]
    ds_read_b64_tr_b16 v[56:57], v2 offset:30720
    ds_read_b64_tr_b16 v[58:59], v2 offset:30976
    v_mfma_f32_32x32x16_bf16 v[112:127], v[44:47], a[56:59], v[112:127]
    ds_read_b64_tr_b16 v[60:61], v2 offset:31232
    ds_read_b64_tr_b16 v[62:63], v2 offset:31488
    s_waitcnt lgkmcnt(4)
    v_mfma_f32_32x32x16_bf16 v[64:79], v[48:51], a[60:63], v[64:79]
    v_mfma_f32_32x32x16_bf16 v[80:95], v[52:55], a[60:63], v[80:95]
    s_waitcnt lgkmcnt(0)
    s_barrier
    ds_read_b128 a[64:67], v5 offset:32768
    ds_read_b64_tr_b16 v[32:33], v2 offset:49152
    ds_read_b64_tr_b16 v[34:35], v2 offset:49408
    ds_read_b64_tr_b16 v[36:37], v2 offset:49664
    ds_read_b64_tr_b16 v[38:39], v2 offset:49920
    v_mfma_f32_32x32x16_bf16 v[96:111], v[56:59], a[60:63], v[96:111]
    ds_read_b64_tr_b16 v[40:41], v2 offset:57344
    ds_read_b64_tr_b16 v[42:43], v2 offset:57600
    ds_read_b64_tr_b16 v[44:45], v2 offset:57856
    ds_read_b64_tr_b16 v[46:47], v2 offset:58112
    v_mfma_f32_32x32x16_bf16 v[112:127], v[60:63], a[60:63], v[112:127]
    ds_read_b128 a[68:71], v6 offset:32768
    ds_read_b128 a[72:75], v7 offset:32768
    ds_read_b128 a[76:79], v8 offset:32768
    s_waitcnt lgkmcnt(7)
    v_mfma_f32_32x32x16_bf16 v[64:79], v[32:35], a[64:67], v[64:79]
    ds_read_b64_tr_b16 v[48:49], v2 offset:51200
    ds_read_b64_tr_b16 v[50:51], v2 offset:51456
    v_mfma_f32_32x32x16_bf16 v[80:95], v[36:39], a[64:67], v[80:95]
    ds_read_b64_tr_b16 v[52:53], v2 offset:51712
    ds_read_b64_tr_b16 v[54:55], v2 offset:51968
    s_waitcnt lgkmcnt(7)
    v_mfma_f32_32x32x16_bf16 v[96:111], v[40:43], a[64:67], v[96:111]
    ds_read_b64_tr_b16 v[56:57], v2 offset:59392
    ds_read_b64_tr_b16 v[58:59], v2 offset:59648
    v_mfma_f32_32x32x16_bf16 v[112:127], v[44:47], a[64:67], v[112:127]
    ds_read_b64_tr_b16 v[60:61], v2 offset:59904
    ds_read_b64_tr_b16 v[62:63], v2 offset:60160
    s_waitcnt lgkmcnt(4)
    v_mfma_f32_32x32x16_bf16 v[64:79], v[48:51], a[68:71], v[64:79]
    ds_read_b64_tr_b16 v[32:33], v2 offset:53248
    ds_read_b64_tr_b16 v[34:35], v2 offset:53504
    v_mfma_f32_32x32x16_bf16 v[80:95], v[52:55], a[68:71], v[80:95]
    ds_read_b64_tr_b16 v[36:37], v2 offset:53760
    ds_read_b64_tr_b16 v[38:39], v2 offset:54016
    s_waitcnt lgkmcnt(4)
    v_mfma_f32_32x32x16_bf16 v[96:111], v[56:59], a[68:71], v[96:111]
    ds_read_b64_tr_b16 v[40:41], v2 offset:61440
    ds_read_b64_tr_b16 v[42:43], v2 offset:61696
    v_mfma_f32_32x32x16_bf16 v[112:127], v[60:63], a[68:71], v[112:127]
    ds_read_b64_tr_b16 v[44:45], v2 offset:61952
    ds_read_b64_tr_b16 v[46:47], v2 offset:62208
    s_waitcnt lgkmcnt(4)
    v_mfma_f32_32x32x16_bf16 v[64:79], v[32:35], a[72:75], v[64:79]
    ds_read_b64_tr_b16 v[48:49], v2 offset:55296
    ds_read_b64_tr_b16 v[50:51], v2 offset:55552
    v_mfma_f32_32x32x16_bf16 v[80:95], v[36:39], a[72:75], v[80:95]
    ds_read_b64_tr_b16 v[52:53], v2 offset:55808
    ds_read_b64_tr_b16 v[54:55], v2 offset:56064
    s_waitcnt lgkmcnt(4)
    v_mfma_f32_32x32x16_bf16 v[96:111], v[40:43], a[72:75], v[96:111]
    ds_read_b64_tr_b16 v[56:57], v2 offset:63488
    ds_read_b64_tr_b16 v[58:59], v2 offset:63744
    v_mfma_f32_32x32x16_bf16 v[112:127], v[44:47], a[72:75], v[112:127]
    ds_read_b64_tr_b16 v[60:61], v2 offset:64000
    ds_read_b64_tr_b16 v[62:63], v2 offset:64256
    s_waitcnt lgkmcnt(4)
    v_mfma_f32_32x32x16_bf16 v[64:79], v[48:51], a[76:79], v[64:79]
    v_mfma_f32_32x32x16_bf16 v[80:95], v[52:55], a[76:79], v[80:95]
    s_waitcnt lgkmcnt(0)
    s_barrier
    v_add_u32 v30, 0x10000, v5
    ds_read_b128 a[80:83], v30
    ds_read_b64_tr_b16 v[32:33], v3 offset:16384
    ds_read_b64_tr_b16 v[34:35], v3 offset:16640
    ds_read_b64_tr_b16 v[36:37], v3 offset:16896
    ds_read_b64_tr_b16 v[38:39], v3 offset:17152
    v_mfma_f32_32x32x16_bf16 v[96:111], v[56:59], a[76:79], v[96:111]
    ds_read_b64_tr_b16 v[40:41], v3 offset:24576
    ds_read_b64_tr_b16 v[42:43], v3 offset:24832
    ds_read_b64_tr_b16 v[44:45], v3 offset:25088
    ds_read_b64_tr_b16 v[46:47], v3 offset:25344
    v_mfma_f32_32x32x16_bf16 v[112:127], v[60:63], a[76:79], v[112:127]
    v_add_u32 v30, 0x10000, v6
    ds_read_b128 a[84:87], v30
    v_add_u32 v30, 0x10000, v7
    ds_read_b128 a[88:91], v30
    v_add_u32 v30, 0x10000, v8
    ds_read_b128 a[92:95], v30
    s_waitcnt lgkmcnt(7)
    v_mfma_f32_32x32x16_bf16 v[64:79], v[32:35], a[80:83], v[64:79]
    ds_read_b64_tr_b16 v[48:49], v3 offset:18432
    ds_read_b64_tr_b16 v[50:51], v3 offset:18688
    v_mfma_f32_32x32x16_bf16 v[80:95], v[36:39], a[80:83], v[80:95]
    ds_read_b64_tr_b16 v[52:53], v3 offset:18944
    ds_read_b64_tr_b16 v[54:55], v3 offset:19200
    s_waitcnt vmcnt(0)
    v_xor_b32 v20, s40, v20
    v_xor_b32 v21, s41, v21
    v_or_b32_e64 v20, v20, v21
    v_cmp_ne_u32 vcc, 0, v20
    s_nop 1
    s_cbranch_vccnz L_slow_st51
L_ret_st52:
    s_waitcnt lgkmcnt(7)
    v_mfma_f32_32x32x16_bf16 v[96:111], v[40:43], a[80:83], v[96:111]
    ds_read_b64_tr_b16 v[56:57], v3 offset:26624
    ds_read_b64_tr_b16 v[58:59], v3 offset:26880
    v_rcp_f32_e64 v22, v19
    v_mfma_f32_32x32x16_bf16 v[112:127], v[44:47], a[80:83], v[112:127]
    ds_read_b64_tr_b16 v[60:61], v3 offset:27136
    ds_read_b64_tr_b16 v[62:63], v3 offset:27392
    v_mov_b32 v15, v19
    s_waitcnt lgkmcnt(4)
    v_mfma_f32_32x32x16_bf16 v[64:79], v[48:51], a[84:87], v[64:79]
    ds_read_b64_tr_b16 v[32:33], v3 offset:20480
    ds_read_b64_tr_b16 v[34:35], v3 offset:20736
    v_mov_b32 v13, 0
    v_sub_f32 v18, 0, v18
    v_mfma_f32_32x32x16_bf16 v[80:95], v[52:55], a[84:87], v[80:95]
    ds_read_b64_tr_b16 v[36:37], v3 offset:20992
    ds_read_b64_tr_b16 v[38:39], v3 offset:21248
    v_mul_f32 v14, 0xc0135761, v22
    v_mul_f32 v23, v22, v22
    s_waitcnt lgkmcnt(4)
    v_mfma_f32_32x32x16_bf16 v[96:111], v[56:59], a[84:87], v[96:111]
    ds_read_b64_tr_b16 v[40:41], v3 offset:28672
    ds_read_b64_tr_b16 v[42:43], v3 offset:28928
    v_mul_f32 v17, 0x3fb8aa3b, v22
    v_mul_f32_e64 v23, v23, v22
    v_mfma_f32_32x32x16_bf16 v[112:127], v[60:63], a[84:87], v[112:127]
    ds_read_b64_tr_b16 v[44:45], v3 offset:29184
    ds_read_b64_tr_b16 v[46:47], v3 offset:29440
    v_mul_f32 v16, 0xbdd2d3e8, v23
    v_cvt_pk_bf16_f32 v20, v19, v13
    s_waitcnt lgkmcnt(4)
    v_mfma_f32_32x32x16_bf16 v[64:79], v[32:35], a[88:91], v[64:79]
    ds_read_b64_tr_b16 v[48:49], v3 offset:22528
    ds_read_b64_tr_b16 v[50:51], v3 offset:22784
    v_cvt_pk_bf16_f32 v11, v18, v18
    v_lshlrev_b32 v20, 16, v20
    v_mfma_f32_32x32x16_bf16 v[80:95], v[36:39], a[88:91], v[80:95]
    ds_read_b64_tr_b16 v[52:53], v3 offset:23040
    ds_read_b64_tr_b16 v[54:55], v3 offset:23296
    v_lshlrev_b32 v21, 16, v11
    v_sub_f32_e64 v20, v19, v20
    s_waitcnt lgkmcnt(4)
    v_mfma_f32_32x32x16_bf16 v[96:111], v[40:43], a[88:91], v[96:111]
    ds_read_b64_tr_b16 v[56:57], v3 offset:30720
    ds_read_b64_tr_b16 v[58:59], v3 offset:30976
    v_sub_f32_e64 v21, v18, v21
    v_cvt_pk_bf16_f32 v10, v19, v20
    v_mfma_f32_32x32x16_bf16 v[112:127], v[44:47], a[88:91], v[112:127]
    ds_read_b64_tr_b16 v[60:61], v3 offset:31232
    ds_read_b64_tr_b16 v[62:63], v3 offset:31488
    v_cvt_pk_bf16_f32 v12, v21, v13
    v_cndmask_b32 v10, v10, v13, s[96:97]
    s_waitcnt lgkmcnt(4)
    v_mfma_f32_32x32x16_bf16 v[64:79], v[48:51], a[92:95], v[64:79]
    v_cndmask_b32 v11, v11, v13, s[96:97]
    v_cndmask_b32 v12, v12, v13, s[96:97]
    v_mfma_f32_32x32x16_bf16 v[80:95], v[52:55], a[92:95], v[80:95]
    s_waitcnt lgkmcnt(0)
    s_barrier
    ds_read_b128 a[96:99], v5 offset:0
    ds_read_b64_tr_b16 v[32:33], v2 offset:16384
    ds_read_b64_tr_b16 v[34:35], v2 offset:16640
    ds_read_b64_tr_b16 v[36:37], v2 offset:16896
    ds_read_b64_tr_b16 v[38:39], v2 offset:17152
    v_mfma_f32_32x32x16_bf16 v[96:111], v[56:59], a[92:95], v[96:111]
    ds_read_b64_tr_b16 v[40:41], v2 offset:24576
    ds_read_b64_tr_b16 v[42:43], v2 offset:24832
    ds_read_b64_tr_b16 v[44:45], v2 offset:25088
    ds_read_b64_tr_b16 v[46:47], v2 offset:25344
    v_mfma_f32_32x32x16_bf16 v[112:127], v[60:63], a[92:95], v[112:127]
    ds_read_b128 a[100:103], v6 offset:0
    ds_read_b128 a[104:107], v7 offset:0
    ds_read_b128 a[108:111], v8 offset:0
    s_waitcnt lgkmcnt(7)
    v_mfma_f32_32x32x16_bf16 v[64:79], v[32:35], a[96:99], v[64:79]
    ds_read_b64_tr_b16 v[48:49], v2 offset:18432
    ds_read_b64_tr_b16 v[50:51], v2 offset:18688
    v_mfma_f32_32x32x16_bf16 v[80:95], v[36:39], a[96:99], v[80:95]
    ds_read_b64_tr_b16 v[52:53], v2 offset:18944
    ds_read_b64_tr_b16 v[54:55], v2 offset:19200
    s_waitcnt lgkmcnt(7)
    v_mfma_f32_32x32x16_bf16 v[96:111], v[40:43], a[96:99], v[96:111]
    ds_read_b64_tr_b16 v[56:57], v2 offset:26624
    ds_read_b64_tr_b16 v[58:59], v2 offset:26880
    v_mfma_f32_32x32x16_bf16 v[112:127], v[44:47], a[96:99], v[112:127]
    ds_read_b64_tr_b16 v[60:61], v2 offset:27136
    ds_read_b64_tr_b16 v[62:63], v2 offset:27392
    s_waitcnt lgkmcnt(4)
    v_mfma_f32_32x32x16_bf16 v[64:79], v[48:51], a[100:103], v[64:79]
    ds_read_b64_tr_b16 v[32:33], v2 offset:20480
    ds_read_b64_tr_b16 v[34:35], v2 offset:20736
    v_mfma_f32_32x32x16_bf16 v[80:95], v[52:55], a[100:103], v[80:95]
    ds_read_b64_tr_b16 v[36:37], v2 offset:20992
    ds_read_b64_tr_b16 v[38:39], v2 offset:21248
    s_waitcnt lgkmcnt(4)
    v_mfma_f32_32x32x16_bf16 v[96:111], v[56:59], a[100:103], v[96:111]
    ds_read_b64_tr_b16 v[40:41], v2 offset:28672
    ds_read_b64_tr_b16 v[42:43], v2 offset:28928
    v_mfma_f32_32x32x16_bf16 v[112:127], v[60:63], a[100:103], v[112:127]
    ds_read_b64_tr_b16 v[44:45], v2 offset:29184
    ds_read_b64_tr_b16 v[46:47], v2 offset:29440
    s_waitcnt lgkmcnt(4)
    v_mfma_f32_32x32x16_bf16 v[64:79], v[32:35], a[104:107], v[64:79]
    ds_read_b64_tr_b16 v[48:49], v2 offset:22528
    ds_read_b64_tr_b16 v[50:51], v2 offset:22784
    v_mfma_f32_32x32x16_bf16 v[80:95], v[36:39], a[104:107], v[80:95]
    ds_read_b64_tr_b16 v[52:53], v2 offset:23040
    ds_read_b64_tr_b16 v[54:55], v2 offset:23296
    s_waitcnt lgkmcnt(4)
    v_mfma_f32_32x32x16_bf16 v[96:111], v[40:43], a[104:107], v[96:111]
    ds_read_b64_tr_b16 v[56:57], v2 offset:30720
    ds_read_b64_tr_b16 v[58:59], v2 offset:30976
    v_mfma_f32_32x32x16_bf16 v[112:127], v[44:47], a[104:107], v[112:127]
    ds_read_b64_tr_b16 v[60:61], v2 offset:31232
    ds_read_b64_tr_b16 v[62:63], v2 offset:31488
    s_waitcnt lgkmcnt(4)
    v_mfma_f32_32x32x16_bf16 v[64:79], v[48:51], a[108:111], v[64:79]
    v_mfma_f32_32x32x16_bf16 v[80:95], v[52:55], a[108:111], v[80:95]
    s_waitcnt lgkmcnt(0)
    s_barrier
    ds_read_b128 a[112:115], v5 offset:32768
    ds_read_b64_tr_b16 v[32:33], v2 offset:49152
    ds_read_b64_tr_b16 v[34:35], v2 offset:49408
    ds_read_b64_tr_b16 v[36:37], v2 offset:49664
    ds_read_b64_tr_b16 v[38:39], v2 offset:49920
    v_mfma_f32_32x32x16_bf16 v[96:111], v[56:59], a[108:111], v[96:111]
    ds_read_b64_tr_b16 v[40:41], v2 offset:57344
    ds_read_b64_tr_b16 v[42:43], v2 offset:57600
    ds_read_b64_tr_b16 v[44:45], v2 offset:57856
    ds_read_b64_tr_b16 v[46:47], v2 offset:58112
    v_mfma_f32_32x32x16_bf16 v[112:127], v[60:63], a[108:111], v[112:127]
    ds_read_b128 a[116:119], v6 offset:32768
    ds_read_b128 a[120:123], v7 offset:32768
    ds_read_b128 a[124:127], v8 offset:32768
    s_waitcnt lgkmcnt(7)
    v_mfma_f32_32x32x16_bf16 v[64:79], v[32:35], a[112:115], v[64:79]
    ds_read_b64_tr_b16 v[48:49], v2 offset:51200
    ds_read_b64_tr_b16 v[50:51], v2 offset:51456
    v_mfma_f32_32x32x16_bf16 v[80:95], v[36:39], a[112:115], v[80:95]
    ds_read_b64_tr_b16 v[52:53], v2 offset:51712
    ds_read_b64_tr_b16 v[54:55], v2 offset:51968
    s_waitcnt lgkmcnt(7)
    v_mfma_f32_32x32x16_bf16 v[96:111], v[40:43], a[112:115], v[96:111]
    ds_read_b64_tr_b16 v[56:57], v2 offset:59392
    ds_read_b64_tr_b16 v[58:59], v2 offset:59648
    v_mfma_f32_32x32x16_bf16 v[112:127], v[44:47], a[112:115], v[112:127]
    ds_read_b64_tr_b16 v[60:61], v2 offset:59904
    ds_read_b64_tr_b16 v[62:63], v2 offset:60160
    s_waitcnt lgkmcnt(4)
    v_mfma_f32_32x32x16_bf16 v[64:79], v[48:51], a[116:119], v[64:79]
    ds_read_b64_tr_b16 v[32:33], v2 offset:53248
    ds_read_b64_tr_b16 v[34:35], v2 offset:53504
    v_mfma_f32_32x32x16_bf16 v[80:95], v[52:55], a[116:119], v[80:95]
    ds_read_b64_tr_b16 v[36:37], v2 offset:53760
    ds_read_b64_tr_b16 v[38:39], v2 offset:54016
    v_mov_b32 v6, v15
    v_mov_b32 v7, v15
    v_mov_b32 v8, v17
    v_mov_b32 v15, v14
    v_mov_b32 v17, v16
    s_mov_b32 s70, 0x3f317218
    s_mov_b32 s71, 0x3f317218
    s_mov_b32 s72, 0x358637bd
    s_mov_b32 s73, 0x358637bd
    s_mov_b32 s76, 0xbfb8aa3b
    s_mov_b32 s77, 0xbfb8aa3b
    s_mov_b32 s78, 1.0
    s_mov_b32 s79, 1.0
    s_waitcnt lgkmcnt(4)
    v_mfma_f32_32x32x16_bf16 v[96:111], v[56:59], a[116:119], v[96:111]
    ds_read_b64_tr_b16 v[40:41], v2 offset:61440
    ds_read_b64_tr_b16 v[42:43], v2 offset:61696
    v_mfma_f32_32x32x16_bf16 v[112:127], v[60:63], a[116:119], v[112:127]
    ds_read_b64_tr_b16 v[44:45], v2 offset:61952
    ds_read_b64_tr_b16 v[46:47], v2 offset:62208
    s_waitcnt lgkmcnt(4)
    v_mfma_f32_32x32x16_bf16 v[64:79], v[32:35], a[120:123], v[64:79]
    ds_read_b64_tr_b16 v[48:49], v2 offset:55296
    ds_read_b64_tr_b16 v[50:51], v2 offset:55552
    v_mfma_f32_32x32x16_bf16 v[80:95], v[36:39], a[120:123], v[80:95]
    ds_read_b64_tr_b16 v[52:53], v2 offset:55808
    ds_read_b64_tr_b16 v[54:55], v2 offset:56064
    s_waitcnt lgkmcnt(4)
    v_mfma_f32_32x32x16_bf16 v[96:111], v[40:43], a[120:123], v[96:111]
    ds_read_b64_tr_b16 v[56:57], v2 offset:63488
    ds_read_b64_tr_b16 v[58:59], v2 offset:63744
    v_mfma_f32_32x32x16_bf16 v[112:127], v[44:47], a[120:123], v[112:127]
    ds_read_b64_tr_b16 v[60:61], v2 offset:64000
    ds_read_b64_tr_b16 v[62:63], v2 offset:64256
    s_waitcnt lgkmcnt(4)
    v_mfma_f32_32x32x16_bf16 v[64:79], v[48:51], a[124:127], v[64:79]
    v_mfma_f32_32x32x16_bf16 v[80:95], v[52:55], a[124:127], v[80:95]
    s_waitcnt lgkmcnt(0)
    s_barrier
    ds_read_b128 v[32:35], v9 offset:0
    ds_read_b128 v[36:39], v9 offset:512
    ds_read_b128 v[40:43], v9 offset:1024
    ds_read_b128 v[44:47], v9 offset:1536
    v_mfma_f32_32x32x16_bf16 v[96:111], v[56:59], a[124:127], v[96:111]
    v_mfma_f32_32x32x16_bf16 v[112:127], v[60:63], a[124:127], v[112:127]
    s_waitcnt lgkmcnt(3)
    v_mfma_f32_32x32x16_bf16 v[64:79], v[32:35], v[10:13], v[64:79]
    s_waitcnt lgkmcnt(2)
    v_mfma_f32_32x32x16_bf16 v[80:95], v[36:39], v[10:13], v[80:95]
    s_waitcnt lgkmcnt(1)
    v_mfma_f32_32x32x16_bf16 v[96:111], v[40:43], v[10:13], v[96:111]
    s_waitcnt lgkmcnt(0)
    v_mfma_f32_32x32x16_bf16 v[112:127], v[44:47], v[10:13], v[112:127]
    s_mul_i32 s100, s63, 114688
    s_lshl_b32 s101, s3, 13
    s_add_u32 s100, s100, 4194304
    s_add_u32 s101, s101, s100
    s_nop 1
    v_pk_mul_f32 v[18:19], v[64:65], v[64:65]
    v_pk_mul_f32 v[20:21], v[66:67], v[66:67]
    v_pk_mul_f32 v[22:23], v[68:69], v[68:69]
    v_pk_mul_f32 v[24:25], v[70:71], v[70:71]
    v_pk_fma_f32 v[18:19], v[18:19], v[16:17], v[14:15]
    v_pk_fma_f32 v[20:21], v[20:21], v[16:17], v[14:15]
    v_pk_fma_f32 v[22:23], v[22:23], v[16:17], v[14:15]
    v_pk_fma_f32 v[24:25], v[24:25], v[16:17], v[14:15]
    v_pk_mul_f32 v[18:19], v[64:65], v[18:19]
    v_pk_mul_f32 v[20:21], v[66:67], v[20:21]
    v_pk_mul_f32 v[22:23], v[68:69], v[22:23]
    v_pk_mul_f32 v[24:25], v[70:71], v[24:25]
    v_exp_f32 v18, v18
    v_exp_f32 v19, v19
    v_exp_f32 v20, v20
    v_exp_f32 v21, v21
    v_exp_f32 v22, v22
    v_exp_f32 v23, v23
    v_exp_f32 v24, v24
    v_exp_f32_e64 v25, v25
    v_pk_fma_f32 v[18:19], v[18:19], v[6:7], v[6:7]
    v_pk_fma_f32 v[20:21], v[20:21], v[6:7], v[6:7]
    v_pk_fma_f32 v[22:23], v[22:23], v[6:7], v[6:7]
    v_pk_fma_f32 v[24:25], v[24:25], v[6:7], v[6:7]
    v_rcp_f32 v18, v18
    v_rcp_f32 v19, v19
    v_rcp_f32 v20, v20
    v_rcp_f32 v21, v21
    v_rcp_f32 v22, v22
    v_rcp_f32 v23, v23
    v_rcp_f32 v24, v24
    v_rcp_f32 v25, v25
    v_pk_mul_f32 v[18:19], v[64:65], v[18:19]
    v_pk_mul_f32 v[20:21], v[66:67], v[20:21]
    v_pk_mul_f32 v[22:23], v[68:69], v[22:23]
    v_pk_mul_f32 v[24:25], v[70:71], v[24:25]
    v_cvt_pk_bf16_f32 v64, v18, v19
    v_cvt_pk_bf16_f32 v65, v20, v21
    v_cvt_pk_bf16_f32 v66, v22, v23
    v_cvt_pk_bf16_f32 v67, v24, v25
    v_pk_mul_f32 v[18:19], v[72:73], v[72:73]
    v_pk_mul_f32 v[20:21], v[74:75], v[74:75]
    v_pk_mul_f32 v[22:23], v[76:77], v[76:77]
    v_pk_mul_f32 v[24:25], v[78:79], v[78:79]
    v_pk_fma_f32 v[18:19], v[18:19], v[16:17], v[14:15]
    v_pk_fma_f32 v[20:21], v[20:21], v[16:17], v[14:15]
    v_pk_fma_f32 v[22:23], v[22:23], v[16:17], v[14:15]
    v_pk_fma_f32 v[24:25], v[24:25], v[16:17], v[14:15]
    v_pk_mul_f32 v[18:19], v[72:73], v[18:19]
    v_pk_mul_f32 v[20:21], v[74:75], v[20:21]
    v_pk_mul_f32 v[22:23], v[76:77], v[22:23]
    v_pk_mul_f32 v[24:25], v[78:79], v[24:25]
    v_exp_f32 v18, v18
    v_exp_f32 v19, v19
    v_exp_f32 v20, v20
    v_exp_f32 v21, v21
    v_exp_f32 v22, v22
    v_exp_f32 v23, v23
    v_exp_f32 v24, v24
    v_exp_f32 v25, v25
    v_pk_fma_f32 v[18:19], v[18:19], v[6:7], v[6:7]
    v_pk_fma_f32 v[20:21], v[20:21], v[6:7], v[6:7]
    v_pk_fma_f32 v[22:23], v[22:23], v[6:7], v[6:7]
    v_pk_fma_f32 v[24:25], v[24:25], v[6:7], v[6:7]
    v_rcp_f32 v18, v18
    v_rcp_f32 v19, v19
    v_rcp_f32 v20, v20
    v_rcp_f32 v21, v21
    v_rcp_f32 v22, v22
    v_rcp_f32 v23, v23
    v_rcp_f32 v24, v24
    v_rcp_f32 v25, v25
    v_pk_mul_f32 v[18:19], v[72:73], v[18:19]
    v_pk_mul_f32 v[20:21], v[74:75], v[20:21]
    v_pk_mul_f32 v[22:23], v[76:77], v[22:23]
    v_pk_mul_f32 v[24:25], v[78:79], v[24:25]
    v_cvt_pk_bf16_f32 v72, v18, v19
    v_cvt_pk_bf16_f32 v73, v20, v21
    v_cvt_pk_bf16_f32 v74, v22, v23
    v_cvt_pk_bf16_f32 v75, v24, v25
    v_pk_mul_f32 v[18:19], v[80:81], v[80:81]
    v_pk_mul_f32 v[20:21], v[82:83], v[82:83]
    v_pk_mul_f32 v[22:23], v[84:85], v[84:85]
    v_pk_mul_f32 v[24:25], v[86:87], v[86:87]
    v_pk_fma_f32 v[18:19], v[18:19], v[16:17], v[14:15]
    v_pk_fma_f32 v[20:21], v[20:21], v[16:17], v[14:15]
    v_pk_fma_f32 v[22:23], v[22:23], v[16:17], v[14:15]
    v_pk_fma_f32 v[24:25], v[24:25], v[16:17], v[14:15]
    v_pk_mul_f32 v[18:19], v[80:81], v[18:19]
    v_pk_mul_f32 v[20:21], v[82:83], v[20:21]
    v_pk_mul_f32 v[22:23], v[84:85], v[22:23]
    v_pk_mul_f32 v[24:25], v[86:87], v[24:25]
    v_exp_f32 v18, v18
    v_exp_f32 v19, v19
    v_exp_f32 v20, v20
    v_exp_f32 v21, v21
    v_exp_f32 v22, v22
    v_exp_f32 v23, v23
    v_exp_f32 v24, v24
    v_exp_f32 v25, v25
    v_pk_fma_f32 v[18:19], v[18:19], v[6:7], v[6:7]
    v_pk_fma_f32 v[20:21], v[20:21], v[6:7], v[6:7]
    v_pk_fma_f32 v[22:23], v[22:23], v[6:7], v[6:7]
    v_pk_fma_f32 v[24:25], v[24:25], v[6:7], v[6:7]
    v_rcp_f32 v18, v18
    v_rcp_f32 v19, v19
    v_rcp_f32 v20, v20
    v_rcp_f32 v21, v21
    v_rcp_f32 v22, v22
    v_rcp_f32 v23, v23
    v_rcp_f32 v24, v24
    v_rcp_f32 v25, v25
    v_pk_mul_f32 v[18:19], v[80:81], v[18:19]
    v_pk_mul_f32 v[20:21], v[82:83], v[20:21]
    v_pk_mul_f32 v[22:23], v[84:85], v[22:23]
    v_pk_mul_f32 v[24:25], v[86:87], v[24:25]
    v_cvt_pk_bf16_f32 v80, v18, v19
    v_cvt_pk_bf16_f32 v81, v20, v21
    v_cvt_pk_bf16_f32 v82, v22, v23
    v_cvt_pk_bf16_f32 v83, v24, v25
    v_pk_mul_f32 v[18:19], v[88:89], v[88:89]
    v_pk_mul_f32 v[20:21], v[90:91], v[90:91]
    v_pk_mul_f32 v[22:23], v[92:93], v[92:93]
    v_pk_mul_f32 v[24:25], v[94:95], v[94:95]
    v_pk_fma_f32 v[18:19], v[18:19], v[16:17], v[14:15]
    v_pk_fma_f32 v[20:21], v[20:21], v[16:17], v[14:15]
    v_pk_fma_f32 v[22:23], v[22:23], v[16:17], v[14:15]
    v_pk_fma_f32 v[24:25], v[24:25], v[16:17], v[14:15]
    v_pk_mul_f32 v[18:19], v[88:89], v[18:19]
    v_pk_mul_f32 v[20:21], v[90:91], v[20:21]
    v_pk_mul_f32 v[22:23], v[92:93], v[22:23]
    v_pk_mul_f32 v[24:25], v[94:95], v[24:25]
    v_exp_f32 v18, v18
    v_exp_f32 v19, v19
    v_exp_f32 v20, v20
    v_exp_f32 v21, v21
    v_exp_f32 v22, v22
    v_exp_f32 v23, v23
    v_exp_f32 v24, v24
    v_exp_f32 v25, v25
    v_pk_fma_f32 v[18:19], v[18:19], v[6:7], v[6:7]
    v_pk_fma_f32 v[20:21], v[20:21], v[6:7], v[6:7]
    v_pk_fma_f32 v[22:23], v[22:23], v[6:7], v[6:7]
    v_pk_fma_f32 v[24:25], v[24:25], v[6:7], v[6:7]
    v_rcp_f32 v18, v18
    v_rcp_f32 v19, v19
    v_rcp_f32 v20, v20
    v_rcp_f32 v21, v21
    v_rcp_f32 v22, v22
    v_rcp_f32 v23, v23
    v_rcp_f32 v24, v24
    v_rcp_f32 v25, v25
    v_pk_mul_f32 v[18:19], v[88:89], v[18:19]
    v_pk_mul_f32 v[20:21], v[90:91], v[20:21]
    v_pk_mul_f32 v[22:23], v[92:93], v[22:23]
    v_pk_mul_f32 v[24:25], v[94:95], v[24:25]
    v_cvt_pk_bf16_f32 v88, v18, v19
    v_cvt_pk_bf16_f32 v89, v20, v21
    v_cvt_pk_bf16_f32 v90, v22, v23
    v_cvt_pk_bf16_f32 v91, v24, v25
    v_pk_mul_f32 v[18:19], v[96:97], v[96:97]
    v_pk_mul_f32 v[20:21], v[98:99], v[98:99]
    v_pk_mul_f32 v[22:23], v[100:101], v[100:101]
    v_pk_mul_f32 v[24:25], v[102:103], v[102:103]
    v_pk_fma_f32 v[18:19], v[18:19], v[16:17], v[14:15]
    v_pk_fma_f32 v[20:21], v[20:21], v[16:17], v[14:15]
    v_pk_fma_f32 v[22:23], v[22:23], v[16:17], v[14:15]
    v_pk_fma_f32 v[24:25], v[24:25], v[16:17], v[14:15]
    v_pk_mul_f32 v[18:19], v[96:97], v[18:19]
    v_pk_mul_f32 v[20:21], v[98:99], v[20:21]
    v_pk_mul_f32 v[22:23], v[100:101], v[22:23]
    v_pk_mul_f32 v[24:25], v[102:103], v[24:25]
    v_exp_f32 v18, v18
    v_exp_f32 v19, v19
    v_exp_f32 v20, v20
    v_exp_f32 v21, v21
    v_exp_f32 v22, v22
    v_exp_f32 v23, v23
    v_exp_f32 v24, v24
    v_exp_f32 v25, v25
    v_pk_fma_f32 v[18:19], v[18:19], v[6:7], v[6:7]
    v_pk_fma_f32 v[20:21], v[20:21], v[6:7], v[6:7]
    v_pk_fma_f32 v[22:23], v[22:23], v[6:7], v[6:7]
    v_pk_fma_f32 v[24:25], v[24:25], v[6:7], v[6:7]
    v_rcp_f32 v18, v18
    v_rcp_f32 v19, v19
    v_rcp_f32 v20, v20
    v_rcp_f32 v21, v21
    v_rcp_f32 v22, v22
    v_rcp_f32 v23, v23
    v_rcp_f32 v24, v24
    v_rcp_f32 v25, v25
    v_pk_mul_f32 v[18:19], v[96:97], v[18:19]
    v_pk_mul_f32 v[20:21], v[98:99], v[20:21]
    v_pk_mul_f32 v[22:23], v[100:101], v[22:23]
    v_pk_mul_f32 v[24:25], v[102:103], v[24:25]
    v_cvt_pk_bf16_f32 v96, v18, v19
    v_cvt_pk_bf16_f32 v97, v20, v21
    v_cvt_pk_bf16_f32 v98, v22, v23
    v_cvt_pk_bf16_f32 v99, v24, v25
    v_pk_mul_f32 v[18:19], v[104:105], v[104:105]
    v_pk_mul_f32 v[20:21], v[106:107], v[106:107]
    v_pk_mul_f32 v[22:23], v[108:109], v[108:109]
    v_pk_mul_f32 v[24:25], v[110:111], v[110:111]
    v_pk_fma_f32 v[18:19], v[18:19], v[16:17], v[14:15]
    v_pk_fma_f32 v[20:21], v[20:21], v[16:17], v[14:15]
    v_pk_fma_f32 v[22:23], v[22:23], v[16:17], v[14:15]
    v_pk_fma_f32 v[24:25], v[24:25], v[16:17], v[14:15]
    v_pk_mul_f32 v[18:19], v[104:105], v[18:19]
    v_pk_mul_f32 v[20:21], v[106:107], v[20:21]
    v_pk_mul_f32 v[22:23], v[108:109], v[22:23]
    v_pk_mul_f32 v[24:25], v[110:111], v[24:25]
    v_exp_f32 v18, v18
    v_exp_f32 v19, v19
    v_exp_f32 v20, v20
    v_exp_f32 v21, v21
    v_exp_f32 v22, v22
    v_exp_f32 v23, v23
    v_exp_f32 v24, v24
    v_exp_f32 v25, v25
    v_pk_fma_f32 v[18:19], v[18:19], v[6:7], v[6:7]
    v_pk_fma_f32 v[20:21], v[20:21], v[6:7], v[6:7]
    v_pk_fma_f32 v[22:23], v[22:23], v[6:7], v[6:7]
    v_pk_fma_f32 v[24:25], v[24:25], v[6:7], v[6:7]
    v_rcp_f32 v18, v18
    v_rcp_f32 v19, v19
    v_rcp_f32 v20, v20
    v_rcp_f32 v21, v21
    v_rcp_f32 v22, v22
    v_rcp_f32 v23, v23
    v_rcp_f32 v24, v24
    v_rcp_f32 v25, v25
    v_pk_mul_f32 v[18:19], v[104:105], v[18:19]
    v_pk_mul_f32 v[20:21], v[106:107], v[20:21]
    v_pk_mul_f32 v[22:23], v[108:109], v[22:23]
    v_pk_mul_f32 v[24:25], v[110:111], v[24:25]
    v_cvt_pk_bf16_f32 v104, v18, v19
    v_cvt_pk_bf16_f32 v105, v20, v21
    v_cvt_pk_bf16_f32 v106, v22, v23
    v_cvt_pk_bf16_f32 v107, v24, v25
    v_pk_mul_f32 v[18:19], v[112:113], v[112:113]
    v_pk_mul_f32 v[20:21], v[114:115], v[114:115]
    v_pk_mul_f32 v[22:23], v[116:117], v[116:117]
    v_pk_mul_f32 v[24:25], v[118:119], v[118:119]
    v_pk_fma_f32 v[18:19], v[18:19], v[16:17], v[14:15]
    v_pk_fma_f32 v[20:21], v[20:21], v[16:17], v[14:15]
    v_pk_fma_f32 v[22:23], v[22:23], v[16:17], v[14:15]
    v_pk_fma_f32 v[24:25], v[24:25], v[16:17], v[14:15]
    v_pk_mul_f32 v[18:19], v[112:113], v[18:19]
    v_pk_mul_f32 v[20:21], v[114:115], v[20:21]
    v_pk_mul_f32 v[22:23], v[116:117], v[22:23]
    v_pk_mul_f32 v[24:25], v[118:119], v[24:25]
    v_exp_f32 v18, v18
    v_exp_f32 v19, v19
    v_exp_f32 v20, v20
    v_exp_f32 v21, v21
    v_exp_f32 v22, v22
    v_exp_f32 v23, v23
    v_exp_f32 v24, v24
    v_exp_f32 v25, v25
    v_pk_fma_f32 v[18:19], v[18:19], v[6:7], v[6:7]
    v_pk_fma_f32 v[20:21], v[20:21], v[6:7], v[6:7]
    v_pk_fma_f32 v[22:23], v[22:23], v[6:7], v[6:7]
    v_pk_fma_f32 v[24:25], v[24:25], v[6:7], v[6:7]
    v_rcp_f32 v18, v18
    v_rcp_f32 v19, v19
    v_rcp_f32 v20, v20
    v_rcp_f32 v21, v21
    v_rcp_f32 v22, v22
    v_rcp_f32 v23, v23
    v_rcp_f32 v24, v24
    v_rcp_f32 v25, v25
    v_pk_mul_f32 v[18:19], v[112:113], v[18:19]
    v_pk_mul_f32 v[20:21], v[114:115], v[20:21]
    v_pk_mul_f32 v[22:23], v[116:117], v[22:23]
    v_pk_mul_f32 v[24:25], v[118:119], v[24:25]
    v_cvt_pk_bf16_f32 v112, v18, v19
    v_cvt_pk_bf16_f32 v113, v20, v21
    v_cvt_pk_bf16_f32 v114, v22, v23
    v_cvt_pk_bf16_f32 v115, v24, v25
    v_pk_mul_f32 v[18:19], v[120:121], v[120:121]
    v_pk_mul_f32 v[20:21], v[122:123], v[122:123]
    v_pk_mul_f32 v[22:23], v[124:125], v[124:125]
    v_pk_mul_f32 v[24:25], v[126:127], v[126:127]
    v_pk_fma_f32 v[18:19], v[18:19], v[16:17], v[14:15]
    v_pk_fma_f32 v[20:21], v[20:21], v[16:17], v[14:15]
    v_pk_fma_f32 v[22:23], v[22:23], v[16:17], v[14:15]
    v_pk_fma_f32 v[24:25], v[24:25], v[16:17], v[14:15]
    v_pk_mul_f32 v[18:19], v[120:121], v[18:19]
    v_pk_mul_f32 v[20:21], v[122:123], v[20:21]
    v_pk_mul_f32 v[22:23], v[124:125], v[22:23]
    v_pk_mul_f32 v[24:25], v[126:127], v[24:25]
    v_exp_f32 v18, v18
    v_exp_f32 v19, v19
    v_exp_f32 v20, v20
    v_exp_f32 v21, v21
    v_exp_f32 v22, v22
    v_exp_f32 v23, v23
    v_exp_f32 v24, v24
    v_exp_f32 v25, v25
    v_pk_fma_f32 v[18:19], v[18:19], v[6:7], v[6:7]
    v_pk_fma_f32 v[20:21], v[20:21], v[6:7], v[6:7]
    v_pk_fma_f32 v[22:23], v[22:23], v[6:7], v[6:7]
    v_pk_fma_f32 v[24:25], v[24:25], v[6:7], v[6:7]
    v_rcp_f32 v18, v18
    v_rcp_f32 v19, v19
    v_rcp_f32 v20, v20
    v_rcp_f32 v21, v21
    v_rcp_f32 v22, v22
    v_rcp_f32 v23, v23
    v_rcp_f32 v24, v24
    v_rcp_f32 v25, v25
    v_pk_mul_f32 v[18:19], v[120:121], v[18:19]
    v_pk_mul_f32 v[20:21], v[122:123], v[20:21]
    v_pk_mul_f32 v[22:23], v[124:125], v[22:23]
    v_pk_mul_f32 v[24:25], v[126:127], v[24:25]
    v_cvt_pk_bf16_f32 v120, v18, v19
    v_cvt_pk_bf16_f32 v121, v20, v21
    v_cvt_pk_bf16_f32 v122, v22, v23
    v_cvt_pk_bf16_f32 v123, v24, v25
    ds_read_b32 v30, v26 offset:0
    s_waitcnt lgkmcnt(0)
    v_cmp_gt_u32 vcc, 1, v30
    s_nop 1
    s_cbranch_vccnz L_lslow53
L_lret54:
    ds_read_b64_tr_b16 v[48:49], v3 offset:32768
    ds_read_b64_tr_b16 v[50:51], v3 offset:33024
    ds_read_b64_tr_b16 v[52:53], v3 offset:33280
    ds_read_b64_tr_b16 v[54:55], v3 offset:33536
    ds_read_b64_tr_b16 v[56:57], v3 offset:34816
    ds_read_b64_tr_b16 v[58:59], v3 offset:35072
    buffer_store_dwordx4 v[64:67], v1, s[24:27], s101 offen offset:0 sc1
    buffer_store_dwordx4 v[72:75], v1, s[24:27], s101 offen offset:1024 sc1
    buffer_store_dwordx4 v[80:83], v1, s[24:27], s101 offen offset:2048 sc1
    buffer_store_dwordx4 v[88:91], v1, s[24:27], s101 offen offset:3072 sc1
    s_add_u32 s101, s101, 4096
    buffer_store_dwordx4 v[96:99], v1, s[24:27], s101 offen offset:0 sc1
    buffer_store_dwordx4 v[104:107], v1, s[24:27], s101 offen offset:1024 sc1
    buffer_store_dwordx4 v[112:115], v1, s[24:27], s101 offen offset:2048 sc1
    buffer_store_dwordx4 v[120:123], v1, s[24:27], s101 offen offset:3072 sc1
    s_waitcnt lgkmcnt(4)
    v_mfma_f32_32x32x16_bf16 v[96:111], v[48:51], a[0:3], 0
    ds_read_b64_tr_b16 v[60:61], v3 offset:35328
    ds_read_b64_tr_b16 v[62:63], v3 offset:35584
    s_waitcnt lgkmcnt(4)
    v_mfma_f32_32x32x16_bf16 v[112:127], v[52:55], a[0:3], 0
    ds_read_b64_tr_b16 v[48:49], v3 offset:36864
    ds_read_b64_tr_b16 v[50:51], v3 offset:37120
    s_waitcnt lgkmcnt(4)
    v_mfma_f32_32x32x16_bf16 v[96:111], v[56:59], a[4:7], v[96:111]
    ds_read_b64_tr_b16 v[52:53], v3 offset:37376
    ds_read_b64_tr_b16 v[54:55], v3 offset:37632
    s_waitcnt lgkmcnt(4)
    v_mfma_f32_32x32x16_bf16 v[112:127], v[60:63], a[4:7], v[112:127]
    ds_read_b64_tr_b16 v[56:57], v3 offset:38912
    ds_read_b64_tr_b16 v[58:59], v3 offset:39168
    s_waitcnt lgkmcnt(4)
    v_mfma_f32_32x32x16_bf16 v[96:111], v[48:51], a[8:11], v[96:111]
    ds_read_b64_tr_b16 v[60:61], v3 offset:39424
    ds_read_b64_tr_b16 v[62:63], v3 offset:39680
    s_waitcnt lgkmcnt(4)
    v_mfma_f32_32x32x16_bf16 v[112:127], v[52:55], a[8:11], v[112:127]
    ds_read_b64_tr_b16 v[48:49], v3 offset:40960
    ds_read_b64_tr_b16 v[50:51], v3 offset:41216
    s_waitcnt lgkmcnt(4)
    v_mfma_f32_32x32x16_bf16 v[96:111], v[56:59], a[12:15], v[96:111]
    ds_read_b64_tr_b16 v[52:53], v3 offset:41472
    ds_read_b64_tr_b16 v[54:55], v3 offset:41728
    s_waitcnt lgkmcnt(4)
    v_mfma_f32_32x32x16_bf16 v[112:127], v[60:63], a[12:15], v[112:127]
    ds_read_b64_tr_b16 v[56:57], v3 offset:43008
    ds_read_b64_tr_b16 v[58:59], v3 offset:43264
    s_waitcnt lgkmcnt(4)
    v_mfma_f32_32x32x16_bf16 v[96:111], v[48:51], a[16:19], v[96:111]
    ds_read_b64_tr_b16 v[60:61], v3 offset:43520
    ds_read_b64_tr_b16 v[62:63], v3 offset:43776
    s_waitcnt lgkmcnt(4)
    v_mfma_f32_32x32x16_bf16 v[112:127], v[52:55], a[16:19], v[112:127]
    ds_read_b64_tr_b16 v[48:49], v3 offset:45056
    ds_read_b64_tr_b16 v[50:51], v3 offset:45312
    s_waitcnt lgkmcnt(4)
    v_mfma_f32_32x32x16_bf16 v[96:111], v[56:59], a[20:23], v[96:111]
    ds_read_b64_tr_b16 v[52:53], v3 offset:45568
    ds_read_b64_tr_b16 v[54:55], v3 offset:45824
    s_waitcnt lgkmcnt(4)
    v_mfma_f32_32x32x16_bf16 v[112:127], v[60:63], a[20:23], v[112:127]
    ds_read_b64_tr_b16 v[56:57], v3 offset:47104
    ds_read_b64_tr_b16 v[58:59], v3 offset:47360
    s_waitcnt lgkmcnt(4)
    v_mfma_f32_32x32x16_bf16 v[96:111], v[48:51], a[24:27], v[96:111]
    ds_read_b64_tr_b16 v[60:61], v3 offset:47616
    ds_read_b64_tr_b16 v[62:63], v3 offset:47872
    s_waitcnt lgkmcnt(4)
    v_mfma_f32_32x32x16_bf16 v[112:127], v[52:55], a[24:27], v[112:127]
    ds_read_b64_tr_b16 v[48:49], v3 offset:49152
    ds_read_b64_tr_b16 v[50:51], v3 offset:49408
    s_waitcnt lgkmcnt(4)
    v_mfma_f32_32x32x16_bf16 v[96:111], v[56:59], a[28:31], v[96:111]
    ds_read_b64_tr_b16 v[52:53], v3 offset:49664
    ds_read_b64_tr_b16 v[54:55], v3 offset:49920
    s_waitcnt lgkmcnt(4)
    v_mfma_f32_32x32x16_bf16 v[112:127], v[60:63], a[28:31], v[112:127]
    ds_read_b64_tr_b16 v[56:57], v3 offset:51200
    ds_read_b64_tr_b16 v[58:59], v3 offset:51456
    s_waitcnt lgkmcnt(4)
    v_mfma_f32_32x32x16_bf16 v[96:111], v[48:51], a[32:35], v[96:111]
    ds_read_b64_tr_b16 v[60:61], v3 offset:51712
    ds_read_b64_tr_b16 v[62:63], v3 offset:51968
    s_waitcnt lgkmcnt(4)
    v_mfma_f32_32x32x16_bf16 v[112:127], v[52:55], a[32:35], v[112:127]
    ds_read_b64_tr_b16 v[48:49], v3 offset:53248
    ds_read_b64_tr_b16 v[50:51], v3 offset:53504
    s_waitcnt lgkmcnt(4)
    v_mfma_f32_32x32x16_bf16 v[96:111], v[56:59], a[36:39], v[96:111]
    ds_read_b64_tr_b16 v[52:53], v3 offset:53760
    ds_read_b64_tr_b16 v[54:55], v3 offset:54016
    s_waitcnt lgkmcnt(4)
    v_mfma_f32_32x32x16_bf16 v[112:127], v[60:63], a[36:39], v[112:127]
    ds_read_b64_tr_b16 v[56:57], v3 offset:55296
    ds_read_b64_tr_b16 v[58:59], v3 offset:55552
    s_waitcnt lgkmcnt(4)
    v_mfma_f32_32x32x16_bf16 v[96:111], v[48:51], a[40:43], v[96:111]
    ds_read_b64_tr_b16 v[60:61], v3 offset:55808
    ds_read_b64_tr_b16 v[62:63], v3 offset:56064
    s_waitcnt lgkmcnt(4)
    v_mfma_f32_32x32x16_bf16 v[112:127], v[52:55], a[40:43], v[112:127]
    ds_read_b64_tr_b16 v[48:49], v3 offset:57344
    ds_read_b64_tr_b16 v[50:51], v3 offset:57600
    s_waitcnt lgkmcnt(4)
    v_mfma_f32_32x32x16_bf16 v[96:111], v[56:59], a[44:47], v[96:111]
    ds_read_b64_tr_b16 v[52:53], v3 offset:57856
    ds_read_b64_tr_b16 v[54:55], v3 offset:58112
    s_waitcnt lgkmcnt(4)
    v_mfma_f32_32x32x16_bf16 v[112:127], v[60:63], a[44:47], v[112:127]
    ds_read_b64_tr_b16 v[56:57], v3 offset:59392
    ds_read_b64_tr_b16 v[58:59], v3 offset:59648
    s_waitcnt lgkmcnt(4)
    v_mfma_f32_32x32x16_bf16 v[96:111], v[48:51], a[48:51], v[96:111]
    ds_read_b64_tr_b16 v[60:61], v3 offset:59904
    ds_read_b64_tr_b16 v[62:63], v3 offset:60160
    s_waitcnt lgkmcnt(4)
    v_mfma_f32_32x32x16_bf16 v[112:127], v[52:55], a[48:51], v[112:127]
    ds_read_b64_tr_b16 v[48:49], v3 offset:61440
    ds_read_b64_tr_b16 v[50:51], v3 offset:61696
    s_waitcnt lgkmcnt(4)
    v_mfma_f32_32x32x16_bf16 v[96:111], v[56:59], a[52:55], v[96:111]
    ds_read_b64_tr_b16 v[52:53], v3 offset:61952
    ds_read_b64_tr_b16 v[54:55], v3 offset:62208
    s_waitcnt lgkmcnt(4)
    v_mfma_f32_32x32x16_bf16 v[112:127], v[60:63], a[52:55], v[112:127]
    ds_read_b64_tr_b16 v[56:57], v3 offset:63488
    ds_read_b64_tr_b16 v[58:59], v3 offset:63744
    s_waitcnt lgkmcnt(4)
    v_mfma_f32_32x32x16_bf16 v[96:111], v[48:51], a[56:59], v[96:111]
    ds_read_b64_tr_b16 v[60:61], v3 offset:64000
    ds_read_b64_tr_b16 v[62:63], v3 offset:64256
    v_mov_b32_e64 v28, 2
    ds_write_b32 v27, v28
    s_waitcnt lgkmcnt(5)
    v_mfma_f32_32x32x16_bf16 v[112:127], v[52:55], a[56:59], v[112:127]
    ds_read_b64_tr_b16 v[48:49], v4 offset:0
    ds_read_b64_tr_b16 v[50:51], v4 offset:256
    s_waitcnt lgkmcnt(5)
    v_mfma_f32_32x32x16_bf16 v[96:111], v[56:59], a[60:63], v[96:111]
    ds_read_b64_tr_b16 v[52:53], v4 offset:512
    ds_read_b64_tr_b16 v[54:55], v4 offset:768
    s_waitcnt vmcnt(0)
    s_lshl_b32 s92, s63, 4
    s_add_u32 s92, s92, s44
    s_lshl_b32 s92, s92, 7
    s_add_u32 s92, s92, 589824
    v_mov_b32 v30, s40
    v_mov_b32 v31, s41
    s_mov_b64 exec, 1
    buffer_store_dwordx2 v[30:31], off, s[24:27], s92 sc1
    s_mov_b64 exec, -1
    s_waitcnt lgkmcnt(5)
    v_mfma_f32_32x32x16_bf16 v[112:127], v[60:63], a[60:63], v[112:127]
    ds_read_b64_tr_b16 v[56:57], v4 offset:2048
    ds_read_b64_tr_b16 v[58:59], v4 offset:2304
    s_waitcnt lgkmcnt(4)
    v_mfma_f32_32x32x16_bf16 v[96:111], v[48:51], a[64:67], v[96:111]
    ds_read_b64_tr_b16 v[60:61], v4 offset:2560
    ds_read_b64_tr_b16 v[62:63], v4 offset:2816
    s_waitcnt lgkmcnt(4)
    v_mfma_f32_32x32x16_bf16 v[112:127], v[52:55], a[64:67], v[112:127]
    ds_read_b64_tr_b16 v[48:49], v4 offset:4096
    ds_read_b64_tr_b16 v[50:51], v4 offset:4352
    s_waitcnt lgkmcnt(4)
    v_mfma_f32_32x32x16_bf16 v[96:111], v[56:59], a[68:71], v[96:111]
    ds_read_b64_tr_b16 v[52:53], v4 offset:4608
    ds_read_b64_tr_b16 v[54:55], v4 offset:4864
    s_waitcnt lgkmcnt(4)
    v_mfma_f32_32x32x16_bf16 v[112:127], v[60:63], a[68:71], v[112:127]
    ds_read_b64_tr_b16 v[56:57], v4 offset:6144
    ds_read_b64_tr_b16 v[58:59], v4 offset:6400
    s_waitcnt lgkmcnt(4)
    v_mfma_f32_32x32x16_bf16 v[96:111], v[48:51], a[72:75], v[96:111]
    ds_read_b64_tr_b16 v[60:61], v4 offset:6656
    ds_read_b64_tr_b16 v[62:63], v4 offset:6912
    s_waitcnt lgkmcnt(4)
    v_mfma_f32_32x32x16_bf16 v[112:127], v[52:55], a[72:75], v[112:127]
    ds_read_b64_tr_b16 v[48:49], v4 offset:8192
    ds_read_b64_tr_b16 v[50:51], v4 offset:8448
    s_waitcnt lgkmcnt(4)
    v_mfma_f32_32x32x16_bf16 v[96:111], v[56:59], a[76:79], v[96:111]
    ds_read_b64_tr_b16 v[52:53], v4 offset:8704
    ds_read_b64_tr_b16 v[54:55], v4 offset:8960
    s_waitcnt lgkmcnt(4)
    v_mfma_f32_32x32x16_bf16 v[112:127], v[60:63], a[76:79], v[112:127]
    ds_read_b64_tr_b16 v[56:57], v4 offset:10240
    ds_read_b64_tr_b16 v[58:59], v4 offset:10496
    s_waitcnt lgkmcnt(4)
    v_mfma_f32_32x32x16_bf16 v[96:111], v[48:51], a[80:83], v[96:111]
    ds_read_b64_tr_b16 v[60:61], v4 offset:10752
    ds_read_b64_tr_b16 v[62:63], v4 offset:11008
    s_waitcnt lgkmcnt(4)
    v_mfma_f32_32x32x16_bf16 v[112:127], v[52:55], a[80:83], v[112:127]
    ds_read_b64_tr_b16 v[48:49], v4 offset:12288
    ds_read_b64_tr_b16 v[50:51], v4 offset:12544
    s_waitcnt lgkmcnt(4)
    v_mfma_f32_32x32x16_bf16 v[96:111], v[56:59], a[84:87], v[96:111]
    ds_read_b64_tr_b16 v[52:53], v4 offset:12800
    ds_read_b64_tr_b16 v[54:55], v4 offset:13056
    s_waitcnt lgkmcnt(4)
    v_mfma_f32_32x32x16_bf16 v[112:127], v[60:63], a[84:87], v[112:127]
    ds_read_b64_tr_b16 v[56:57], v4 offset:14336
    ds_read_b64_tr_b16 v[58:59], v4 offset:14592
    s_waitcnt lgkmcnt(4)
    v_mfma_f32_32x32x16_bf16 v[96:111], v[48:51], a[88:91], v[96:111]
    ds_read_b64_tr_b16 v[60:61], v4 offset:14848
    ds_read_b64_tr_b16 v[62:63], v4 offset:15104
    s_waitcnt lgkmcnt(4)
    v_mfma_f32_32x32x16_bf16 v[112:127], v[52:55], a[88:91], v[112:127]
    ds_read_b64_tr_b16 v[48:49], v3 offset:0
    ds_read_b64_tr_b16 v[50:51], v3 offset:256
    s_waitcnt lgkmcnt(4)
    v_mfma_f32_32x32x16_bf16 v[96:111], v[56:59], a[92:95], v[96:111]
    ds_read_b64_tr_b16 v[52:53], v3 offset:512
    ds_read_b64_tr_b16 v[54:55], v3 offset:768
    v_mov_b32 v6, v8
    v_mov_b32 v7, v8
    s_waitcnt lgkmcnt(4)
    v_mfma_f32_32x32x16_bf16 v[112:127], v[60:63], a[92:95], v[112:127]
    ds_read_b64_tr_b16 v[56:57], v3 offset:2048
    ds_read_b64_tr_b16 v[58:59], v3 offset:2304
    s_waitcnt lgkmcnt(4)
    v_mfma_f32_32x32x16_bf16 v[96:111], v[48:51], a[96:99], v[96:111]
    ds_read_b64_tr_b16 v[60:61], v3 offset:2560
    ds_read_b64_tr_b16 v[62:63], v3 offset:2816
    s_lshl_b32 s100, s3, 13
    s_add_u32 s100, s100, 720896
    s_lshl_b32 s90, s42, 7
    v_and_b32 v16, 15, v0
    v_lshlrev_b32_e64 v16, 9, v16
    v_bfe_u32 v17, v0, 4, 1
    v_mul_lo_u32 v17, v17, s90
    v_add_u32 v16, v16, v17
    s_waitcnt lgkmcnt(4)
    v_mfma_f32_32x32x16_bf16 v[112:127], v[52:55], a[96:99], v[112:127]
    ds_read_b64_tr_b16 v[48:49], v3 offset:4096
    ds_read_b64_tr_b16 v[50:51], v3 offset:4352
    s_waitcnt lgkmcnt(4)
    v_mfma_f32_32x32x16_bf16 v[96:111], v[56:59], a[100:103], v[96:111]
    ds_read_b64_tr_b16 v[52:53], v3 offset:4608
    ds_read_b64_tr_b16 v[54:55], v3 offset:4864
    s_waitcnt lgkmcnt(4)
    v_mfma_f32_32x32x16_bf16 v[112:127], v[60:63], a[100:103], v[112:127]
    ds_read_b64_tr_b16 v[56:57], v3 offset:6144
    ds_read_b64_tr_b16 v[58:59], v3 offset:6400
    s_waitcnt lgkmcnt(4)
    v_mfma_f32_32x32x16_bf16 v[96:111], v[48:51], a[104:107], v[96:111]
    ds_read_b64_tr_b16 v[60:61], v3 offset:6656
    ds_read_b64_tr_b16 v[62:63], v3 offset:6912
    s_waitcnt lgkmcnt(4)
    v_mfma_f32_32x32x16_bf16 v[112:127], v[52:55], a[104:107], v[112:127]
    ds_read_b64_tr_b16 v[48:49], v3 offset:8192
    ds_read_b64_tr_b16 v[50:51], v3 offset:8448
    s_waitcnt lgkmcnt(4)
    v_mfma_f32_32x32x16_bf16 v[96:111], v[56:59], a[108:111], v[96:111]
    ds_read_b64_tr_b16 v[52:53], v3 offset:8704
    ds_read_b64_tr_b16 v[54:55], v3 offset:8960
    s_waitcnt lgkmcnt(4)
    v_mfma_f32_32x32x16_bf16 v[112:127], v[60:63], a[108:111], v[112:127]
    ds_read_b64_tr_b16 v[56:57], v3 offset:10240
    ds_read_b64_tr_b16 v[58:59], v3 offset:10496
    s_waitcnt lgkmcnt(4)
    v_mfma_f32_32x32x16_bf16 v[96:111], v[48:51], a[112:115], v[96:111]
    ds_read_b64_tr_b16 v[60:61], v3 offset:10752
    ds_read_b64_tr_b16 v[62:63], v3 offset:11008
    s_waitcnt lgkmcnt(4)
    v_mfma_f32_32x32x16_bf16 v[112:127], v[52:55], a[112:115], v[112:127]
    ds_read_b64_tr_b16 v[48:49], v3 offset:12288
    ds_read_b64_tr_b16 v[50:51], v3 offset:12544
    s_lshl_b32 s101, s3, 17
    s_add_u32 s101, s101, 1048576
    s_lshl_b32 s90, s42, 6
    s_add_u32 s81, s101, s90
    s_add_u32 s81, s81, 4096
    s_lshl_b32 s90, s42, 10
    s_add_u32 s101, s101, s90
    s_waitcnt lgkmcnt(4)
    v_mfma_f32_32x32x16_bf16 v[96:111], v[56:59], a[116:119], v[96:111]
    ds_read_b64_tr_b16 v[52:53], v3 offset:12800
    ds_read_b64_tr_b16 v[54:55], v3 offset:13056
    s_waitcnt lgkmcnt(4)
    v_mfma_f32_32x32x16_bf16 v[112:127], v[60:63], a[116:119], v[112:127]
    ds_read_b64_tr_b16 v[56:57], v3 offset:14336
    ds_read_b64_tr_b16 v[58:59], v3 offset:14592
    s_waitcnt lgkmcnt(4)
    v_mfma_f32_32x32x16_bf16 v[96:111], v[48:51], a[120:123], v[96:111]
    ds_read_b64_tr_b16 v[60:61], v3 offset:14848
    ds_read_b64_tr_b16 v[62:63], v3 offset:15104
    v_mov_b32 v28, 3
    ds_write_b32 v27, v28
    v_lshrrev_b32 v5, 2, v0
    v_lshlrev_b32 v5, 13, v5
    v_and_b32_e64 v8, 3, v0
    v_lshl_or_b32 v5, v8, 4, v5
    s_waitcnt lgkmcnt(5)
    v_mfma_f32_32x32x16_bf16 v[112:127], v[52:55], a[120:123], v[112:127]
    ds_read_b128 v[48:51], v9 offset:2048
    s_lshl_b32 s80, s63, 15
    s_lshl_b32 s90, s3, 12
    s_add_u32 s80, s80, s90
    s_add_u32 s80, s80, 2097152
    s_waitcnt lgkmcnt(4)
    v_mfma_f32_32x32x16_bf16 v[96:111], v[56:59], a[124:127], v[96:111]
    ds_read_b128 v[52:55], v9 offset:2560
    s_waitcnt lgkmcnt(3)
    v_mfma_f32_32x32x16_bf16 v[112:127], v[60:63], a[124:127], v[112:127]
    s_waitcnt lgkmcnt(1)
    v_mfma_f32_32x32x16_bf16 v[96:111], v[48:51], v[10:13], v[96:111]
    s_waitcnt lgkmcnt(0)
    v_mfma_f32_32x32x16_bf16 v[112:127], v[52:55], v[10:13], v[112:127]
    s_lshl_b32 s100, s3, 9
    s_add_u32 s100, s100, 720896
    s_lshl_b32 s90, s42, 7
    v_and_b32_e64 v16, 1, v0
    v_mul_lo_u32 v16, v16, s90
    s_lshl_b32 s81, s3, 13
    s_add_u32 s81, s81, 1048576
    s_lshl_b32 s90, s42, 10
    s_add_u32 s101, s81, s90
    s_add_u32 s81, s81, 4096
    v_lshlrev_b32_e64 v17, 2, v0
    v_pk_mul_f32 v[96:97], v[96:97], v[6:7]
    v_pk_mul_f32 v[98:99], v[98:99], v[6:7]
    v_pk_mul_f32 v[100:101], v[100:101], v[6:7]
    v_pk_mul_f32 v[102:103], v[102:103], v[6:7]
    v_exp_f32_e64 v18, v96 clamp
    v_exp_f32_e64 v19, v97 clamp
    v_exp_f32_e64 v20, v98 clamp
    v_exp_f32_e64 v21, v99 clamp
    v_exp_f32_e64 v22, v100 clamp
    v_exp_f32_e64 v23, v101 clamp
    v_exp_f32_e64 v24, v102 clamp
    v_exp_f32_e64 v25, v103 clamp
    v_max_f32 v96, 0, v96
    v_max_f32 v97, 0, v97
    v_max_f32 v98, 0, v98
    v_max_f32 v99, 0, v99
    v_max_f32 v100, 0, v100
    v_max_f32 v101, 0, v101
    v_max_f32 v102, 0, v102
    v_max_f32 v103, 0, v103
    v_pk_add_f32 v[18:19], v[18:19], s[72:73]
    v_pk_add_f32 v[20:21], v[20:21], s[72:73]
    v_pk_add_f32 v[22:23], v[22:23], s[72:73]
    v_pk_add_f32 v[24:25], v[24:25], s[72:73]
    v_pk_fma_f32 v[18:19], v[96:97], s[70:71], v[18:19]
    v_pk_fma_f32 v[20:21], v[98:99], s[70:71], v[20:21]
    v_pk_fma_f32 v[22:23], v[100:101], s[70:71], v[22:23]
    v_pk_fma_f32 v[24:25], v[102:103], s[70:71], v[24:25]
    v_cvt_pk_bf16_f32 v96, v18, v19
    v_cvt_pk_bf16_f32 v97, v20, v21
    v_cvt_pk_bf16_f32 v98, v22, v23
    v_cvt_pk_bf16_f32 v99, v24, v25
    v_pk_mul_f32 v[104:105], v[104:105], v[6:7]
    v_pk_mul_f32 v[106:107], v[106:107], v[6:7]
    v_pk_mul_f32 v[108:109], v[108:109], v[6:7]
    v_pk_mul_f32 v[110:111], v[110:111], v[6:7]
    v_exp_f32_e64 v18, v104 clamp
    v_exp_f32_e64 v19, v105 clamp
    v_exp_f32_e64 v20, v106 clamp
    v_exp_f32_e64 v21, v107 clamp
    v_exp_f32_e64 v22, v108 clamp
    v_exp_f32_e64 v23, v109 clamp
    v_exp_f32_e64 v24, v110 clamp
    v_exp_f32_e64 v25, v111 clamp
    v_max_f32 v104, 0, v104
    v_max_f32 v105, 0, v105
    v_max_f32 v106, 0, v106
    v_max_f32 v107, 0, v107
    v_max_f32 v108, 0, v108
    v_max_f32 v109, 0, v109
    v_max_f32 v110, 0, v110
    v_max_f32 v111, 0, v111
    v_pk_add_f32 v[18:19], v[18:19], s[72:73]
    v_pk_add_f32 v[20:21], v[20:21], s[72:73]
    v_pk_add_f32 v[22:23], v[22:23], s[72:73]
    v_pk_add_f32 v[24:25], v[24:25], s[72:73]
    v_pk_fma_f32 v[18:19], v[104:105], s[70:71], v[18:19]
    v_pk_fma_f32 v[20:21], v[106:107], s[70:71], v[20:21]
    v_pk_fma_f32 v[22:23], v[108:109], s[70:71], v[22:23]
    v_pk_fma_f32 v[24:25], v[110:111], s[70:71], v[24:25]
    v_cvt_pk_bf16_f32 v104, v18, v19
    v_cvt_pk_bf16_f32 v105, v20, v21
    v_cvt_pk_bf16_f32 v106, v22, v23
    v_cvt_pk_bf16_f32 v107, v24, v25
    v_pk_mul_f32 v[112:113], v[112:113], v[6:7]
    v_pk_mul_f32 v[114:115], v[114:115], v[6:7]
    v_pk_mul_f32 v[116:117], v[116:117], v[6:7]
    v_pk_mul_f32 v[118:119], v[118:119], v[6:7]
    v_exp_f32_e64 v18, v112 clamp
    v_exp_f32_e64 v19, v113 clamp
    v_exp_f32_e64 v20, v114 clamp
    v_exp_f32_e64 v21, v115 clamp
    v_exp_f32_e64 v22, v116 clamp
    v_exp_f32_e64 v23, v117 clamp
    v_exp_f32_e64 v24, v118 clamp
    v_exp_f32_e64 v25, v119 clamp
    v_max_f32 v112, 0, v112
    v_max_f32 v113, 0, v113
    v_max_f32 v114, 0, v114
    v_max_f32 v115, 0, v115
    v_max_f32 v116, 0, v116
    v_max_f32 v117, 0, v117
    v_max_f32 v118, 0, v118
    v_max_f32 v119, 0, v119
    v_pk_add_f32 v[18:19], v[18:19], s[72:73]
    v_pk_add_f32 v[20:21], v[20:21], s[72:73]
    v_pk_add_f32 v[22:23], v[22:23], s[72:73]
    v_pk_add_f32 v[24:25], v[24:25], s[72:73]
    v_pk_fma_f32 v[18:19], v[112:113], s[70:71], v[18:19]
    v_pk_fma_f32 v[20:21], v[114:115], s[70:71], v[20:21]
    v_pk_fma_f32 v[22:23], v[116:117], s[70:71], v[22:23]
    v_pk_fma_f32 v[24:25], v[118:119], s[70:71], v[24:25]
    v_cvt_pk_bf16_f32 v112, v18, v19
    v_cvt_pk_bf16_f32 v113, v20, v21
    v_cvt_pk_bf16_f32 v114, v22, v23
    v_cvt_pk_bf16_f32 v115, v24, v25
    v_pk_mul_f32 v[120:121], v[120:121], v[6:7]
    v_pk_mul_f32 v[122:123], v[122:123], v[6:7]
    v_pk_mul_f32 v[124:125], v[124:125], v[6:7]
    v_pk_mul_f32 v[126:127], v[126:127], v[6:7]
    v_exp_f32_e64 v18, v120 clamp
    v_exp_f32_e64 v19, v121 clamp
    v_exp_f32_e64 v20, v122 clamp
    v_exp_f32_e64 v21, v123 clamp
    v_exp_f32_e64 v22, v124 clamp
    v_exp_f32_e64 v23, v125 clamp
    v_exp_f32_e64 v24, v126 clamp
    v_exp_f32_e64 v25, v127 clamp
    v_max_f32 v120, 0, v120
    v_max_f32 v121, 0, v121
    v_max_f32 v122, 0, v122
    v_max_f32 v123, 0, v123
    v_max_f32 v124, 0, v124
    v_max_f32 v125, 0, v125
    v_max_f32 v126, 0, v126
    v_max_f32 v127, 0, v127
    v_pk_add_f32 v[18:19], v[18:19], s[72:73]
    v_pk_add_f32 v[20:21], v[20:21], s[72:73]
    v_pk_add_f32 v[22:23], v[22:23], s[72:73]
    v_pk_add_f32 v[24:25], v[24:25], s[72:73]
    v_pk_fma_f32 v[18:19], v[120:121], s[70:71], v[18:19]
    v_pk_fma_f32 v[20:21], v[122:123], s[70:71], v[20:21]
    v_pk_fma_f32 v[22:23], v[124:125], s[70:71], v[22:23]
    v_pk_fma_f32 v[24:25], v[126:127], s[70:71], v[24:25]
    v_cvt_pk_bf16_f32 v120, v18, v19
    v_cvt_pk_bf16_f32 v121, v20, v21
    v_cvt_pk_bf16_f32 v122, v22, v23
    v_cvt_pk_bf16_f32 v123, v24, v25
    buffer_load_dword v14, v16, s[24:27], s100 offen sc1
    s_waitcnt vmcnt(0)
    v_subrev_u32 v14, s40, v14
    v_subrev_u32 v14, 16, v14
    v_cmp_lt_u32 vcc, 0, v14
    s_nop 1
    s_cbranch_vccnz L_slow_kv55
L_ret_kv56:
    buffer_load_dword v64, v17, s[24:27], s101 offen offset:0 sc1
    buffer_load_dword v65, v17, s[24:27], s101 offen offset:256 sc1
    buffer_load_dword v66, v17, s[24:27], s101 offen offset:512 sc1
    buffer_load_dword v67, v17, s[24:27], s101 offen offset:768 sc1
    buffer_load_dword v10, v17, s[24:27], s81 offen sc1
    v_lshlrev_b32_e64 v8, 1, v0
    v_add_u32 v8, 155648, v8
    v_lshlrev_b32 v5, 3, v0
    v_add_u32 v5, 153600, v5
    s_lshl_b32 s90, s42, 9
    v_add_u32 v6, s90, v5
    v_lshrrev_b32_e64 v7, 5, v0
    v_lshlrev_b32_e64 v7, 3, v7
    v_add_u32 v7, 155648, v7
    s_waitcnt vmcnt(3)
    v_cvt_pk_bf16_f32 v64, v64, v65
    s_waitcnt vmcnt(1)
    v_cvt_pk_bf16_f32 v65, v66, v67
    ds_write_b64 v6, v[64:65]
    s_waitcnt vmcnt(0)
    v_cvt_pk_bf16_f32 v10, v10, v10
    ds_write_b16 v8, v10
    v_mov_b32_e64 v28, 4
    ds_write_b32 v27, v28
    ds_read_b32 v30, v26 offset:16
    s_waitcnt lgkmcnt(0)
    v_cmp_gt_u32 vcc, 4, v30
    s_nop 1
    s_cbranch_vccnz L_lslow57
L_lret58:
    ds_read_b64 v[72:73], v5 offset:0
    ds_read_b64 v[74:75], v5 offset:512
    ds_read_b64 v[76:77], v5 offset:1024
    ds_read_b64 v[78:79], v5 offset:1536
    ds_read_b64 v[80:81], v7 offset:0
    ds_read_b64 v[82:83], v7 offset:16
    ds_read_b64 v[84:85], v7 offset:32
    ds_read_b64 v[86:87], v7 offset:48
    ds_read_b64 v[88:89], v7 offset:64
    ds_read_b64 v[90:91], v7 offset:80
    ds_read_b64 v[92:93], v7 offset:96
    ds_read_b64 v[94:95], v7 offset:112
    ds_read_b32 v30, v26 offset:0
    s_waitcnt lgkmcnt(8)
    v_cndmask_b32 v32, v72, v80, s[94:95]
    v_cndmask_b32 v33, v73, v81, s[94:95]
    s_waitcnt lgkmcnt(7)
    v_cndmask_b32 v34, v74, v82, s[94:95]
    v_cndmask_b32 v35, v75, v83, s[94:95]
    s_waitcnt lgkmcnt(6)
    v_cndmask_b32 v36, v84, v72, s[94:95]
    v_cndmask_b32 v37, v85, v73, s[94:95]
    s_waitcnt lgkmcnt(5)
    v_cndmask_b32 v38, v86, v74, s[94:95]
    v_cndmask_b32 v39, v87, v75, s[94:95]
    s_waitcnt lgkmcnt(4)
    v_cndmask_b32 v40, v76, v88, s[94:95]
    v_cndmask_b32 v41, v77, v89, s[94:95]
    s_waitcnt lgkmcnt(3)
    v_cndmask_b32 v42, v78, v90, s[94:95]
    v_cndmask_b32 v43, v79, v91, s[94:95]
    s_waitcnt lgkmcnt(2)
    v_cndmask_b32 v44, v92, v76, s[94:95]
    v_cndmask_b32 v45, v93, v77, s[94:95]
    s_waitcnt lgkmcnt(1)
    v_cndmask_b32 v46, v94, v78, s[94:95]
    v_cndmask_b32 v47, v95, v79, s[94:95]
    v_mfma_f32_32x32x16_bf16 v[48:63], v[32:35], v[96:99], 0
    v_mfma_f32_32x32x16_bf16 v[64:79], v[36:39], v[104:107], 0
    v_mfma_f32_32x32x16_bf16 v[80:95], v[40:43], v[112:115], 0
    s_nop 9
    v_pk_add_f32 v[18:19], v[56:57], s[72:73]
    v_rcp_f32 v18, v18
    v_rcp_f32 v19, v19
    s_nop 0
    v_pk_mul_f32 v[48:49], v[48:49], v[18:19]
    v_pk_mul_f32 v[50:51], v[50:51], v[18:19]
    v_pk_mul_f32 v[52:53], v[52:53], v[18:19]
    v_pk_mul_f32 v[54:55], v[54:55], v[18:19]
    v_cvt_pk_bf16_f32 v22, v48, v49
    v_cvt_pk_bf16_f32 v23, v50, v51
    v_cvt_pk_bf16_f32 v24, v52, v53
    v_cvt_pk_bf16_f32 v25, v54, v55
    v_mfma_f32_32x32x16_bf16 v[48:63], v[44:47], v[120:123], 0
    buffer_store_dwordx4 v[22:25], v1, s[24:27], s80 offen offset:0 sc1
    v_pk_add_f32 v[18:19], v[64:65], s[72:73]
    v_rcp_f32 v18, v18
    v_rcp_f32_e64 v19, v19
    s_nop 0
    v_pk_mul_f32 v[72:73], v[72:73], v[18:19]
    v_pk_mul_f32 v[74:75], v[74:75], v[18:19]
    v_pk_mul_f32 v[76:77], v[76:77], v[18:19]
    v_pk_mul_f32 v[78:79], v[78:79], v[18:19]
    v_cvt_pk_bf16_f32 v64, v72, v73
    v_cvt_pk_bf16_f32 v65, v74, v75
    v_cvt_pk_bf16_f32 v66, v76, v77
    v_cvt_pk_bf16_f32 v67, v78, v79
    buffer_store_dwordx4 v[64:67], v1, s[24:27], s80 offen offset:1024 sc1
    v_pk_add_f32 v[18:19], v[88:89], s[72:73]
    v_rcp_f32 v18, v18
    v_rcp_f32_e64 v19, v19
    s_nop 0
    v_pk_mul_f32 v[80:81], v[80:81], v[18:19]
    v_pk_mul_f32 v[82:83], v[82:83], v[18:19]
    v_pk_mul_f32 v[84:85], v[84:85], v[18:19]
    v_pk_mul_f32 v[86:87], v[86:87], v[18:19]
    v_cvt_pk_bf16_f32 v88, v80, v81
    v_cvt_pk_bf16_f32 v89, v82, v83
    v_cvt_pk_bf16_f32 v90, v84, v85
    v_cvt_pk_bf16_f32 v91, v86, v87
    buffer_store_dwordx4 v[88:91], v1, s[24:27], s80 offen offset:2048 sc1
    v_pk_add_f32 v[18:19], v[48:49], s[72:73]
    v_rcp_f32 v18, v18
    v_rcp_f32_e64 v19, v19
    s_nop 0
    v_pk_mul_f32 v[56:57], v[56:57], v[18:19]
    v_pk_mul_f32 v[58:59], v[58:59], v[18:19]
    v_pk_mul_f32 v[60:61], v[60:61], v[18:19]
    v_pk_mul_f32 v[62:63], v[62:63], v[18:19]
    v_cvt_pk_bf16_f32 v48, v56, v57
    v_cvt_pk_bf16_f32 v49, v58, v59
    v_cvt_pk_bf16_f32 v50, v60, v61
    v_cvt_pk_bf16_f32 v51, v62, v63
    buffer_store_dwordx4 v[48:51], v1, s[24:27], s80 offen offset:3072 sc1
    s_and_b32 s93, s42, 1
    s_lshl_b32 s90, s93, 9
    v_and_b32 v5, 0xff, v2
    v_lshrrev_b32 v6, 5, v0
    v_lshl_or_b32 v5, v6, 8, v5
    v_add_u32 v5, s90, v5
    v_add_u32 v6, 0x10000, v5
    v_add_u32 v7, 0x20000, v5
    v_xor_b32 v10, 512, v5
    v_xor_b32 v11, 512, v6
    v_xor_b32 v12, 512, v7
    s_waitcnt lgkmcnt(0)
    v_cmp_gt_u32 vcc, 3, v30
    s_nop 1
    s_cbranch_vccnz L_lslow59
L_lret60:
    s_cmp_eq_u32 s93, 1
    s_cbranch_scc1 L_park1Q
    ds_read_b64_tr_b16 a[0:1], v6 offset:16384
    ds_read_b64_tr_b16 a[2:3], v6 offset:17408
    ds_read_b64_tr_b16 a[4:5], v11 offset:16384
    ds_read_b64_tr_b16 a[6:7], v11 offset:17408
    ds_read_b64_tr_b16 a[8:9], v6 offset:18432
    ds_read_b64_tr_b16 a[10:11], v6 offset:19456
    ds_read_b64_tr_b16 a[12:13], v11 offset:18432
    ds_read_b64_tr_b16 a[14:15], v11 offset:19456
    ds_read_b64_tr_b16 a[16:17], v6 offset:20480
    ds_read_b64_tr_b16 a[18:19], v6 offset:21504
    ds_read_b64_tr_b16 a[20:21], v11 offset:20480
    ds_read_b64_tr_b16 a[22:23], v11 offset:21504
    ds_read_b64_tr_b16 a[24:25], v6 offset:22528
    ds_read_b64_tr_b16 a[26:27], v6 offset:23552
    ds_read_b64_tr_b16 a[28:29], v11 offset:22528
    ds_read_b64_tr_b16 a[30:31], v11 offset:23552
    ds_read_b64_tr_b16 a[32:33], v6 offset:24576
    ds_read_b64_tr_b16 a[34:35], v6 offset:25600
    ds_read_b64_tr_b16 a[36:37], v11 offset:24576
    ds_read_b64_tr_b16 a[38:39], v11 offset:25600
    ds_read_b64_tr_b16 a[40:41], v6 offset:26624
    ds_read_b64_tr_b16 a[42:43], v6 offset:27648
    ds_read_b64_tr_b16 a[44:45], v11 offset:26624
    ds_read_b64_tr_b16 a[46:47], v11 offset:27648
    ds_read_b64_tr_b16 a[48:49], v6 offset:28672
    ds_read_b64_tr_b16 a[50:51], v6 offset:29696
    ds_read_b64_tr_b16 a[52:53], v11 offset:28672
    ds_read_b64_tr_b16 a[54:55], v11 offset:29696
    ds_read_b64_tr_b16 a[56:57], v6 offset:30720
    ds_read_b64_tr_b16 a[58:59], v6 offset:31744
    ds_read_b64_tr_b16 a[60:61], v11 offset:30720
    ds_read_b64_tr_b16 a[62:63], v11 offset:31744
    ds_read_b64_tr_b16 a[64:65], v5 offset:49152
    ds_read_b64_tr_b16 a[66:67], v5 offset:50176
    ds_read_b64_tr_b16 a[68:69], v10 offset:49152
    ds_read_b64_tr_b16 a[70:71], v10 offset:50176
    ds_read_b64_tr_b16 a[72:73], v5 offset:51200
    ds_read_b64_tr_b16 a[74:75], v5 offset:52224
    ds_read_b64_tr_b16 a[76:77], v10 offset:51200
    ds_read_b64_tr_b16 a[78:79], v10 offset:52224
    ds_read_b64_tr_b16 a[80:81], v5 offset:53248
    ds_read_b64_tr_b16 a[82:83], v5 offset:54272
    ds_read_b64_tr_b16 a[84:85], v10 offset:53248
    ds_read_b64_tr_b16 a[86:87], v10 offset:54272
    ds_read_b64_tr_b16 a[88:89], v5 offset:55296
    ds_read_b64_tr_b16 a[90:91], v5 offset:56320
    ds_read_b64_tr_b16 a[92:93], v10 offset:55296
    ds_read_b64_tr_b16 a[94:95], v10 offset:56320
    ds_read_b64_tr_b16 a[96:97], v5 offset:57344
    ds_read_b64_tr_b16 a[98:99], v5 offset:58368
    ds_read_b64_tr_b16 a[100:101], v10 offset:57344
    ds_read_b64_tr_b16 a[102:103], v10 offset:58368
    ds_read_b64_tr_b16 a[104:105], v5 offset:59392
    ds_read_b64_tr_b16 a[106:107], v5 offset:60416
    ds_read_b64_tr_b16 a[108:109], v10 offset:59392
    ds_read_b64_tr_b16 a[110:111], v10 offset:60416
    ds_read_b64_tr_b16 a[112:113], v5 offset:61440
    ds_read_b64_tr_b16 a[114:115], v5 offset:62464
    ds_read_b64_tr_b16 a[116:117], v10 offset:61440
    ds_read_b64_tr_b16 a[118:119], v10 offset:62464
    ds_read_b64_tr_b16 a[120:121], v5 offset:63488
    ds_read_b64_tr_b16 a[122:123], v5 offset:64512
    ds_read_b64_tr_b16 a[124:125], v10 offset:63488
    ds_read_b64_tr_b16 a[126:127], v10 offset:64512
L_parkedQ:
    v_mov_b32_e64 v28, 5
    ds_write_b32 v27, v28
    s_waitcnt vmcnt(0)
    s_lshl_b32 s92, s63, 3
    s_add_u32 s92, s92, s3
    s_lshl_b32 s92, s92, 7
    s_add_u32 s92, s92, 851968
    v_mov_b32 v18, s40
    v_mov_b32 v19, s41
    s_mov_b64 exec, 1
    buffer_store_dwordx2 v[18:19], off, s[24:27], s92 sc1
    s_mov_b64 exec, -1
    ds_read_b32 v30, v26 offset:16
    s_lshl_b32 s90, s45, 6
    s_lshr_b32 s92, s42, 1
    s_lshl_b32 s92, s92, 5
    s_add_u32 s90, s90, s92
    s_lshl_b32 s90, s90, 10
    s_lshl_b32 s92, s46, 1
    s_add_u32 s92, s92, s93
    s_lshl_b32 s92, s92, 6
    s_add_u32 s91, s90, s92
    v_lshrrev_b32 v2, 2, v0
    v_lshlrev_b32 v2, 10, v2
    v_and_b32 v3, 3, v0
    v_lshl_or_b32 v2, v3, 4, v2
    v_lshlrev_b32_e64 v7, 7, v3
    v_add_u32 v3, 15360, v2
    s_lshr_b32 s90, s62, 1
    s_add_u32 s90, s90, 131072
    s_mov_b32 m0, s90
    v_and_b32 v4, 31, v0
    v_lshlrev_b32 v4, 6, v4
    v_lshrrev_b32 v31, 5, v0
    v_lshl_or_b32 v4, v31, 3, v4
    v_add_u32 v4, s90, v4
    v_add_u32 v9, s90, v1
    s_waitcnt lgkmcnt(0)
    v_cmp_gt_u32 vcc, 5, v30
    s_nop 1
    s_cbranch_vccnz L_lslow61
L_lret62:
    buffer_load_dwordx4 v2, s[4:7], s91 offen lds
    buffer_load_dwordx4 v3, s[4:7], s91 offen offset:1024 lds
    s_lshl_b32 s100, s45, 1
    s_lshr_b32 s92, s42, 1
    s_add_u32 s100, s100, s92
    s_lshl_b32 s100, s100, 1
    s_add_u32 s100, s100, s93
    s_lshl_b32 s101, s100, 14
    s_lshl_b32 s100, s100, 9
    s_add_u32 s100, s100, 851968
    s_add_u32 s101, s101, 2097152
    s_xor_b32 s90, s62, 4096
    s_add_u32 s90, s90, 65536
    v_add_u32 v8, s90, v1
    s_lshl_b32 s90, s42, 14
    s_add_u32 s90, s90, 0
    v_add_u32 v6, s90, v1
    ds_read_b32 v30, v26 offset:0
    s_waitcnt lgkmcnt(0)
    v_cmp_gt_u32 vcc, 4, v30
    s_nop 1
    s_cbranch_vccnz L_lslow63
L_lret64:
    s_buffer_load_dwordx2 s[48:49], s[24:27], s100 offset:0 glc
    s_buffer_load_dwordx2 s[50:51], s[24:27], s100 offset:128 glc
    s_buffer_load_dwordx2 s[52:53], s[24:27], s100 offset:256 glc
    s_buffer_load_dwordx2 s[54:55], s[24:27], s100 offset:384 glc
    s_waitcnt lgkmcnt(0)
    s_xor_b64 s[48:49], s[48:49], s[40:41]
    s_xor_b64 s[50:51], s[50:51], s[40:41]
    s_xor_b64 s[52:53], s[52:53], s[40:41]
    s_xor_b64 s[54:55], s[54:55], s[40:41]
    s_or_b64 s[48:49], s[48:49], s[50:51]
    s_or_b64 s[48:49], s[48:49], s[52:53]
    s_or_b64 s[48:49], s[48:49], s[54:55]
    s_cbranch_scc1 L_slow_o65
L_ret_o66:
    s_mul_i32 s84, s46, 1
    s_add_u32 s84, s84, 0
    s_and_b32 s84, s84, 7
    s_lshl_b32 s84, s84, 11
    s_add_u32 s84, s84, s101
    buffer_load_dwordx4 v[32:35], v1, s[24:27], s84 offen offset:0 sc1
    buffer_load_dwordx4 v[36:39], v1, s[24:27], s84 offen offset:1024 sc1
    s_mul_i32 s84, s46, 1
    s_add_u32 s84, s84, 1
    s_and_b32 s84, s84, 7
    s_lshl_b32 s84, s84, 11
    s_add_u32 s84, s84, s101
    buffer_load_dwordx4 v[40:43], v1, s[24:27], s84 offen offset:0 sc1
    buffer_load_dwordx4 v[44:47], v1, s[24:27], s84 offen offset:1024 sc1
    s_mul_i32 s84, s46, 1
    s_add_u32 s84, s84, 2
    s_and_b32 s84, s84, 7
    s_lshl_b32 s84, s84, 11
    s_add_u32 s84, s84, s101
    buffer_load_dwordx4 v[48:51], v1, s[24:27], s84 offen offset:0 sc1
    buffer_load_dwordx4 v[52:55], v1, s[24:27], s84 offen offset:1024 sc1
    s_mul_i32 s84, s46, 1
    s_add_u32 s84, s84, 3
    s_and_b32 s84, s84, 7
    s_lshl_b32 s84, s84, 11
    s_add_u32 s84, s84, s101
    buffer_load_dwordx4 v[56:59], v1, s[24:27], s84 offen offset:0 sc1
    buffer_load_dwordx4 v[60:63], v1, s[24:27], s84 offen offset:1024 sc1
    s_waitcnt vmcnt(7)
    v_mfma_f32_32x32x16_bf16 v[80:95], a[4:7], v[32:35], 0
    v_mfma_f32_32x32x16_bf16 v[64:79], a[0:3], v[32:35], 0
    s_mul_i32 s84, s46, 1
    s_add_u32 s84, s84, 4
    s_and_b32 s84, s84, 7
    s_lshl_b32 s84, s84, 11
    s_add_u32 s84, s84, s101
    buffer_load_dwordx4 v[32:35], v1, s[24:27], s84 offen offset:0 sc1
    ds_read_b64 v[96:97], v4 offset:0
    ds_read_b64 v[98:99], v4 offset:16
    ds_read_b64 v[100:101], v4 offset:32
    ds_read_b64 v[102:103], v4 offset:48
    s_waitcnt vmcnt(7)
    v_mfma_f32_32x32x16_bf16 v[80:95], a[12:15], v[36:39], v[80:95]
    v_mfma_f32_32x32x16_bf16 v[64:79], a[8:11], v[36:39], v[64:79]
    buffer_load_dwordx4 v[36:39], v1, s[24:27], s84 offen offset:1024 sc1
    s_waitcnt vmcnt(7)
    v_mfma_f32_32x32x16_bf16 v[80:95], a[20:23], v[40:43], v[80:95]
    v_mfma_f32_32x32x16_bf16 v[64:79], a[16:19], v[40:43], v[64:79]
    s_mul_i32 s84, s46, 1
    s_add_u32 s84, s84, 5
    s_and_b32 s84, s84, 7
    s_lshl_b32 s84, s84, 11
    s_add_u32 s84, s84, s101
    buffer_load_dwordx4 v[40:43], v1, s[24:27], s84 offen offset:0 sc1
    s_waitcnt lgkmcnt(3)
    v_lshlrev_b32_e64 v112, 16, v96
    v_and_b32 v113, 0xffff0000, v96
    s_waitcnt vmcnt(7)
    v_mfma_f32_32x32x16_bf16 v[80:95], a[28:31], v[44:47], v[80:95]
    v_mfma_f32_32x32x16_bf16 v[64:79], a[24:27], v[44:47], v[64:79]
    buffer_load_dwordx4 v[44:47], v1, s[24:27], s84 offen offset:1024 sc1
    v_lshlrev_b32_e64 v114, 16, v97
    v_and_b32 v115, 0xffff0000, v97
    s_waitcnt vmcnt(7)
    v_mfma_f32_32x32x16_bf16 v[80:95], a[36:39], v[48:51], v[80:95]
    v_mfma_f32_32x32x16_bf16 v[64:79], a[32:35], v[48:51], v[64:79]
    s_mul_i32 s84, s46, 1
    s_add_u32 s84, s84, 6
    s_and_b32 s84, s84, 7
    s_lshl_b32 s84, s84, 11
    s_add_u32 s84, s84, s101
    buffer_load_dwordx4 v[48:51], v1, s[24:27], s84 offen offset:0 sc1
    s_waitcnt lgkmcnt(2)
    v_lshlrev_b32_e64 v116, 16, v98
    v_and_b32 v117, 0xffff0000, v98
    s_waitcnt vmcnt(7)
    v_mfma_f32_32x32x16_bf16 v[80:95], a[44:47], v[52:55], v[80:95]
    v_mfma_f32_32x32x16_bf16 v[64:79], a[40:43], v[52:55], v[64:79]
    buffer_load_dwordx4 v[52:55], v1, s[24:27], s84 offen offset:1024 sc1
    v_lshlrev_b32 v118, 16, v99
    v_and_b32 v119, 0xffff0000, v99
    s_waitcnt vmcnt(7)
    v_mfma_f32_32x32x16_bf16 v[80:95], a[52:55], v[56:59], v[80:95]
    v_mfma_f32_32x32x16_bf16 v[64:79], a[48:51], v[56:59], v[64:79]
    s_mul_i32 s84, s46, 1
    s_add_u32 s84, s84, 7
    s_and_b32 s84, s84, 7
    s_lshl_b32 s84, s84, 11
    s_add_u32 s84, s84, s101
    buffer_load_dwordx4 v[56:59], v1, s[24:27], s84 offen offset:0 sc1
    s_waitcnt lgkmcnt(1)
    v_lshlrev_b32 v120, 16, v100
    v_and_b32 v121, 0xffff0000, v100
    s_waitcnt vmcnt(7)
    v_mfma_f32_32x32x16_bf16 v[80:95], a[60:63], v[60:63], v[80:95]
    v_mfma_f32_32x32x16_bf16 v[64:79], a[56:59], v[60:63], v[64:79]
    buffer_load_dwordx4 v[60:63], v1, s[24:27], s84 offen offset:1024 sc1
    v_lshlrev_b32 v122, 16, v101
    v_and_b32 v123, 0xffff0000, v101
    s_waitcnt vmcnt(7)
    v_mfma_f32_32x32x16_bf16 v[80:95], a[68:71], v[32:35], v[80:95]
    v_mfma_f32_32x32x16_bf16 v[64:79], a[64:67], v[32:35], v[64:79]
    s_waitcnt lgkmcnt(0)
    v_lshlrev_b32 v124, 16, v102
    v_and_b32 v125, 0xffff0000, v102
    s_waitcnt vmcnt(6)
    v_mfma_f32_32x32x16_bf16 v[80:95], a[76:79], v[36:39], v[80:95]
    v_mfma_f32_32x32x16_bf16 v[64:79], a[72:75], v[36:39], v[64:79]
    v_lshlrev_b32 v126, 16, v103
    v_and_b32 v127, 0xffff0000, v103
    s_waitcnt vmcnt(5)
    v_mfma_f32_32x32x16_bf16 v[80:95], a[84:87], v[40:43], v[80:95]
    v_mfma_f32_32x32x16_bf16 v[64:79], a[80:83], v[40:43], v[64:79]
    s_waitcnt vmcnt(4)
    v_mfma_f32_32x32x16_bf16 v[80:95], a[92:95], v[44:47], v[80:95]
    v_mfma_f32_32x32x16_bf16 v[64:79], a[88:91], v[44:47], v[64:79]
    s_waitcnt vmcnt(3)
    v_mfma_f32_32x32x16_bf16 v[80:95], a[100:103], v[48:51], v[80:95]
    v_mfma_f32_32x32x16_bf16 v[64:79], a[96:99], v[48:51], v[64:79]
    s_waitcnt vmcnt(2)
    v_mfma_f32_32x32x16_bf16 v[80:95], a[108:111], v[52:55], v[80:95]
    v_mfma_f32_32x32x16_bf16 v[64:79], a[104:107], v[52:55], v[64:79]
    ds_read_b32 v30, v26 offset:0
    s_waitcnt vmcnt(1)
    v_mfma_f32_32x32x16_bf16 v[80:95], a[116:119], v[56:59], v[80:95]
    v_mfma_f32_32x32x16_bf16 v[64:79], a[112:115], v[56:59], v[64:79]
    s_waitcnt vmcnt(0)
    v_mfma_f32_32x32x16_bf16 v[80:95], a[124:127], v[60:63], v[80:95]
    v_mfma_f32_32x32x16_bf16 v[64:79], a[120:123], v[60:63], v[64:79]
    s_waitcnt lgkmcnt(0)
    v_cmp_gt_u32 vcc, 6, v30
    s_nop 1
    s_cbranch_vccnz L_lslow67
L_lret68:
    ds_read_b128 v[32:35], v6 offset:0
    ds_read_b128 v[96:99], v6 offset:4096
    ds_read_b128 v[10:13], v6 offset:8192
    ds_read_b128 v[48:51], v6 offset:12288
    ds_read_b128 v[36:39], v6 offset:1024
    ds_read_b128 v[100:103], v6 offset:5120
    ds_read_b128 v[14:17], v6 offset:9216
    ds_read_b128 v[52:55], v6 offset:13312
    ds_write_b128 v8, v[80:83] offset:0
    ds_write_b128 v8, v[84:87] offset:1024
    ds_write_b128 v8, v[88:91] offset:2048
    ds_write_b128 v8, v[92:95] offset:3072
    v_mov_b32_e64 v28, 6
    ds_write_b32 v27, v28
    v_xor_b32 v8, 4096, v8
    v_add_u32 v3, 1024, v3
    s_waitcnt lgkmcnt(11)
    v_pk_add_f32 v[32:33], v[32:33], v[96:97]
    v_pk_add_f32 v[34:35], v[34:35], v[98:99]
    s_waitcnt lgkmcnt(9)
    v_pk_add_f32 v[18:19], v[10:11], v[48:49]
    v_pk_add_f32 v[20:21], v[12:13], v[50:51]
    ds_read_b128 v[40:43], v6 offset:2048
    ds_read_b128 v[104:107], v6 offset:6144
    ds_read_b128 v[10:13], v6 offset:10240
    ds_read_b128 v[56:59], v6 offset:14336
    v_pk_add_f32 v[32:33], v[32:33], v[18:19]
    v_pk_add_f32 v[34:35], v[34:35], v[20:21]
    v_pk_mul_f32 v[18:19], v[32:33], s[76:77]
    v_pk_mul_f32 v[20:21], v[34:35], s[76:77]
    v_exp_f32 v18, v18
    v_exp_f32 v19, v19
    v_exp_f32 v20, v20
    v_exp_f32 v21, v21
    v_pk_add_f32 v[18:19], v[18:19], s[78:79]
    v_pk_add_f32 v[20:21], v[20:21], s[78:79]
    v_rcp_f32 v18, v18
    v_rcp_f32 v19, v19
    v_rcp_f32_e64 v20, v20
    v_rcp_f32_e64 v21, v21
    v_pk_mul_f32 v[32:33], v[32:33], v[18:19]
    v_pk_mul_f32 v[34:35], v[34:35], v[20:21]
    s_waitcnt lgkmcnt(11)
    v_pk_add_f32 v[36:37], v[36:37], v[100:101]
    v_pk_add_f32 v[38:39], v[38:39], v[102:103]
    s_waitcnt lgkmcnt(9)
    v_pk_add_f32 v[18:19], v[14:15], v[52:53]
    v_pk_add_f32 v[20:21], v[16:17], v[54:55]
    ds_read_b128 v[44:47], v6 offset:3072
    ds_read_b128 v[108:111], v6 offset:7168
    ds_read_b128 v[14:17], v6 offset:11264
    ds_read_b128 v[60:63], v6 offset:15360
    v_pk_add_f32 v[36:37], v[36:37], v[18:19]
    v_pk_add_f32 v[38:39], v[38:39], v[20:21]
    v_pk_mul_f32 v[18:19], v[36:37], s[76:77]
    v_pk_mul_f32 v[20:21], v[38:39], s[76:77]
    v_exp_f32 v18, v18
    v_exp_f32 v19, v19
    v_exp_f32 v20, v20
    v_exp_f32 v21, v21
    v_pk_add_f32 v[18:19], v[18:19], s[78:79]
    v_pk_add_f32 v[20:21], v[20:21], s[78:79]
    v_rcp_f32 v18, v18
    v_rcp_f32 v19, v19
    v_rcp_f32 v20, v20
    v_rcp_f32 v21, v21
    v_pk_mul_f32 v[36:37], v[36:37], v[18:19]
    v_pk_mul_f32 v[38:39], v[38:39], v[20:21]
    s_waitcnt lgkmcnt(6)
    v_pk_add_f32 v[40:41], v[40:41], v[104:105]
    v_pk_add_f32 v[42:43], v[42:43], v[106:107]
    s_waitcnt lgkmcnt(4)
    v_pk_add_f32 v[18:19], v[10:11], v[56:57]
    v_pk_add_f32 v[20:21], v[12:13], v[58:59]
    ds_read_b32 v30, v26 offset:16
    v_pk_add_f32 v[40:41], v[40:41], v[18:19]
    v_pk_add_f32 v[42:43], v[42:43], v[20:21]
    v_pk_mul_f32 v[18:19], v[40:41], s[76:77]
    v_pk_mul_f32 v[20:21], v[42:43], s[76:77]
    v_exp_f32 v18, v18
    v_exp_f32 v19, v19
    v_exp_f32 v20, v20
    v_exp_f32 v21, v21
    v_pk_add_f32 v[18:19], v[18:19], s[78:79]
    v_pk_add_f32 v[20:21], v[20:21], s[78:79]
    v_rcp_f32 v18, v18
    v_rcp_f32 v19, v19
    v_rcp_f32_e64 v20, v20
    v_rcp_f32_e64 v21, v21
    v_pk_mul_f32 v[40:41], v[40:41], v[18:19]
    v_pk_mul_f32 v[42:43], v[42:43], v[20:21]
    s_waitcnt lgkmcnt(3)
    v_pk_add_f32 v[44:45], v[44:45], v[108:109]
    v_pk_add_f32 v[46:47], v[46:47], v[110:111]
    s_waitcnt lgkmcnt(1)
    v_pk_add_f32 v[18:19], v[14:15], v[60:61]
    v_pk_add_f32 v[20:21], v[16:17], v[62:63]
    v_pk_add_f32 v[44:45], v[44:45], v[18:19]
    v_pk_add_f32 v[46:47], v[46:47], v[20:21]
    v_pk_mul_f32 v[18:19], v[44:45], s[76:77]
    v_pk_mul_f32 v[20:21], v[46:47], s[76:77]
    v_exp_f32 v18, v18
    v_exp_f32 v19, v19
    v_exp_f32 v20, v20
    v_exp_f32 v21, v21
    s_waitcnt lgkmcnt(0)
    v_cmp_gt_u32 vcc, 6, v30
    s_nop 1
    s_cbranch_vccnz L_lslow69
L_lret70:
    ds_read_b128 v[80:83], v8 offset:0
    ds_read_b128 v[84:87], v8 offset:1024
    ds_read_b128 v[88:91], v8 offset:2048
    ds_read_b128 v[92:95], v8 offset:3072
    v_pk_add_f32 v[18:19], v[18:19], s[78:79]
    v_pk_add_f32 v[20:21], v[20:21], s[78:79]
    v_rcp_f32 v18, v18
    v_rcp_f32 v19, v19
    v_rcp_f32 v20, v20
    v_rcp_f32_e64 v21, v21
    v_pk_mul_f32 v[44:45], v[44:45], v[18:19]
    v_pk_mul_f32 v[46:47], v[46:47], v[20:21]
    s_waitcnt lgkmcnt(3)
    v_pk_add_f32 v[64:65], v[64:65], v[80:81]
    v_pk_add_f32 v[66:67], v[66:67], v[82:83]
    v_pk_fma_f32 v[112:113], v[64:65], v[32:33], v[112:113]
    v_pk_fma_f32 v[114:115], v[66:67], v[34:35], v[114:115]
    v_cvt_pk_bf16_f32 v18, v112, v113
    v_cvt_pk_bf16_f32 v19, v114, v115
    ds_write_b64 v4, v[18:19] offset:0
    s_waitcnt lgkmcnt(3)
    v_pk_add_f32 v[68:69], v[68:69], v[84:85]
    v_pk_add_f32 v[70:71], v[70:71], v[86:87]
    v_pk_fma_f32 v[116:117], v[68:69], v[36:37], v[116:117]
    v_pk_fma_f32 v[118:119], v[70:71], v[38:39], v[118:119]
    v_cvt_pk_bf16_f32 v20, v116, v117
    v_cvt_pk_bf16_f32 v21, v118, v119
    ds_write_b64 v4, v[20:21] offset:16
    s_waitcnt lgkmcnt(3)
    v_pk_add_f32 v[72:73], v[72:73], v[88:89]
    v_pk_add_f32 v[74:75], v[74:75], v[90:91]
    v_pk_fma_f32 v[120:121], v[72:73], v[40:41], v[120:121]
    v_pk_fma_f32 v[122:123], v[74:75], v[42:43], v[122:123]
    v_cvt_pk_bf16_f32 v22, v120, v121
    v_cvt_pk_bf16_f32 v23, v122, v123
    ds_write_b64 v4, v[22:23] offset:32
    s_waitcnt lgkmcnt(3)
    v_pk_add_f32 v[76:77], v[76:77], v[92:93]
    v_pk_add_f32 v[78:79], v[78:79], v[94:95]
    v_pk_fma_f32 v[124:125], v[76:77], v[44:45], v[124:125]
    v_pk_fma_f32 v[126:127], v[78:79], v[46:47], v[126:127]
    v_cvt_pk_bf16_f32 v24, v124, v125
    v_cvt_pk_bf16_f32 v25, v126, v127
    ds_write_b64 v4, v[24:25] offset:48
    ds_read_b128 v[48:51], v9
    ds_read_b128 v[52:55], v9 offset:1024
    s_waitcnt lgkmcnt(1)
    buffer_store_dwordx4 v[48:51], v2, s[28:31], s91 offen sc1
    s_waitcnt lgkmcnt(0)
    buffer_store_dwordx4 v[52:55], v3, s[28:31], s91 offen sc1
    s_endpgm
L_slow_st51:
s_mov_b32 s67, 0
L_slow_st51_loop:
s_sleep 4
buffer_load_dwordx4 v[18:21], v31, s[24:27], s101 offen sc1
s_waitcnt vmcnt(0)
s_add_u32 s67, s67, 1
s_cmp_ge_u32 s67, 0x8000
s_cbranch_scc1 L_ret_st52
v_cmp_ne_u64 vcc, s[40:41], v[20:21]
s_nop 1
s_cbranch_vccnz L_slow_st51_loop
s_branch L_ret_st52
L_lslow53:
s_mov_b32 s67, 0
L_lslow53_loop:
ds_read_b32 v30, v26 offset:0
s_add_u32 s67, s67, 1
s_cmp_ge_u32 s67, 0x100000
s_cbranch_scc1 L_lret54
s_waitcnt lgkmcnt(0)
v_cmp_gt_u32 vcc, 1, v30
s_nop 1
s_cbranch_vccnz L_lslow53_loop
s_branch L_lret54
L_slow_kv55:
s_mov_b32 s67, 0
L_slow_kv55_loop:
s_sleep 4
buffer_load_dword v14, v16, s[24:27], s100 offen sc1
s_waitcnt vmcnt(0)
s_add_u32 s67, s67, 1
s_cmp_ge_u32 s67, 0x8000
s_cbranch_scc1 L_ret_kv56
v_subrev_u32_e64 v14, s40, v14
v_subrev_u32_e64 v14, 16, v14
v_cmp_lt_u32 vcc, 0, v14
s_nop 1
s_cbranch_vccnz L_slow_kv55_loop
s_branch L_ret_kv56
L_lslow57:
s_mov_b32 s67, 0
L_lslow57_loop:
ds_read_b32 v30, v26 offset:16
s_add_u32 s67, s67, 1
s_cmp_ge_u32 s67, 0x100000
s_cbranch_scc1 L_lret58
s_waitcnt lgkmcnt(0)
v_cmp_gt_u32 vcc, 4, v30
s_nop 1
s_cbranch_vccnz L_lslow57_loop
s_branch L_lret58
L_lslow59:
s_mov_b32 s67, 0
L_lslow59_loop:
ds_read_b32 v30, v26 offset:0
s_add_u32 s67, s67, 1
s_cmp_ge_u32 s67, 0x100000
s_cbranch_scc1 L_lret60
s_waitcnt lgkmcnt(0)
v_cmp_gt_u32 vcc, 3, v30
s_nop 1
s_cbranch_vccnz L_lslow59_loop
s_branch L_lret60
L_park1Q:
ds_read_b64_tr_b16 a[0:1], v6 offset:32768
ds_read_b64_tr_b16 a[2:3], v6 offset:33792
ds_read_b64_tr_b16 a[4:5], v11 offset:32768
ds_read_b64_tr_b16 a[6:7], v11 offset:33792
ds_read_b64_tr_b16 a[8:9], v6 offset:34816
ds_read_b64_tr_b16 a[10:11], v6 offset:35840
ds_read_b64_tr_b16 a[12:13], v11 offset:34816
ds_read_b64_tr_b16 a[14:15], v11 offset:35840
ds_read_b64_tr_b16 a[16:17], v6 offset:36864
ds_read_b64_tr_b16 a[18:19], v6 offset:37888
ds_read_b64_tr_b16 a[20:21], v11 offset:36864
ds_read_b64_tr_b16 a[22:23], v11 offset:37888
ds_read_b64_tr_b16 a[24:25], v6 offset:38912
ds_read_b64_tr_b16 a[26:27], v6 offset:39936
ds_read_b64_tr_b16 a[28:29], v11 offset:38912
ds_read_b64_tr_b16 a[30:31], v11 offset:39936
ds_read_b64_tr_b16 a[32:33], v6 offset:40960
ds_read_b64_tr_b16 a[34:35], v6 offset:41984
ds_read_b64_tr_b16 a[36:37], v11 offset:40960
ds_read_b64_tr_b16 a[38:39], v11 offset:41984
ds_read_b64_tr_b16 a[40:41], v6 offset:43008
ds_read_b64_tr_b16 a[42:43], v6 offset:44032
ds_read_b64_tr_b16 a[44:45], v11 offset:43008
ds_read_b64_tr_b16 a[46:47], v11 offset:44032
ds_read_b64_tr_b16 a[48:49], v6 offset:45056
ds_read_b64_tr_b16 a[50:51], v6 offset:46080
ds_read_b64_tr_b16 a[52:53], v11 offset:45056
ds_read_b64_tr_b16 a[54:55], v11 offset:46080
ds_read_b64_tr_b16 a[56:57], v6 offset:47104
ds_read_b64_tr_b16 a[58:59], v6 offset:48128
ds_read_b64_tr_b16 a[60:61], v11 offset:47104
ds_read_b64_tr_b16 a[62:63], v11 offset:48128
ds_read_b64_tr_b16 a[64:65], v6 offset:49152
ds_read_b64_tr_b16 a[66:67], v6 offset:50176
ds_read_b64_tr_b16 a[68:69], v11 offset:49152
ds_read_b64_tr_b16 a[70:71], v11 offset:50176
ds_read_b64_tr_b16 a[72:73], v6 offset:51200
ds_read_b64_tr_b16 a[74:75], v6 offset:52224
ds_read_b64_tr_b16 a[76:77], v11 offset:51200
ds_read_b64_tr_b16 a[78:79], v11 offset:52224
ds_read_b64_tr_b16 a[80:81], v6 offset:53248
ds_read_b64_tr_b16 a[82:83], v6 offset:54272
ds_read_b64_tr_b16 a[84:85], v11 offset:53248
ds_read_b64_tr_b16 a[86:87], v11 offset:54272
ds_read_b64_tr_b16 a[88:89], v6 offset:55296
ds_read_b64_tr_b16 a[90:91], v6 offset:56320
ds_read_b64_tr_b16 a[92:93], v11 offset:55296
ds_read_b64_tr_b16 a[94:95], v11 offset:56320
ds_read_b64_tr_b16 a[96:97], v6 offset:57344
ds_read_b64_tr_b16 a[98:99], v6 offset:58368
ds_read_b64_tr_b16 a[100:101], v11 offset:57344
ds_read_b64_tr_b16 a[102:103], v11 offset:58368
ds_read_b64_tr_b16 a[104:105], v6 offset:59392
ds_read_b64_tr_b16 a[106:107], v6 offset:60416
ds_read_b64_tr_b16 a[108:109], v11 offset:59392
ds_read_b64_tr_b16 a[110:111], v11 offset:60416
ds_read_b64_tr_b16 a[112:113], v6 offset:61440
ds_read_b64_tr_b16 a[114:115], v6 offset:62464
ds_read_b64_tr_b16 a[116:117], v11 offset:61440
ds_read_b64_tr_b16 a[118:119], v11 offset:62464
ds_read_b64_tr_b16 a[120:121], v6 offset:63488
ds_read_b64_tr_b16 a[122:123], v6 offset:64512
ds_read_b64_tr_b16 a[124:125], v11 offset:63488
ds_read_b64_tr_b16 a[126:127], v11 offset:64512
s_branch L_parkedQ
L_lslow61:
s_mov_b32 s67, 0
L_lslow61_loop:
ds_read_b32 v30, v26 offset:16
s_add_u32 s67, s67, 1
s_cmp_ge_u32 s67, 0x100000
s_cbranch_scc1 L_lret62
s_waitcnt lgkmcnt(0)
v_cmp_gt_u32 vcc, 5, v30
s_nop 1
s_cbranch_vccnz L_lslow61_loop
s_branch L_lret62
L_lslow63:
s_mov_b32 s67, 0
L_lslow63_loop:
ds_read_b32 v30, v26 offset:0
s_add_u32 s67, s67, 1
s_cmp_ge_u32 s67, 0x100000
s_cbranch_scc1 L_lret64
s_waitcnt lgkmcnt(0)
v_cmp_gt_u32 vcc, 4, v30
s_nop 1
s_cbranch_vccnz L_lslow63_loop
s_branch L_lret64
L_slow_o65:
s_mov_b32 s67, 0
L_slow_o65_loop:
s_sleep 2
s_buffer_load_dwordx2 s[48:49], s[24:27], s100 offset:0 glc
s_buffer_load_dwordx2 s[50:51], s[24:27], s100 offset:128 glc
s_buffer_load_dwordx2 s[52:53], s[24:27], s100 offset:256 glc
s_buffer_load_dwordx2 s[54:55], s[24:27], s100 offset:384 glc
s_waitcnt lgkmcnt(0)
s_add_u32 s67, s67, 1
s_cmp_ge_u32 s67, 0x8000
s_cbranch_scc1 L_ret_o66
s_xor_b64 s[48:49], s[48:49], s[40:41]
s_xor_b64 s[50:51], s[50:51], s[40:41]
s_xor_b64 s[52:53], s[52:53], s[40:41]
s_xor_b64 s[54:55], s[54:55], s[40:41]
s_or_b64 s[48:49], s[48:49], s[50:51]
s_or_b64 s[48:49], s[48:49], s[52:53]
s_or_b64 s[48:49], s[48:49], s[54:55]
s_cbranch_scc1 L_slow_o65_loop
s_branch L_ret_o66
L_lslow67:
s_mov_b32 s67, 0
L_lslow67_loop:
ds_read_b32 v30, v26 offset:0
s_add_u32 s67, s67, 1
s_cmp_ge_u32 s67, 0x100000
s_cbranch_scc1 L_lret68
s_waitcnt lgkmcnt(0)
v_cmp_gt_u32 vcc, 6, v30
s_nop 1
s_cbranch_vccnz L_lslow67_loop
s_branch L_lret68
L_lslow69:
s_mov_b32 s67, 0
L_lslow69_loop:
ds_read_b32 v30, v26 offset:16
s_add_u32 s67, s67, 1
s_cmp_ge_u32 s67, 0x100000
s_cbranch_scc1 L_lret70
s_waitcnt lgkmcnt(0)
v_cmp_gt_u32 vcc, 6, v30
s_nop 1
s_cbranch_vccnz L_lslow69_loop
s_branch L_lret70
L_end:
s_endpgm
.section .rodata,"a"
.p2align 6
.amdhsa_kernel recurrent_scan__linear_attn_block__dense_activation_gelu__prompt_kernel
  .amdhsa_next_free_vgpr 256
  .amdhsa_next_free_sgpr 102
  .amdhsa_accum_offset 128
  .amdhsa_group_segment_fixed_size 0
  .amdhsa_kernarg_size 88
  .amdhsa_user_sgpr_count 2
  .amdhsa_user_sgpr_kernarg_segment_ptr 1
  .amdhsa_system_sgpr_workgroup_id_x 1
.end_amdhsa_kernel
```
